```python
import torch

def _softmax(x, axis=-1):
    return torch.softmax(x, dim=axis)
def _gelu(x):
    return torch.nn.functional.gelu(x, approximate="tanh")
def _silu(x):
    return torch.nn.functional.silu(x)
def _sigmoid(x):
    return torch.sigmoid(x)
def _layernorm(x, axis=-1, eps=1e-5):
    m = x.mean(dim=axis, keepdim=True)
    v = x.var(dim=axis, keepdim=True, unbiased=False)
    return (x - m) / torch.sqrt(v + eps)
def _scatter_add(tgt, idx, src, axis=0):
    return tgt.clone().index_add_(axis, idx, src)
def _segment_sum(src, seg, n):
    out = torch.zeros((n,) + src.shape[1:], dtype=src.dtype)
    return out.index_add_(0, seg, src)
def _pad(x, pw):
    flat = tuple(v for pair in reversed(pw) for v in pair)
    return torch.nn.functional.pad(x, flat)

kernel_name = 'gated_mix__sliding_local_dilated__dense_activation_relu__prompt'

def setup_inputs():

    _w = (lambda a: (lambda t: t.to(torch.bfloat16) if t.is_floating_point() else t)(torch.as_tensor(a)))
    def _A_setup():
        B, S, D = 1, 2048, 1024
        return {
            "x": _w((lambda *s: torch.randn(*s, dtype=torch.bfloat16) * 0.05)(B, S, D)),
            "wqkv": _w((lambda *s: torch.randn(*s, dtype=torch.bfloat16) * 0.8)(D, 3 * D)),
            "wo": _w((lambda *s: torch.randn(*s, dtype=torch.bfloat16) * 0.05)(D, D)),
        }
    _A_in = _A_setup()

    def _B_setup():
        B, S, D, Dff = 1, 2048, 1024, 3584
        return {
            "x": _w((lambda *s: torch.randn(*s, dtype=torch.bfloat16) * 0.05)(B, S, D)),
            "w1": _w((lambda *s: torch.randn(*s, dtype=torch.bfloat16) * 0.2)(D, Dff)),
            "w2": _w((lambda *s: torch.randn(*s, dtype=torch.bfloat16) * 0.2)(Dff, D)),
        }
    _B_in = _B_setup()

    return {
        "A_x": _A_in["x"],
        "A_wqkv": _A_in["wqkv"],
        "A_wo": _A_in["wo"],
        "B_x": _B_in["x"],
        "B_w1": _B_in["w1"],
        "B_w2": _B_in["w2"],
        "gate_w": _w((lambda *s: torch.randn(*s, dtype=torch.bfloat16) * 0.05)(1024) * 16.0),
    }

def reference(A_x, A_wqkv, A_wo, B_x, B_w1, B_w2, gate_w):
    def _A_ref(x, wqkv, wo):
        B, S, D = x.shape
        H = 32; Dh = D // H
        W, dil = 8, 2
        qkv = (lambda x, *d: x.permute(*d))((x @ wqkv).reshape(B, S, 3, H, Dh), 2, 0, 3, 1, 4)
        q, k, v = qkv[0], qkv[1], qkv[2]
        scale = Dh ** -0.5
        pos = torch.arange(S)
        off = torch.arange(W) * dil
        idx = pos[:, None] - off[None, :]
        mask = idx >= 0
        idx_c = torch.where(mask, idx, 0).reshape(-1)
        kg = k[:, :, idx_c, :].reshape(B, H, S, W, Dh)
        vg = v[:, :, idx_c, :].reshape(B, H, S, W, Dh)
        logits = torch.einsum("bhsd,bhswd->bhsw", q, kg) * scale
        logits = torch.where(mask[None, None, :, :], logits, -1e9)
        attn = _softmax(logits, axis=-1)
        o = torch.einsum("bhsw,bhswd->bhsd", attn, vg)
        return (lambda x, *d: x.permute(*d))(o, 0, 2, 1, 3).reshape(B, S, D) @ wo

    def _B_ref(x, w1, w2):
        h = torch.einsum("bsd,df->bsf", x, w1)
        zero = torch.zeros_like(h)
        h = torch.maximum(h, zero)
        return torch.einsum("bsf,fd->bsd", h, w2)

    x = A_x
    g = _sigmoid((x * gate_w).sum(-1, keepdims=True))
    a = _A_ref(x, A_wqkv, A_wo)
    b = _B_ref(x, B_w1, B_w2)
    return g * a + (1 - g) * b
```

```asm
; @launch grid=(256,1,1) block=(256,1,1) lds=163840
.amdgcn_target "amdgcn-amd-amdhsa--gfx950"
.text
.globl gated_mix__sliding_local_dilated__dense_activation_relu__prompt_kernel
.p2align 8
.type gated_mix__sliding_local_dilated__dense_activation_relu__prompt_kernel,@function
gated_mix__sliding_local_dilated__dense_activation_relu__prompt_kernel:
s_cmp_ge_u32 s2, 256
s_cbranch_scc1 L_exit
s_load_dwordx8 s[60:67], s[0:1], 0
s_load_dwordx8 s[68:75], s[0:1], 32
s_load_dwordx4 s[76:79], s[0:1], 64
v_lshrrev_b32 v253, 6, v0
v_and_b32 v254, 63, v0
v_readfirstlane_b32 s20, v253
s_and_b32 s51, s2, 7
s_lshr_b32 s52, s2, 3
s_bfe_u32 s23, s52, 0x10000
s_and_b32 s53, s52, 0
s_lshr_b32 s54, s52, 1
s_lshl_b32 s54, s54, 0
s_or_b32 s53, s53, s54
s_and_b32 s21, s51, 1
s_lshl_b32 s21, s21, 2
s_and_b32 s54, s53, 3
s_add_u32 s21, s21, s54
s_lshr_b32 s22, s51, 1
s_lshl_b32 s22, s22, 2
s_lshr_b32 s54, s53, 2
s_add_u32 s22, s22, s54
s_lshl_b32 s95, s22, 1
s_add_u32 s95, s95, s23
v_lshrrev_b32 v0, 3, v254
v_lshlrev_b32 v0, 12, v0
v_lshrrev_b32 v1, 4, v254
v_and_b32 v2, 7, v254
v_xor_b32 v1, v1, v2
v_lshl_add_u32 v234, v1, 4, v0
v_xor_b32 v1, 4, v1
v_lshl_add_u32 v1, v1, 4, v0
v_add_u32 v235, 31744, v1
s_lshl_b32 s36, s21, 19
s_lshl_b32 s58, s20, 16
s_add_u32 s36, s36, s58
s_add_u32 s37, s36, 262144
s_lshl_b32 s39, s20, 12
s_add_u32 s40, s39, 16384
s_cmp_eq_u32 s23, 0
s_cbranch_scc1 L1_Q
L1_W:
v_lshrrev_b32 v0, 5, v254
v_and_b32 v1, 31, v254
s_and_b32 s51, s20, 1
s_lshl_b32 s51, s51, 3
v_lshlrev_b32 v2, 1, v0
v_or_b32 v2, s51, v2
v_xor_b32 v1, v1, v2
v_mul_u32_u24 v3, 7168, v0
v_mov_b32 v6, 0x7fff0000
v_mov_b32 v4, v1
v_cmp_gt_u32 vcc, 28, v4
v_lshlrev_b32 v4, 4, v4
v_add_u32 v4, 0, v4
v_add_u32 v4, v4, v3
v_cndmask_b32 v236, v6, v4, vcc
v_xor_b32 v4, 4, v1
v_cmp_gt_u32 vcc, 28, v4
v_lshlrev_b32 v4, 4, v4
v_add_u32 v4, 13312, v4
v_add_u32 v4, v4, v3
v_cndmask_b32 v237, v6, v4, vcc
v_mov_b32 v4, v1
v_cmp_gt_u32 vcc, 28, v4
v_lshlrev_b32 v4, 4, v4
v_add_u32 v4, 26624, v4
v_add_u32 v4, v4, v3
v_cndmask_b32 v238, v6, v4, vcc
v_xor_b32 v4, 4, v1
v_cmp_gt_u32 vcc, 28, v4
v_lshlrev_b32 v4, 4, v4
v_add_u32 v4, 39936, v4
v_add_u32 v4, v4, v3
v_cndmask_b32 v239, v6, v4, vcc
s_mov_b32 s38, 65536
s_mul_i32 s43, s20, 4096
s_mul_i32 s41, s20, 57344
s_mul_i32 s51, s22, 448
s_add_u32 s41, s41, s51
s_mov_b32 s53, 32768
s_mov_b32 s54, -65536
s_mov_b32 s45, s53
s_mov_b32 s46, 0
s_waitcnt lgkmcnt(0)
s_mov_b32 s4, s60
s_and_b32 s5, s61, 0xffff
s_mov_b32 s6, 0x400000
s_mov_b32 s7, 0x20000
s_mov_b32 s8, s68
s_and_b32 s9, s69, 0xffff
s_mov_b32 s10, 0x700000
s_mov_b32 s11, 0x20000
s_add_u32 m0, s38, s39
s_nop 0
buffer_load_dwordx4 v234, s[4:7], s36 offen offset:0 lds
buffer_load_dwordx4 v235, s[4:7], s36 offen offset:1024 lds
buffer_load_dwordx4 v234, s[4:7], s36 offen offset:2048 lds
buffer_load_dwordx4 v235, s[4:7], s36 offen offset:3072 lds
s_add_u32 s36, s36, 128
s_add_u32 m0, s38, s40
s_nop 0
buffer_load_dwordx4 v234, s[4:7], s37 offen offset:0 lds
buffer_load_dwordx4 v235, s[4:7], s37 offen offset:1024 lds
buffer_load_dwordx4 v234, s[4:7], s37 offen offset:2048 lds
buffer_load_dwordx4 v235, s[4:7], s37 offen offset:3072 lds
s_add_u32 s37, s37, 128
s_add_u32 s38, s38, 32768
s_cmp_ge_u32 s38, 163840
s_cselect_b32 s38, 65536, s38
s_add_u32 m0, s43, 0
s_nop 0
buffer_load_dwordx4 v236, s[8:11], s41 offen offset:0 lds
buffer_load_dwordx4 v237, s[8:11], s41 offen offset:1024 lds
buffer_load_dwordx4 v238, s[8:11], s41 offen offset:2048 lds
buffer_load_dwordx4 v239, s[8:11], s41 offen offset:3072 lds
s_add_u32 s41, s41, 229376
v_and_b32 v0, 15, v254
v_lshrrev_b32 v1, 4, v254
v_lshrrev_b32 v2, 1, v0
v_xor_b32 v2, v2, v1
v_lshlrev_b32 v2, 4, v2
v_lshl_add_u32 v2, v0, 7, v2
s_lshr_b32 s51, s20, 1
s_lshl_b32 s52, s51, 14
s_add_u32 s52, s52, 65536
s_and_b32 s58, s20, 1
s_lshl_b32 s58, s58, 11
s_add_u32 s52, s52, s58
v_add_u32 v232, s52, v2
v_xor_b32 v233, 64, v232
v_xor_b32 v248, 0x800, v232
v_xor_b32 v249, 0x800, v233
v_bfe_u32 v3, v254, 2, 2
v_and_b32 v4, 3, v254
v_lshlrev_b32 v4, 3, v4
v_lshl_add_u32 v5, v1, 3, v3
s_and_b32 s52, s20, 1
v_lshl_add_u32 v4, v5, 9, v4
v_and_b32 v6, 1, v1
v_lshl_add_u32 v6, v6, 2, v3
s_lshl_b32 s58, s52, 3
v_xor_b32 v8, s58, v6
v_xor_b32 v7, 0, v8
v_lshl_add_u32 v224, v7, 5, v4
v_xor_b32 v7, 1, v8
v_lshl_add_u32 v225, v7, 5, v4
v_xor_b32 v7, 2, v8
v_lshl_add_u32 v226, v7, 5, v4
v_xor_b32 v7, 3, v8
v_lshl_add_u32 v227, v7, 5, v4
v_xor_b32 v7, 4, v8
v_lshl_add_u32 v228, v7, 5, v4
v_xor_b32 v7, 5, v8
v_lshl_add_u32 v229, v7, 5, v4
v_xor_b32 v7, 6, v6
v_lshl_add_u32 v230, v7, 5, v4
v_xor_b32 v7, 7, v6
v_lshl_add_u32 v231, v7, 5, v4
s_add_u32 m0, s38, s39
s_nop 0
buffer_load_dwordx4 v234, s[4:7], s36 offen offset:0 lds
buffer_load_dwordx4 v235, s[4:7], s36 offen offset:1024 lds
buffer_load_dwordx4 v234, s[4:7], s36 offen offset:2048 lds
buffer_load_dwordx4 v235, s[4:7], s36 offen offset:3072 lds
s_add_u32 s36, s36, 128
s_add_u32 m0, s43, 16384
s_nop 0
buffer_load_dwordx4 v236, s[8:11], s41 offen offset:0 lds
buffer_load_dwordx4 v237, s[8:11], s41 offen offset:1024 lds
buffer_load_dwordx4 v238, s[8:11], s41 offen offset:2048 lds
buffer_load_dwordx4 v239, s[8:11], s41 offen offset:3072 lds
s_add_u32 s41, s41, 229376
s_mov_b32 s12, s78
s_and_b32 s13, s79, 0xffff
s_mov_b32 s14, 0x10000000
s_mov_b32 s15, 0x20000
s_mov_b32 s16, s72
s_and_b32 s17, s73, 0xffff
s_mov_b32 s18, 0x800
s_mov_b32 s19, 0x20000
s_mov_b64 s[24:25], s[64:65]
s_mov_b64 s[26:27], s[70:71]
s_mov_b64 s[28:29], s[74:75]
s_mov_b64 s[30:31], s[76:77]
s_mov_b64 s[32:33], s[78:79]
s_lshl_b32 s51, s2, 2
s_add_u32 s51, s51, s20
s_cmp_lt_u32 s51, 832
s_cselect_b64 s[0:1], s[68:69], s[64:65]
s_mov_b32 s92, 2097152
s_cselect_b32 s92, 7340032, s92
s_mov_b32 s93, 196608
s_cselect_b32 s93, 458752, s93
s_mov_b32 s94, 832
s_cselect_b32 s94, 384, s94
s_cselect_b32 s59, 4, 0
s_cmp_lt_u32 s51, 384
s_cselect_b64 s[0:1], s[62:63], s[0:1]
s_cselect_b32 s92, 6291456, s92
s_cselect_b32 s93, 393216, s93
s_cselect_b32 s94, 0, s94
s_sub_u32 s94, s51, s94
s_lshl_b32 s94, s94, 10
s_mul_i32 s59, s59, s93
s_add_u32 s94, s94, s59
s_add_u32 m0, s38, s40
s_nop 0
buffer_load_dwordx4 v234, s[4:7], s37 offen offset:0 lds
buffer_load_dwordx4 v235, s[4:7], s37 offen offset:1024 lds
buffer_load_dwordx4 v234, s[4:7], s37 offen offset:2048 lds
buffer_load_dwordx4 v235, s[4:7], s37 offen offset:3072 lds
s_add_u32 s37, s37, 128
s_add_u32 s38, s38, 32768
s_cmp_ge_u32 s38, 163840
s_cselect_b32 s38, 65536, s38
s_add_u32 m0, s43, 32768
s_nop 0
buffer_load_dwordx4 v236, s[8:11], s41 offen offset:0 lds
buffer_load_dwordx4 v237, s[8:11], s41 offen offset:1024 lds
buffer_load_dwordx4 v238, s[8:11], s41 offen offset:2048 lds
buffer_load_dwordx4 v239, s[8:11], s41 offen offset:3072 lds
s_add_u32 s41, s41, 229376
v_lshlrev_b32 v253, 4, v254
s_waitcnt vmcnt(16) lgkmcnt(0)
s_barrier
ds_read_b64_tr_b16 a[36:37], v224 offset:0
ds_read_b128 a[0:3], v232 offset:0
ds_read_b64_tr_b16 a[38:39], v224 offset:2048
ds_read_b64_tr_b16 a[40:41], v225 offset:0
ds_read_b128 a[4:7], v248 offset:0
ds_read_b64_tr_b16 a[42:43], v225 offset:2048
ds_read_b64_tr_b16 a[44:45], v226 offset:0
ds_read_b128 a[8:11], v232 offset:4096
ds_read_b64_tr_b16 a[46:47], v226 offset:2048
ds_read_b64_tr_b16 a[48:49], v227 offset:0
ds_read_b128 a[12:15], v248 offset:4096
ds_read_b64_tr_b16 a[50:51], v227 offset:2048
ds_read_b64_tr_b16 a[52:53], v228 offset:0
ds_read_b128 a[16:19], v232 offset:8192
ds_read_b64_tr_b16 a[54:55], v228 offset:2048
ds_read_b64_tr_b16 a[56:57], v229 offset:0
ds_read_b128 a[20:23], v248 offset:8192
ds_read_b64_tr_b16 a[58:59], v229 offset:2048
ds_read_b64_tr_b16 a[60:61], v230 offset:0
ds_read_b128 a[24:27], v232 offset:12288
ds_read_b64_tr_b16 a[62:63], v230 offset:2048
ds_read_b64_tr_b16 a[64:65], v231 offset:0
ds_read_b128 a[28:31], v248 offset:12288
ds_read_b64_tr_b16 a[66:67], v231 offset:2048
v_add_u32 v232, s45, v232
v_add_u32 v248, s45, v248
s_waitcnt vmcnt(8) lgkmcnt(0)
s_barrier
v_mfma_f32_16x16x32_bf16 v[0:3], a[36:39], a[0:3], 0
ds_read_b64_tr_b16 a[108:109], v224 offset:16384
v_mfma_f32_16x16x32_bf16 v[4:7], a[40:43], a[0:3], 0
ds_read_b128 a[72:75], v233 offset:0
s_add_u32 m0, s38, s39
v_mfma_f32_16x16x32_bf16 v[8:11], a[44:47], a[0:3], 0
buffer_load_dwordx4 v234, s[4:7], s36 offen offset:0 lds
v_mfma_f32_16x16x32_bf16 v[12:15], a[48:51], a[0:3], 0
ds_read_b64_tr_b16 a[110:111], v224 offset:18432
v_mfma_f32_16x16x32_bf16 v[16:19], a[52:55], a[0:3], 0
buffer_load_dwordx4 v235, s[4:7], s36 offen offset:1024 lds
v_mfma_f32_16x16x32_bf16 v[20:23], a[56:59], a[0:3], 0
ds_read_b64_tr_b16 a[112:113], v225 offset:16384
v_mfma_f32_16x16x32_bf16 v[24:27], a[60:63], a[0:3], 0
v_mfma_f32_16x16x32_bf16 v[28:31], a[64:67], a[0:3], 0
ds_read_b128 a[76:79], v249 offset:0
buffer_load_dwordx4 v234, s[4:7], s36 offen offset:2048 lds
v_mfma_f32_16x16x32_bf16 v[32:35], a[36:39], a[4:7], 0
v_mfma_f32_16x16x32_bf16 v[36:39], a[40:43], a[4:7], 0
ds_read_b64_tr_b16 a[114:115], v225 offset:18432
v_mfma_f32_16x16x32_bf16 v[40:43], a[44:47], a[4:7], 0
buffer_load_dwordx4 v235, s[4:7], s36 offen offset:3072 lds
s_add_u32 s36, s36, 128
v_mfma_f32_16x16x32_bf16 v[44:47], a[48:51], a[4:7], 0
ds_read_b64_tr_b16 a[116:117], v226 offset:16384
s_add_u32 m0, s43, 49152
v_mfma_f32_16x16x32_bf16 v[48:51], a[52:55], a[4:7], 0
ds_read_b128 a[80:83], v233 offset:4096
v_mfma_f32_16x16x32_bf16 v[52:55], a[56:59], a[4:7], 0
v_mfma_f32_16x16x32_bf16 v[56:59], a[36:39], a[8:11], 0
ds_read_b64_tr_b16 a[118:119], v226 offset:18432
buffer_load_dwordx4 v236, s[8:11], s41 offen offset:0 lds
v_mfma_f32_16x16x32_bf16 v[60:63], a[40:43], a[8:11], 0
v_mfma_f32_16x16x32_bf16 v[64:67], a[44:47], a[8:11], 0
ds_read_b64_tr_b16 a[120:121], v227 offset:16384
buffer_load_dwordx4 v237, s[8:11], s41 offen offset:1024 lds
v_mfma_f32_16x16x32_bf16 v[68:71], a[48:51], a[8:11], 0
v_mfma_f32_16x16x32_bf16 v[72:75], a[52:55], a[8:11], 0
ds_read_b128 a[84:87], v249 offset:4096
v_mfma_f32_16x16x32_bf16 v[76:79], a[56:59], a[8:11], 0
buffer_load_dwordx4 v238, s[8:11], s41 offen offset:2048 lds
v_mfma_f32_16x16x32_bf16 v[80:83], a[60:63], a[8:11], 0
ds_read_b64_tr_b16 a[122:123], v227 offset:18432
v_mfma_f32_16x16x32_bf16 v[84:87], a[64:67], a[8:11], 0
v_mfma_f32_16x16x32_bf16 v[88:91], a[36:39], a[12:15], 0
ds_read_b64_tr_b16 a[124:125], v228 offset:16384
buffer_load_dwordx4 v239, s[8:11], s41 offen offset:3072 lds
v_mfma_f32_16x16x32_bf16 v[92:95], a[40:43], a[12:15], 0
ds_read_b128 a[88:91], v233 offset:8192
s_add_u32 s41, s41, 229376
v_mfma_f32_16x16x32_bf16 v[96:99], a[44:47], a[12:15], 0
s_add_u32 m0, s38, s40
v_mfma_f32_16x16x32_bf16 v[100:103], a[48:51], a[12:15], 0
ds_read_b64_tr_b16 a[126:127], v228 offset:18432
v_mfma_f32_16x16x32_bf16 v[104:107], a[52:55], a[12:15], 0
buffer_load_dwordx4 v234, s[4:7], s37 offen offset:0 lds
v_mfma_f32_16x16x32_bf16 v[108:111], a[56:59], a[12:15], 0
ds_read_b64_tr_b16 a[128:129], v229 offset:16384
v_mfma_f32_16x16x32_bf16 v[112:115], a[36:39], a[16:19], 0
buffer_load_dwordx4 v235, s[4:7], s37 offen offset:1024 lds
v_mfma_f32_16x16x32_bf16 v[116:119], a[40:43], a[16:19], 0
ds_read_b128 a[92:95], v249 offset:8192
v_mfma_f32_16x16x32_bf16 v[120:123], a[44:47], a[16:19], 0
v_mfma_f32_16x16x32_bf16 v[124:127], a[48:51], a[16:19], 0
ds_read_b64_tr_b16 a[130:131], v229 offset:18432
buffer_load_dwordx4 v234, s[4:7], s37 offen offset:2048 lds
v_mfma_f32_16x16x32_bf16 v[128:131], a[52:55], a[16:19], 0
v_mfma_f32_16x16x32_bf16 v[132:135], a[56:59], a[16:19], 0
ds_read_b64_tr_b16 a[132:133], v230 offset:16384
v_mfma_f32_16x16x32_bf16 v[136:139], a[60:63], a[16:19], 0
ds_read_b128 a[96:99], v233 offset:12288
buffer_load_dwordx4 v235, s[4:7], s37 offen offset:3072 lds
v_mfma_f32_16x16x32_bf16 v[140:143], a[64:67], a[16:19], 0
s_add_u32 s37, s37, 128
s_add_u32 s38, s38, 32768
v_mfma_f32_16x16x32_bf16 v[144:147], a[36:39], a[20:23], 0
ds_read_b64_tr_b16 a[134:135], v230 offset:18432
s_cmp_ge_u32 s38, 163840
v_mfma_f32_16x16x32_bf16 v[148:151], a[40:43], a[20:23], 0
s_cselect_b32 s38, 65536, s38
s_add_u32 m0, s43, 0
v_mfma_f32_16x16x32_bf16 v[152:155], a[44:47], a[20:23], 0
ds_read_b64_tr_b16 a[136:137], v231 offset:16384
buffer_load_dwordx4 v236, s[8:11], s41 offen offset:0 lds
v_mfma_f32_16x16x32_bf16 v[156:159], a[48:51], a[20:23], 0
v_mfma_f32_16x16x32_bf16 v[160:163], a[52:55], a[20:23], 0
ds_read_b128 a[100:103], v249 offset:12288
buffer_load_dwordx4 v237, s[8:11], s41 offen offset:1024 lds
v_mfma_f32_16x16x32_bf16 v[164:167], a[56:59], a[20:23], 0
v_mfma_f32_16x16x32_bf16 v[168:171], a[36:39], a[24:27], 0
ds_read_b64_tr_b16 a[138:139], v231 offset:18432
v_mfma_f32_16x16x32_bf16 v[172:175], a[40:43], a[24:27], 0
buffer_load_dwordx4 v238, s[8:11], s41 offen offset:2048 lds
v_mfma_f32_16x16x32_bf16 v[176:179], a[44:47], a[24:27], 0
v_add_u32 v233, s45, v233
v_mfma_f32_16x16x32_bf16 v[180:183], a[48:51], a[24:27], 0
v_add_u32 v249, s45, v249
v_mfma_f32_16x16x32_bf16 v[184:187], a[52:55], a[24:27], 0
buffer_load_dwordx4 v239, s[8:11], s41 offen offset:3072 lds
s_add_u32 s41, s41, 229376
v_mfma_f32_16x16x32_bf16 v[188:191], a[56:59], a[24:27], 0
s_lshl_b32 s51, s21, 5
s_add_u32 s51, s51, s95
v_mfma_f32_16x16x32_bf16 v[192:195], a[60:63], a[24:27], 0
s_lshl_b32 s51, s51, 2
s_add_u32 s51, s51, s20
v_mfma_f32_16x16x32_bf16 v[196:199], a[64:67], a[24:27], 0
s_lshl_b32 s3, s51, 7
s_lshl_b32 s57, s51, 12
v_mfma_f32_16x16x32_bf16 v[200:203], a[36:39], a[28:31], 0
s_add_u32 s3, s3, 0x1400000
s_lshl_b32 s51, s2, 2
v_mfma_f32_16x16x32_bf16 v[204:207], a[40:43], a[28:31], 0
s_add_u32 s51, s51, s20
s_lshl_b32 s35, s51, 10
v_mfma_f32_16x16x32_bf16 v[208:211], a[44:47], a[28:31], 0
s_mov_b32 s96, s0
s_and_b32 s97, s1, 0xffff
v_mfma_f32_16x16x32_bf16 v[212:215], a[48:51], a[28:31], 0
s_mov_b32 s98, s92
s_mov_b32 s99, 0x20000
v_mfma_f32_16x16x32_bf16 v[216:219], a[52:55], a[28:31], 0
s_add_u32 s46, s46, s45
v_mfma_f32_16x16x32_bf16 v[220:223], a[56:59], a[28:31], 0
s_cmp_eq_u32 s46, 65536
s_cselect_b32 s45, s54, s53
s_waitcnt vmcnt(16) lgkmcnt(0)
s_barrier
v_mfma_f32_16x16x32_bf16 v[0:3], a[108:111], a[72:75], v[0:3]
ds_read_b64_tr_b16 a[36:37], v224 offset:32768
v_mfma_f32_16x16x32_bf16 v[4:7], a[112:115], a[72:75], v[4:7]
ds_read_b128 a[0:3], v232 offset:0
v_mfma_f32_16x16x32_bf16 v[8:11], a[116:119], a[72:75], v[8:11]
buffer_load_dwordx4 a[144:147], v253, s[4:7], s57 offen offset:0
v_mfma_f32_16x16x32_bf16 v[12:15], a[120:123], a[72:75], v[12:15]
ds_read_b64_tr_b16 a[38:39], v224 offset:34816
v_mfma_f32_16x16x32_bf16 v[16:19], a[124:127], a[72:75], v[16:19]
buffer_load_dwordx4 a[148:151], v253, s[4:7], s57 offen offset:1024
v_mfma_f32_16x16x32_bf16 v[20:23], a[128:131], a[72:75], v[20:23]
ds_read_b64_tr_b16 a[40:41], v225 offset:32768
v_mfma_f32_16x16x32_bf16 v[24:27], a[132:135], a[72:75], v[24:27]
v_mfma_f32_16x16x32_bf16 v[28:31], a[136:139], a[72:75], v[28:31]
ds_read_b128 a[4:7], v248 offset:0
v_mfma_f32_16x16x32_bf16 v[32:35], a[108:111], a[76:79], v[32:35]
buffer_load_dwordx4 a[152:155], v253, s[4:7], s57 offen offset:2048
v_mfma_f32_16x16x32_bf16 v[36:39], a[112:115], a[76:79], v[36:39]
ds_read_b64_tr_b16 a[42:43], v225 offset:34816
v_mfma_f32_16x16x32_bf16 v[40:43], a[116:119], a[76:79], v[40:43]
buffer_load_dwordx4 a[156:159], v253, s[4:7], s57 offen offset:3072
v_mfma_f32_16x16x32_bf16 v[44:47], a[120:123], a[76:79], v[44:47]
ds_read_b64_tr_b16 a[44:45], v226 offset:32768
v_mfma_f32_16x16x32_bf16 v[48:51], a[124:127], a[76:79], v[48:51]
ds_read_b128 a[8:11], v232 offset:4096
v_mfma_f32_16x16x32_bf16 v[52:55], a[128:131], a[76:79], v[52:55]
buffer_load_dwordx4 a[160:163], v253, s[16:19], 0 offen offset:0
v_mfma_f32_16x16x32_bf16 v[56:59], a[108:111], a[80:83], v[56:59]
ds_read_b64_tr_b16 a[46:47], v226 offset:34816
v_mfma_f32_16x16x32_bf16 v[60:63], a[112:115], a[80:83], v[60:63]
v_mfma_f32_16x16x32_bf16 v[64:67], a[116:119], a[80:83], v[64:67]
ds_read_b64_tr_b16 a[48:49], v227 offset:32768
v_mfma_f32_16x16x32_bf16 v[68:71], a[120:123], a[80:83], v[68:71]
buffer_load_dwordx4 a[164:167], v253, s[16:19], 0 offen offset:1024
v_mfma_f32_16x16x32_bf16 v[72:75], a[124:127], a[80:83], v[72:75]
ds_read_b128 a[12:15], v248 offset:4096
v_mfma_f32_16x16x32_bf16 v[76:79], a[128:131], a[80:83], v[76:79]
v_mfma_f32_16x16x32_bf16 v[80:83], a[132:135], a[80:83], v[80:83]
ds_read_b64_tr_b16 a[50:51], v227 offset:34816
v_mfma_f32_16x16x32_bf16 v[84:87], a[136:139], a[80:83], v[84:87]
buffer_load_dwordx4 a[252:255], v253, s[96:99], s94 offen
v_mfma_f32_16x16x32_bf16 v[88:91], a[108:111], a[84:87], v[88:91]
ds_read_b64_tr_b16 a[52:53], v228 offset:32768
v_mfma_f32_16x16x32_bf16 v[92:95], a[112:115], a[84:87], v[92:95]
ds_read_b128 a[16:19], v232 offset:8192
v_mfma_f32_16x16x32_bf16 v[96:99], a[116:119], a[84:87], v[96:99]
s_add_u32 s94, s94, s93
v_mfma_f32_16x16x32_bf16 v[100:103], a[120:123], a[84:87], v[100:103]
ds_read_b64_tr_b16 a[54:55], v228 offset:34816
v_mfma_f32_16x16x32_bf16 v[104:107], a[124:127], a[84:87], v[104:107]
s_add_u32 m0, s38, s39
v_mfma_f32_16x16x32_bf16 v[108:111], a[128:131], a[84:87], v[108:111]
ds_read_b64_tr_b16 a[56:57], v229 offset:32768
v_mfma_f32_16x16x32_bf16 v[112:115], a[108:111], a[88:91], v[112:115]
buffer_load_dwordx4 v234, s[4:7], s36 offen offset:0 lds
v_mfma_f32_16x16x32_bf16 v[116:119], a[112:115], a[88:91], v[116:119]
ds_read_b128 a[20:23], v248 offset:8192
v_mfma_f32_16x16x32_bf16 v[120:123], a[116:119], a[88:91], v[120:123]
buffer_load_dwordx4 v235, s[4:7], s36 offen offset:1024 lds
v_mfma_f32_16x16x32_bf16 v[124:127], a[120:123], a[88:91], v[124:127]
ds_read_b64_tr_b16 a[58:59], v229 offset:34816
v_mfma_f32_16x16x32_bf16 v[128:131], a[124:127], a[88:91], v[128:131]
buffer_load_dwordx4 v234, s[4:7], s36 offen offset:2048 lds
v_mfma_f32_16x16x32_bf16 v[132:135], a[128:131], a[88:91], v[132:135]
ds_read_b64_tr_b16 a[60:61], v230 offset:32768
v_mfma_f32_16x16x32_bf16 v[136:139], a[132:135], a[88:91], v[136:139]
ds_read_b128 a[24:27], v232 offset:12288
v_mfma_f32_16x16x32_bf16 v[140:143], a[136:139], a[88:91], v[140:143]
buffer_load_dwordx4 v235, s[4:7], s36 offen offset:3072 lds
v_mfma_f32_16x16x32_bf16 v[144:147], a[108:111], a[92:95], v[144:147]
ds_read_b64_tr_b16 a[62:63], v230 offset:34816
v_mfma_f32_16x16x32_bf16 v[148:151], a[112:115], a[92:95], v[148:151]
s_add_u32 s36, s36, 128
v_mfma_f32_16x16x32_bf16 v[152:155], a[116:119], a[92:95], v[152:155]
ds_read_b64_tr_b16 a[64:65], v231 offset:32768
v_mfma_f32_16x16x32_bf16 v[156:159], a[120:123], a[92:95], v[156:159]
s_add_u32 m0, s43, 16384
v_mfma_f32_16x16x32_bf16 v[160:163], a[124:127], a[92:95], v[160:163]
ds_read_b128 a[28:31], v248 offset:12288
v_mfma_f32_16x16x32_bf16 v[164:167], a[128:131], a[92:95], v[164:167]
buffer_load_dwordx4 v236, s[8:11], s41 offen offset:0 lds
v_mfma_f32_16x16x32_bf16 v[168:171], a[108:111], a[96:99], v[168:171]
ds_read_b64_tr_b16 a[66:67], v231 offset:34816
v_mfma_f32_16x16x32_bf16 v[172:175], a[112:115], a[96:99], v[172:175]
buffer_load_dwordx4 v237, s[8:11], s41 offen offset:1024 lds
v_mfma_f32_16x16x32_bf16 v[176:179], a[116:119], a[96:99], v[176:179]
buffer_load_dwordx4 v238, s[8:11], s41 offen offset:2048 lds
v_mfma_f32_16x16x32_bf16 v[180:183], a[120:123], a[96:99], v[180:183]
buffer_load_dwordx4 v239, s[8:11], s41 offen offset:3072 lds
v_mfma_f32_16x16x32_bf16 v[184:187], a[124:127], a[96:99], v[184:187]
s_add_u32 s41, s41, 229376
v_mfma_f32_16x16x32_bf16 v[188:191], a[128:131], a[96:99], v[188:191]
v_add_u32 v232, s45, v232
v_mfma_f32_16x16x32_bf16 v[192:195], a[132:135], a[96:99], v[192:195]
v_add_u32 v248, s45, v248
v_mfma_f32_16x16x32_bf16 v[196:199], a[136:139], a[96:99], v[196:199]
v_mfma_f32_16x16x32_bf16 v[200:203], a[108:111], a[100:103], v[200:203]
v_mfma_f32_16x16x32_bf16 v[204:207], a[112:115], a[100:103], v[204:207]
v_mfma_f32_16x16x32_bf16 v[208:211], a[116:119], a[100:103], v[208:211]
v_mfma_f32_16x16x32_bf16 v[212:215], a[120:123], a[100:103], v[212:215]
v_mfma_f32_16x16x32_bf16 v[216:219], a[124:127], a[100:103], v[216:219]
v_mfma_f32_16x16x32_bf16 v[220:223], a[128:131], a[100:103], v[220:223]
s_waitcnt vmcnt(23) lgkmcnt(0)
s_barrier
v_mfma_f32_16x16x32_bf16 v[0:3], a[36:39], a[0:3], v[0:3]
ds_read_b64_tr_b16 a[108:109], v224 offset:49152
v_mfma_f32_16x16x32_bf16 v[4:7], a[40:43], a[0:3], v[4:7]
ds_read_b128 a[72:75], v233 offset:0
s_add_u32 m0, s38, s40
v_mfma_f32_16x16x32_bf16 v[8:11], a[44:47], a[0:3], v[8:11]
buffer_load_dwordx4 v234, s[4:7], s37 offen offset:0 lds
v_mfma_f32_16x16x32_bf16 v[12:15], a[48:51], a[0:3], v[12:15]
ds_read_b64_tr_b16 a[110:111], v224 offset:51200
v_mfma_f32_16x16x32_bf16 v[16:19], a[52:55], a[0:3], v[16:19]
v_mfma_f32_16x16x32_bf16 v[20:23], a[56:59], a[0:3], v[20:23]
ds_read_b64_tr_b16 a[112:113], v225 offset:49152
buffer_load_dwordx4 v235, s[4:7], s37 offen offset:1024 lds
v_mfma_f32_16x16x32_bf16 v[24:27], a[60:63], a[0:3], v[24:27]
v_mfma_f32_16x16x32_bf16 v[28:31], a[64:67], a[0:3], v[28:31]
ds_read_b128 a[76:79], v249 offset:0
v_mfma_f32_16x16x32_bf16 v[32:35], a[36:39], a[4:7], v[32:35]
v_mfma_f32_16x16x32_bf16 v[36:39], a[40:43], a[4:7], v[36:39]
ds_read_b64_tr_b16 a[114:115], v225 offset:51200
buffer_load_dwordx4 v234, s[4:7], s37 offen offset:2048 lds
v_mfma_f32_16x16x32_bf16 v[40:43], a[44:47], a[4:7], v[40:43]
v_mfma_f32_16x16x32_bf16 v[44:47], a[48:51], a[4:7], v[44:47]
ds_read_b64_tr_b16 a[116:117], v226 offset:49152
v_mfma_f32_16x16x32_bf16 v[48:51], a[52:55], a[4:7], v[48:51]
ds_read_b128 a[80:83], v233 offset:4096
v_mfma_f32_16x16x32_bf16 v[52:55], a[56:59], a[4:7], v[52:55]
v_mfma_f32_16x16x32_bf16 v[56:59], a[36:39], a[8:11], v[56:59]
ds_read_b64_tr_b16 a[118:119], v226 offset:51200
buffer_load_dwordx4 v235, s[4:7], s37 offen offset:3072 lds
v_mfma_f32_16x16x32_bf16 v[60:63], a[40:43], a[8:11], v[60:63]
s_add_u32 s37, s37, 128
s_add_u32 s38, s38, 32768
v_mfma_f32_16x16x32_bf16 v[64:67], a[44:47], a[8:11], v[64:67]
ds_read_b64_tr_b16 a[120:121], v227 offset:49152
s_cmp_ge_u32 s38, 163840
v_mfma_f32_16x16x32_bf16 v[68:71], a[48:51], a[8:11], v[68:71]
s_cselect_b32 s38, 65536, s38
s_add_u32 m0, s43, 32768
v_mfma_f32_16x16x32_bf16 v[72:75], a[52:55], a[8:11], v[72:75]
ds_read_b128 a[84:87], v249 offset:4096
v_mfma_f32_16x16x32_bf16 v[76:79], a[56:59], a[8:11], v[76:79]
buffer_load_dwordx4 v236, s[8:11], s41 offen offset:0 lds
v_mfma_f32_16x16x32_bf16 v[80:83], a[60:63], a[8:11], v[80:83]
ds_read_b64_tr_b16 a[122:123], v227 offset:51200
v_mfma_f32_16x16x32_bf16 v[84:87], a[64:67], a[8:11], v[84:87]
v_mfma_f32_16x16x32_bf16 v[88:91], a[36:39], a[12:15], v[88:91]
ds_read_b64_tr_b16 a[124:125], v228 offset:49152
buffer_load_dwordx4 v237, s[8:11], s41 offen offset:1024 lds
v_mfma_f32_16x16x32_bf16 v[92:95], a[40:43], a[12:15], v[92:95]
ds_read_b128 a[88:91], v233 offset:8192
v_mfma_f32_16x16x32_bf16 v[96:99], a[44:47], a[12:15], v[96:99]
v_mfma_f32_16x16x32_bf16 v[100:103], a[48:51], a[12:15], v[100:103]
ds_read_b64_tr_b16 a[126:127], v228 offset:51200
v_mfma_f32_16x16x32_bf16 v[104:107], a[52:55], a[12:15], v[104:107]
v_mfma_f32_16x16x32_bf16 v[108:111], a[56:59], a[12:15], v[108:111]
ds_read_b64_tr_b16 a[128:129], v229 offset:49152
buffer_load_dwordx4 v238, s[8:11], s41 offen offset:2048 lds
v_mfma_f32_16x16x32_bf16 v[112:115], a[36:39], a[16:19], v[112:115]
v_mfma_f32_16x16x32_bf16 v[116:119], a[40:43], a[16:19], v[116:119]
ds_read_b128 a[92:95], v249 offset:8192
v_mfma_f32_16x16x32_bf16 v[120:123], a[44:47], a[16:19], v[120:123]
v_mfma_f32_16x16x32_bf16 v[124:127], a[48:51], a[16:19], v[124:127]
ds_read_b64_tr_b16 a[130:131], v229 offset:51200
buffer_load_dwordx4 v239, s[8:11], s41 offen offset:3072 lds
v_mfma_f32_16x16x32_bf16 v[128:131], a[52:55], a[16:19], v[128:131]
s_add_u32 s41, s41, 229376
s_getpc_b64 s[16:17]
L1_pc_W:
v_mfma_f32_16x16x32_bf16 v[132:135], a[56:59], a[16:19], v[132:135]
ds_read_b64_tr_b16 a[132:133], v230 offset:49152
s_add_u32 s16, s16, gated_mix__sliding_local_dilated__dense_activation_relu__prompt_kernel-L1_pc_W
v_mfma_f32_16x16x32_bf16 v[136:139], a[60:63], a[16:19], v[136:139]
ds_read_b128 a[96:99], v233 offset:12288
s_addc_u32 s17, s17, -1
v_mfma_f32_16x16x32_bf16 v[140:143], a[64:67], a[16:19], v[140:143]
s_and_b32 s17, s17, 0xffff
s_mov_b32 s18, code_end-gated_mix__sliding_local_dilated__dense_activation_relu__prompt_kernel
v_mfma_f32_16x16x32_bf16 v[144:147], a[36:39], a[20:23], v[144:147]
ds_read_b64_tr_b16 a[134:135], v230 offset:51200
s_bfe_u32 s51, s2, 0x20003
v_mfma_f32_16x16x32_bf16 v[148:151], a[40:43], a[20:23], v[148:151]
s_lshl_b32 s51, s51, 2
s_add_u32 s51, s51, s20
v_mfma_f32_16x16x32_bf16 v[152:155], a[44:47], a[20:23], v[152:155]
ds_read_b64_tr_b16 a[136:137], v231 offset:49152
s_mul_i32 s51, s51, 3072
v_mfma_f32_16x16x32_bf16 v[156:159], a[48:51], a[20:23], v[156:159]
buffer_load_dwordx4 a[252:255], v253, s[16:19], s51 offen offset:0
v_mfma_f32_16x16x32_bf16 v[160:163], a[52:55], a[20:23], v[160:163]
ds_read_b128 a[100:103], v249 offset:12288
buffer_load_dwordx4 a[252:255], v253, s[16:19], s51 offen offset:1024
v_mfma_f32_16x16x32_bf16 v[164:167], a[56:59], a[20:23], v[164:167]
v_mfma_f32_16x16x32_bf16 v[168:171], a[36:39], a[24:27], v[168:171]
ds_read_b64_tr_b16 a[138:139], v231 offset:51200
v_mfma_f32_16x16x32_bf16 v[172:175], a[40:43], a[24:27], v[172:175]
v_add_u32 v233, s45, v233
v_mfma_f32_16x16x32_bf16 v[176:179], a[44:47], a[24:27], v[176:179]
buffer_load_dwordx4 a[252:255], v253, s[16:19], s51 offen offset:2048
s_mov_b32 s16, s30
v_mfma_f32_16x16x32_bf16 v[180:183], a[48:51], a[24:27], v[180:183]
s_and_b32 s17, s31, 0xffff
s_mov_b32 s18, 0x8
v_mfma_f32_16x16x32_bf16 v[184:187], a[52:55], a[24:27], v[184:187]
s_mov_b32 s19, 0x20000
v_mfma_f32_16x16x32_bf16 v[188:191], a[56:59], a[24:27], v[188:191]
v_add_u32 v249, s45, v249
v_mfma_f32_16x16x32_bf16 v[192:195], a[60:63], a[24:27], v[192:195]
s_add_u32 s46, s46, s45
v_mfma_f32_16x16x32_bf16 v[196:199], a[64:67], a[24:27], v[196:199]
s_cmp_eq_u32 s46, 65536
v_mfma_f32_16x16x32_bf16 v[200:203], a[36:39], a[28:31], v[200:203]
s_cselect_b32 s45, s54, s53
v_mfma_f32_16x16x32_bf16 v[204:207], a[40:43], a[28:31], v[204:207]
v_mfma_f32_16x16x32_bf16 v[208:211], a[44:47], a[28:31], v[208:211]
v_mfma_f32_16x16x32_bf16 v[212:215], a[48:51], a[28:31], v[212:215]
v_mfma_f32_16x16x32_bf16 v[216:219], a[52:55], a[28:31], v[216:219]
v_mfma_f32_16x16x32_bf16 v[220:223], a[56:59], a[28:31], v[220:223]
s_waitcnt vmcnt(20) lgkmcnt(0)
s_barrier
v_mfma_f32_16x16x32_bf16 v[0:3], a[108:111], a[72:75], v[0:3]
ds_read_b64_tr_b16 a[36:37], v224 offset:0
v_mov_b32 v240, 0x3f803f80
v_mfma_f32_16x16x32_bf16 v[4:7], a[112:115], a[72:75], v[4:7]
ds_read_b128 a[0:3], v232 offset:0
v_mov_b32 v241, 0
v_mfma_f32_16x16x32_bf16 v[8:11], a[116:119], a[72:75], v[8:11]
buffer_load_dwordx4 a[252:255], v253, s[96:99], s94 offen
v_mov_b32 v242, 0
v_mfma_f32_16x16x32_bf16 v[12:15], a[120:123], a[72:75], v[12:15]
ds_read_b64_tr_b16 a[38:39], v224 offset:2048
v_mov_b32 v252, 0xffff0000
v_mfma_f32_16x16x32_bf16 v[16:19], a[124:127], a[72:75], v[16:19]
s_add_u32 s94, s94, s93
v_accvgpr_read_b32 v243, a160
v_mfma_f32_16x16x32_bf16 v[20:23], a[128:131], a[72:75], v[20:23]
ds_read_b64_tr_b16 a[40:41], v225 offset:0
v_accvgpr_read_b32 v244, a144
v_mfma_f32_16x16x32_bf16 v[24:27], a[132:135], a[72:75], v[24:27]
s_add_u32 m0, s38, s39
v_accvgpr_read_b32 v251, a152
v_mfma_f32_16x16x32_bf16 v[28:31], a[136:139], a[72:75], v[28:31]
ds_read_b128 a[4:7], v248 offset:0
v_lshlrev_b32 v245, 16, v243
v_mfma_f32_16x16x32_bf16 v[32:35], a[108:111], a[76:79], v[32:35]
buffer_load_dwordx4 v234, s[4:7], s36 offen offset:0 lds
v_and_b32 v246, v252, v243
v_mfma_f32_16x16x32_bf16 v[36:39], a[112:115], a[76:79], v[36:39]
ds_read_b64_tr_b16 a[42:43], v225 offset:2048
v_lshlrev_b32 v247, 16, v244
v_mfma_f32_16x16x32_bf16 v[40:43], a[116:119], a[76:79], v[40:43]
buffer_load_dwordx4 v235, s[4:7], s36 offen offset:1024 lds
v_and_b32 v244, v252, v244
v_mfma_f32_16x16x32_bf16 v[44:47], a[120:123], a[76:79], v[44:47]
ds_read_b64_tr_b16 a[44:45], v226 offset:0
v_lshlrev_b32 v250, 16, v251
v_mfma_f32_16x16x32_bf16 v[48:51], a[124:127], a[76:79], v[48:51]
ds_read_b128 a[8:11], v232 offset:4096
v_and_b32 v251, v252, v251
v_mfma_f32_16x16x32_bf16 v[52:55], a[128:131], a[76:79], v[52:55]
v_mul_f32 v247, v247, v245
v_mul_f32 v244, v244, v246
v_mfma_f32_16x16x32_bf16 v[56:59], a[108:111], a[80:83], v[56:59]
ds_read_b64_tr_b16 a[46:47], v226 offset:2048
v_mul_f32 v250, v250, v245
v_mfma_f32_16x16x32_bf16 v[60:63], a[112:115], a[80:83], v[60:63]
buffer_load_dwordx4 v234, s[4:7], s36 offen offset:2048 lds
v_mul_f32 v251, v251, v246
v_mfma_f32_16x16x32_bf16 v[64:67], a[116:119], a[80:83], v[64:67]
ds_read_b64_tr_b16 a[48:49], v227 offset:0
v_cvt_pk_bf16_f32 v247, v247, v244
v_mfma_f32_16x16x32_bf16 v[68:71], a[120:123], a[80:83], v[68:71]
v_cvt_pk_bf16_f32 v250, v250, v251
v_dot2_f32_bf16 v241, v247, v240, v241
v_mfma_f32_16x16x32_bf16 v[72:75], a[124:127], a[80:83], v[72:75]
ds_read_b128 a[12:15], v248 offset:4096
v_dot2_f32_bf16 v242, v250, v240, v242
v_mfma_f32_16x16x32_bf16 v[76:79], a[128:131], a[80:83], v[76:79]
v_accvgpr_read_b32 v243, a161
v_accvgpr_read_b32 v244, a145
v_mfma_f32_16x16x32_bf16 v[80:83], a[132:135], a[80:83], v[80:83]
ds_read_b64_tr_b16 a[50:51], v227 offset:2048
v_accvgpr_read_b32 v251, a153
v_mfma_f32_16x16x32_bf16 v[84:87], a[136:139], a[80:83], v[84:87]
buffer_load_dwordx4 v235, s[4:7], s36 offen offset:3072 lds
v_lshlrev_b32 v245, 16, v243
v_mfma_f32_16x16x32_bf16 v[88:91], a[108:111], a[84:87], v[88:91]
ds_read_b64_tr_b16 a[52:53], v228 offset:0
v_and_b32 v246, v252, v243
v_mfma_f32_16x16x32_bf16 v[92:95], a[112:115], a[84:87], v[92:95]
ds_read_b128 a[16:19], v232 offset:8192
v_lshlrev_b32 v247, 16, v244
v_mfma_f32_16x16x32_bf16 v[96:99], a[116:119], a[84:87], v[96:99]
s_add_u32 s36, s36, 128
v_and_b32 v244, v252, v244
v_mfma_f32_16x16x32_bf16 v[100:103], a[120:123], a[84:87], v[100:103]
ds_read_b64_tr_b16 a[54:55], v228 offset:2048
v_lshlrev_b32 v250, 16, v251
v_mfma_f32_16x16x32_bf16 v[104:107], a[124:127], a[84:87], v[104:107]
s_add_u32 m0, s43, 49152
v_and_b32 v251, v252, v251
v_mfma_f32_16x16x32_bf16 v[108:111], a[128:131], a[84:87], v[108:111]
ds_read_b64_tr_b16 a[56:57], v229 offset:0
v_mul_f32 v247, v247, v245
v_mfma_f32_16x16x32_bf16 v[112:115], a[108:111], a[88:91], v[112:115]
buffer_load_dwordx4 v236, s[8:11], s41 offen offset:0 lds
v_mul_f32 v244, v244, v246
v_mfma_f32_16x16x32_bf16 v[116:119], a[112:115], a[88:91], v[116:119]
ds_read_b128 a[20:23], v248 offset:8192
v_mul_f32 v250, v250, v245
v_mfma_f32_16x16x32_bf16 v[120:123], a[116:119], a[88:91], v[120:123]
buffer_load_dwordx4 v237, s[8:11], s41 offen offset:1024 lds
v_mul_f32 v251, v251, v246
v_mfma_f32_16x16x32_bf16 v[124:127], a[120:123], a[88:91], v[124:127]
ds_read_b64_tr_b16 a[58:59], v229 offset:2048
v_cvt_pk_bf16_f32 v247, v247, v244
v_mfma_f32_16x16x32_bf16 v[128:131], a[124:127], a[88:91], v[128:131]
v_cvt_pk_bf16_f32 v250, v250, v251
v_dot2_f32_bf16 v241, v247, v240, v241
v_mfma_f32_16x16x32_bf16 v[132:135], a[128:131], a[88:91], v[132:135]
ds_read_b64_tr_b16 a[60:61], v230 offset:0
v_dot2_f32_bf16 v242, v250, v240, v242
v_mfma_f32_16x16x32_bf16 v[136:139], a[132:135], a[88:91], v[136:139]
ds_read_b128 a[24:27], v232 offset:12288
v_accvgpr_read_b32 v243, a162
v_mfma_f32_16x16x32_bf16 v[140:143], a[136:139], a[88:91], v[140:143]
buffer_load_dwordx4 v238, s[8:11], s41 offen offset:2048 lds
v_accvgpr_read_b32 v244, a146
v_mfma_f32_16x16x32_bf16 v[144:147], a[108:111], a[92:95], v[144:147]
ds_read_b64_tr_b16 a[62:63], v230 offset:2048
v_accvgpr_read_b32 v251, a154
v_mfma_f32_16x16x32_bf16 v[148:151], a[112:115], a[92:95], v[148:151]
v_lshlrev_b32 v245, 16, v243
v_and_b32 v246, v252, v243
v_mfma_f32_16x16x32_bf16 v[152:155], a[116:119], a[92:95], v[152:155]
ds_read_b64_tr_b16 a[64:65], v231 offset:0
v_lshlrev_b32 v247, 16, v244
v_mfma_f32_16x16x32_bf16 v[156:159], a[120:123], a[92:95], v[156:159]
buffer_load_dwordx4 v239, s[8:11], s41 offen offset:3072 lds
v_and_b32 v244, v252, v244
v_mfma_f32_16x16x32_bf16 v[160:163], a[124:127], a[92:95], v[160:163]
ds_read_b128 a[28:31], v248 offset:12288
v_lshlrev_b32 v250, 16, v251
v_mfma_f32_16x16x32_bf16 v[164:167], a[128:131], a[92:95], v[164:167]
s_add_u32 s41, s41, 229376
v_and_b32 v251, v252, v251
v_mfma_f32_16x16x32_bf16 v[168:171], a[108:111], a[96:99], v[168:171]
ds_read_b64_tr_b16 a[66:67], v231 offset:2048
v_mul_f32 v247, v247, v245
v_mfma_f32_16x16x32_bf16 v[172:175], a[112:115], a[96:99], v[172:175]
v_add_u32 v232, s45, v232
v_mul_f32 v244, v244, v246
v_mfma_f32_16x16x32_bf16 v[176:179], a[116:119], a[96:99], v[176:179]
buffer_load_dwordx2 a[168:169], v253, s[16:19], 0 offen sc1
v_mul_f32 v250, v250, v245
v_mfma_f32_16x16x32_bf16 v[180:183], a[120:123], a[96:99], v[180:183]
v_add_u32 v248, s45, v248
v_mul_f32 v251, v251, v246
v_mfma_f32_16x16x32_bf16 v[184:187], a[124:127], a[96:99], v[184:187]
v_cvt_pk_bf16_f32 v247, v247, v244
v_cvt_pk_bf16_f32 v250, v250, v251
v_mfma_f32_16x16x32_bf16 v[188:191], a[128:131], a[96:99], v[188:191]
v_dot2_f32_bf16 v241, v247, v240, v241
v_dot2_f32_bf16 v242, v250, v240, v242
v_mfma_f32_16x16x32_bf16 v[192:195], a[132:135], a[96:99], v[192:195]
v_accvgpr_read_b32 v243, a163
v_accvgpr_read_b32 v244, a147
v_mfma_f32_16x16x32_bf16 v[196:199], a[136:139], a[96:99], v[196:199]
v_accvgpr_read_b32 v251, a155
v_lshlrev_b32 v245, 16, v243
v_mfma_f32_16x16x32_bf16 v[200:203], a[108:111], a[100:103], v[200:203]
v_and_b32 v246, v252, v243
v_lshlrev_b32 v247, 16, v244
v_mfma_f32_16x16x32_bf16 v[204:207], a[112:115], a[100:103], v[204:207]
v_and_b32 v244, v252, v244
v_lshlrev_b32 v250, 16, v251
v_mfma_f32_16x16x32_bf16 v[208:211], a[116:119], a[100:103], v[208:211]
v_and_b32 v251, v252, v251
v_mul_f32 v247, v247, v245
v_mfma_f32_16x16x32_bf16 v[212:215], a[120:123], a[100:103], v[212:215]
v_mul_f32 v244, v244, v246
v_mul_f32 v250, v250, v245
v_mfma_f32_16x16x32_bf16 v[216:219], a[124:127], a[100:103], v[216:219]
v_mul_f32 v251, v251, v246
v_cvt_pk_bf16_f32 v247, v247, v244
v_mfma_f32_16x16x32_bf16 v[220:223], a[128:131], a[100:103], v[220:223]
v_cvt_pk_bf16_f32 v250, v250, v251
v_dot2_f32_bf16 v241, v247, v240, v241
v_dot2_f32_bf16 v242, v250, v240, v242
v_accvgpr_read_b32 v243, a164
v_accvgpr_read_b32 v244, a148
v_accvgpr_read_b32 v251, a156
v_lshlrev_b32 v245, 16, v243
v_and_b32 v246, v252, v243
v_lshlrev_b32 v247, 16, v244
v_and_b32 v244, v252, v244
v_lshlrev_b32 v250, 16, v251
v_and_b32 v251, v252, v251
v_mul_f32 v247, v247, v245
v_mul_f32 v244, v244, v246
v_mul_f32 v250, v250, v245
v_mul_f32 v251, v251, v246
v_cvt_pk_bf16_f32 v247, v247, v244
v_cvt_pk_bf16_f32 v250, v250, v251
v_dot2_f32_bf16 v241, v247, v240, v241
v_dot2_f32_bf16 v242, v250, v240, v242
v_accvgpr_read_b32 v243, a165
v_accvgpr_read_b32 v244, a149
v_accvgpr_read_b32 v251, a157
v_lshlrev_b32 v245, 16, v243
v_and_b32 v246, v252, v243
v_lshlrev_b32 v247, 16, v244
v_and_b32 v244, v252, v244
v_lshlrev_b32 v250, 16, v251
v_and_b32 v251, v252, v251
v_mul_f32 v247, v247, v245
v_mul_f32 v244, v244, v246
v_mul_f32 v250, v250, v245
v_mul_f32 v251, v251, v246
v_cvt_pk_bf16_f32 v247, v247, v244
v_cvt_pk_bf16_f32 v250, v250, v251
v_dot2_f32_bf16 v241, v247, v240, v241
v_dot2_f32_bf16 v242, v250, v240, v242
v_accvgpr_read_b32 v243, a166
v_accvgpr_read_b32 v244, a150
v_accvgpr_read_b32 v251, a158
v_lshlrev_b32 v245, 16, v243
v_and_b32 v246, v252, v243
v_lshlrev_b32 v247, 16, v244
v_and_b32 v244, v252, v244
v_lshlrev_b32 v250, 16, v251
v_and_b32 v251, v252, v251
v_mul_f32 v247, v247, v245
v_mul_f32 v244, v244, v246
v_mul_f32 v250, v250, v245
v_mul_f32 v251, v251, v246
v_cvt_pk_bf16_f32 v247, v247, v244
v_cvt_pk_bf16_f32 v250, v250, v251
v_dot2_f32_bf16 v241, v247, v240, v241
v_dot2_f32_bf16 v242, v250, v240, v242
v_accvgpr_read_b32 v243, a167
v_accvgpr_read_b32 v244, a151
v_accvgpr_read_b32 v251, a159
v_lshlrev_b32 v245, 16, v243
v_and_b32 v246, v252, v243
v_lshlrev_b32 v247, 16, v244
v_and_b32 v244, v252, v244
v_lshlrev_b32 v250, 16, v251
v_and_b32 v251, v252, v251
v_mul_f32 v247, v247, v245
v_mul_f32 v244, v244, v246
v_mul_f32 v250, v250, v245
v_mul_f32 v251, v251, v246
v_cvt_pk_bf16_f32 v247, v247, v244
v_cvt_pk_bf16_f32 v250, v250, v251
v_dot2_f32_bf16 v241, v247, v240, v241
v_dot2_f32_bf16 v242, v250, v240, v242
s_nop 1
v_add_f32_dpp v241, v241, v241 row_ror:8 row_mask:0xf bank_mask:0xf
v_add_f32_dpp v242, v242, v242 row_ror:8 row_mask:0xf bank_mask:0xf
s_nop 0
v_add_f32_dpp v241, v241, v241 row_ror:4 row_mask:0xf bank_mask:0xf
v_add_f32_dpp v242, v242, v242 row_ror:4 row_mask:0xf bank_mask:0xf
s_nop 0
v_add_f32_dpp v241, v241, v241 row_ror:2 row_mask:0xf bank_mask:0xf
v_add_f32_dpp v242, v242, v242 row_ror:2 row_mask:0xf bank_mask:0xf
s_nop 0
v_add_f32_dpp v241, v241, v241 row_ror:1 row_mask:0xf bank_mask:0xf
v_add_f32_dpp v242, v242, v242 row_ror:1 row_mask:0xf bank_mask:0xf
v_mov_b32 v243, v241
v_mov_b32 v244, v242
s_nop 0
v_permlane32_swap_b32 v241, v243
v_permlane32_swap_b32 v242, v244
v_add_f32 v241, v241, v243
v_add_f32 v242, v242, v244
v_mov_b32 v243, v241
v_mov_b32 v244, v242
s_nop 0
v_permlane16_swap_b32 v241, v243
v_permlane16_swap_b32 v242, v244
v_add_f32 v241, v241, v243
v_add_f32 v242, v242, v244
v_and_b32 v243, 1, v254
v_cmp_eq_u32 vcc, 1, v243
v_lshlrev_b32 v243, 2, v254
v_and_b32 v245, 2, v254
v_cndmask_b32 v241, v241, v242, vcc
v_cvt_pk_bf16_f32 v241, v241, v241
v_and_b32 v241, v252, v241
v_mul_f32 v241, 0xbfb8aa3b, v241
v_exp_f32 v241, v241
v_cmp_gt_u32 vcc, 32, v254
v_add_f32 v241, 1.0, v241
v_rcp_f32 v241, v241
v_mov_b32 v244, 0x7fff0000
v_cvt_pk_bf16_f32 v241, v241, v241
v_and_b32 v241, v252, v241
v_sub_f32 v242, 1.0, v241
v_cndmask_b32 v243, v244, v243, vcc
v_cmp_eq_u32 vcc, 2, v245
v_cvt_pk_bf16_f32 v242, v242, v242
v_and_b32 v242, v252, v242
v_cndmask_b32 v241, v241, v242, vcc
s_mov_b32 s34, 6
.p2align 6
L1_loop_W:
s_waitcnt vmcnt(17) lgkmcnt(0)
s_barrier
v_mfma_f32_16x16x32_bf16 v[0:3], a[36:39], a[0:3], v[0:3]
ds_read_b64_tr_b16 a[108:109], v224 offset:16384
v_mfma_f32_16x16x32_bf16 v[4:7], a[40:43], a[0:3], v[4:7]
ds_read_b128 a[72:75], v233 offset:0
v_mfma_f32_16x16x32_bf16 v[8:11], a[44:47], a[0:3], v[8:11]
s_add_u32 m0, s38, s40
v_mfma_f32_16x16x32_bf16 v[12:15], a[48:51], a[0:3], v[12:15]
ds_read_b64_tr_b16 a[110:111], v224 offset:18432
v_mfma_f32_16x16x32_bf16 v[16:19], a[52:55], a[0:3], v[16:19]
buffer_load_dwordx4 v234, s[4:7], s37 offen offset:0 lds
v_mfma_f32_16x16x32_bf16 v[20:23], a[56:59], a[0:3], v[20:23]
ds_read_b64_tr_b16 a[112:113], v225 offset:16384
v_mfma_f32_16x16x32_bf16 v[24:27], a[60:63], a[0:3], v[24:27]
v_mfma_f32_16x16x32_bf16 v[28:31], a[64:67], a[0:3], v[28:31]
ds_read_b128 a[76:79], v249 offset:0
v_mfma_f32_16x16x32_bf16 v[32:35], a[36:39], a[4:7], v[32:35]
buffer_load_dwordx4 v235, s[4:7], s37 offen offset:1024 lds
v_mfma_f32_16x16x32_bf16 v[36:39], a[40:43], a[4:7], v[36:39]
ds_read_b64_tr_b16 a[114:115], v225 offset:18432
v_mfma_f32_16x16x32_bf16 v[40:43], a[44:47], a[4:7], v[40:43]
v_mfma_f32_16x16x32_bf16 v[44:47], a[48:51], a[4:7], v[44:47]
ds_read_b64_tr_b16 a[116:117], v226 offset:16384
v_mfma_f32_16x16x32_bf16 v[48:51], a[52:55], a[4:7], v[48:51]
ds_read_b128 a[80:83], v233 offset:4096
v_mfma_f32_16x16x32_bf16 v[52:55], a[56:59], a[4:7], v[52:55]
buffer_load_dwordx4 v234, s[4:7], s37 offen offset:2048 lds
v_mfma_f32_16x16x32_bf16 v[56:59], a[36:39], a[8:11], v[56:59]
ds_read_b64_tr_b16 a[118:119], v226 offset:18432
v_mfma_f32_16x16x32_bf16 v[60:63], a[40:43], a[8:11], v[60:63]
v_mfma_f32_16x16x32_bf16 v[64:67], a[44:47], a[8:11], v[64:67]
ds_read_b64_tr_b16 a[120:121], v227 offset:16384
v_mfma_f32_16x16x32_bf16 v[68:71], a[48:51], a[8:11], v[68:71]
v_mfma_f32_16x16x32_bf16 v[72:75], a[52:55], a[8:11], v[72:75]
ds_read_b128 a[84:87], v249 offset:4096
v_mfma_f32_16x16x32_bf16 v[76:79], a[56:59], a[8:11], v[76:79]
buffer_load_dwordx4 v235, s[4:7], s37 offen offset:3072 lds
v_mfma_f32_16x16x32_bf16 v[80:83], a[60:63], a[8:11], v[80:83]
ds_read_b64_tr_b16 a[122:123], v227 offset:18432
v_mfma_f32_16x16x32_bf16 v[84:87], a[64:67], a[8:11], v[84:87]
s_add_u32 s37, s37, 128
v_mfma_f32_16x16x32_bf16 v[88:91], a[36:39], a[12:15], v[88:91]
ds_read_b64_tr_b16 a[124:125], v228 offset:16384
v_mfma_f32_16x16x32_bf16 v[92:95], a[40:43], a[12:15], v[92:95]
ds_read_b128 a[88:91], v233 offset:8192
v_mfma_f32_16x16x32_bf16 v[96:99], a[44:47], a[12:15], v[96:99]
s_add_u32 s38, s38, 32768
v_mfma_f32_16x16x32_bf16 v[100:103], a[48:51], a[12:15], v[100:103]
ds_read_b64_tr_b16 a[126:127], v228 offset:18432
v_mfma_f32_16x16x32_bf16 v[104:107], a[52:55], a[12:15], v[104:107]
s_cmp_ge_u32 s38, 163840
v_mfma_f32_16x16x32_bf16 v[108:111], a[56:59], a[12:15], v[108:111]
ds_read_b64_tr_b16 a[128:129], v229 offset:16384
v_mfma_f32_16x16x32_bf16 v[112:115], a[36:39], a[16:19], v[112:115]
s_cselect_b32 s38, 65536, s38
v_mfma_f32_16x16x32_bf16 v[116:119], a[40:43], a[16:19], v[116:119]
ds_read_b128 a[92:95], v249 offset:8192
v_mfma_f32_16x16x32_bf16 v[120:123], a[44:47], a[16:19], v[120:123]
s_add_u32 m0, s43, 0
v_mfma_f32_16x16x32_bf16 v[124:127], a[48:51], a[16:19], v[124:127]
ds_read_b64_tr_b16 a[130:131], v229 offset:18432
v_mfma_f32_16x16x32_bf16 v[128:131], a[52:55], a[16:19], v[128:131]
buffer_load_dwordx4 v236, s[8:11], s41 offen offset:0 lds
v_mfma_f32_16x16x32_bf16 v[132:135], a[56:59], a[16:19], v[132:135]
ds_read_b64_tr_b16 a[132:133], v230 offset:16384
v_mfma_f32_16x16x32_bf16 v[136:139], a[60:63], a[16:19], v[136:139]
ds_read_b128 a[96:99], v233 offset:12288
v_mfma_f32_16x16x32_bf16 v[140:143], a[64:67], a[16:19], v[140:143]
buffer_load_dwordx4 v237, s[8:11], s41 offen offset:1024 lds
v_mfma_f32_16x16x32_bf16 v[144:147], a[36:39], a[20:23], v[144:147]
ds_read_b64_tr_b16 a[134:135], v230 offset:18432
v_mfma_f32_16x16x32_bf16 v[148:151], a[40:43], a[20:23], v[148:151]
buffer_load_dwordx4 v238, s[8:11], s41 offen offset:2048 lds
v_mfma_f32_16x16x32_bf16 v[152:155], a[44:47], a[20:23], v[152:155]
ds_read_b64_tr_b16 a[136:137], v231 offset:16384
v_mfma_f32_16x16x32_bf16 v[156:159], a[48:51], a[20:23], v[156:159]
v_mfma_f32_16x16x32_bf16 v[160:163], a[52:55], a[20:23], v[160:163]
ds_read_b128 a[100:103], v249 offset:12288
v_mfma_f32_16x16x32_bf16 v[164:167], a[56:59], a[20:23], v[164:167]
v_mfma_f32_16x16x32_bf16 v[168:171], a[36:39], a[24:27], v[168:171]
ds_read_b64_tr_b16 a[138:139], v231 offset:18432
v_mfma_f32_16x16x32_bf16 v[172:175], a[40:43], a[24:27], v[172:175]
buffer_load_dwordx4 v239, s[8:11], s41 offen offset:3072 lds
v_mfma_f32_16x16x32_bf16 v[176:179], a[44:47], a[24:27], v[176:179]
s_add_u32 s41, s41, 229376
v_mfma_f32_16x16x32_bf16 v[180:183], a[48:51], a[24:27], v[180:183]
v_add_u32 v233, s45, v233
v_mfma_f32_16x16x32_bf16 v[184:187], a[52:55], a[24:27], v[184:187]
v_add_u32 v249, s45, v249
v_mfma_f32_16x16x32_bf16 v[188:191], a[56:59], a[24:27], v[188:191]
s_add_u32 s46, s46, s45
v_mfma_f32_16x16x32_bf16 v[192:195], a[60:63], a[24:27], v[192:195]
s_cmp_eq_u32 s46, 65536
v_mfma_f32_16x16x32_bf16 v[196:199], a[64:67], a[24:27], v[196:199]
s_cselect_b32 s45, s54, s53
v_mfma_f32_16x16x32_bf16 v[200:203], a[36:39], a[28:31], v[200:203]
v_mfma_f32_16x16x32_bf16 v[204:207], a[40:43], a[28:31], v[204:207]
v_mfma_f32_16x16x32_bf16 v[208:211], a[44:47], a[28:31], v[208:211]
v_mfma_f32_16x16x32_bf16 v[212:215], a[48:51], a[28:31], v[212:215]
v_mfma_f32_16x16x32_bf16 v[216:219], a[52:55], a[28:31], v[216:219]
v_mfma_f32_16x16x32_bf16 v[220:223], a[56:59], a[28:31], v[220:223]
s_waitcnt vmcnt(17) lgkmcnt(0)
s_barrier
v_mfma_f32_16x16x32_bf16 v[0:3], a[108:111], a[72:75], v[0:3]
ds_read_b64_tr_b16 a[36:37], v224 offset:32768
v_mfma_f32_16x16x32_bf16 v[4:7], a[112:115], a[72:75], v[4:7]
ds_read_b128 a[0:3], v232 offset:0
v_mfma_f32_16x16x32_bf16 v[8:11], a[116:119], a[72:75], v[8:11]
buffer_load_dwordx4 a[252:255], v253, s[96:99], s94 offen
v_mfma_f32_16x16x32_bf16 v[12:15], a[120:123], a[72:75], v[12:15]
ds_read_b64_tr_b16 a[38:39], v224 offset:34816
v_mfma_f32_16x16x32_bf16 v[16:19], a[124:127], a[72:75], v[16:19]
s_add_u32 s94, s94, s93
v_mfma_f32_16x16x32_bf16 v[20:23], a[128:131], a[72:75], v[20:23]
ds_read_b64_tr_b16 a[40:41], v225 offset:32768
v_mfma_f32_16x16x32_bf16 v[24:27], a[132:135], a[72:75], v[24:27]
s_add_u32 m0, s38, s39
v_mfma_f32_16x16x32_bf16 v[28:31], a[136:139], a[72:75], v[28:31]
ds_read_b128 a[4:7], v248 offset:0
v_mfma_f32_16x16x32_bf16 v[32:35], a[108:111], a[76:79], v[32:35]
buffer_load_dwordx4 v234, s[4:7], s36 offen offset:0 lds
v_mfma_f32_16x16x32_bf16 v[36:39], a[112:115], a[76:79], v[36:39]
ds_read_b64_tr_b16 a[42:43], v225 offset:34816
v_mfma_f32_16x16x32_bf16 v[40:43], a[116:119], a[76:79], v[40:43]
v_mfma_f32_16x16x32_bf16 v[44:47], a[120:123], a[76:79], v[44:47]
ds_read_b64_tr_b16 a[44:45], v226 offset:32768
v_mfma_f32_16x16x32_bf16 v[48:51], a[124:127], a[76:79], v[48:51]
ds_read_b128 a[8:11], v232 offset:4096
v_mfma_f32_16x16x32_bf16 v[52:55], a[128:131], a[76:79], v[52:55]
buffer_load_dwordx4 v235, s[4:7], s36 offen offset:1024 lds
v_mfma_f32_16x16x32_bf16 v[56:59], a[108:111], a[80:83], v[56:59]
ds_read_b64_tr_b16 a[46:47], v226 offset:34816
v_mfma_f32_16x16x32_bf16 v[60:63], a[112:115], a[80:83], v[60:63]
v_mfma_f32_16x16x32_bf16 v[64:67], a[116:119], a[80:83], v[64:67]
ds_read_b64_tr_b16 a[48:49], v227 offset:32768
v_mfma_f32_16x16x32_bf16 v[68:71], a[120:123], a[80:83], v[68:71]
buffer_load_dwordx4 v234, s[4:7], s36 offen offset:2048 lds
v_mfma_f32_16x16x32_bf16 v[72:75], a[124:127], a[80:83], v[72:75]
ds_read_b128 a[12:15], v248 offset:4096
v_mfma_f32_16x16x32_bf16 v[76:79], a[128:131], a[80:83], v[76:79]
v_mfma_f32_16x16x32_bf16 v[80:83], a[132:135], a[80:83], v[80:83]
ds_read_b64_tr_b16 a[50:51], v227 offset:34816
v_mfma_f32_16x16x32_bf16 v[84:87], a[136:139], a[80:83], v[84:87]
v_mfma_f32_16x16x32_bf16 v[88:91], a[108:111], a[84:87], v[88:91]
ds_read_b64_tr_b16 a[52:53], v228 offset:32768
v_mfma_f32_16x16x32_bf16 v[92:95], a[112:115], a[84:87], v[92:95]
ds_read_b128 a[16:19], v232 offset:8192
v_mfma_f32_16x16x32_bf16 v[96:99], a[116:119], a[84:87], v[96:99]
buffer_load_dwordx4 v235, s[4:7], s36 offen offset:3072 lds
v_mfma_f32_16x16x32_bf16 v[100:103], a[120:123], a[84:87], v[100:103]
ds_read_b64_tr_b16 a[54:55], v228 offset:34816
v_mfma_f32_16x16x32_bf16 v[104:107], a[124:127], a[84:87], v[104:107]
s_add_u32 s36, s36, 128
v_mfma_f32_16x16x32_bf16 v[108:111], a[128:131], a[84:87], v[108:111]
ds_read_b64_tr_b16 a[56:57], v229 offset:32768
v_mfma_f32_16x16x32_bf16 v[112:115], a[108:111], a[88:91], v[112:115]
s_add_u32 m0, s43, 16384
v_mfma_f32_16x16x32_bf16 v[116:119], a[112:115], a[88:91], v[116:119]
ds_read_b128 a[20:23], v248 offset:8192
v_mfma_f32_16x16x32_bf16 v[120:123], a[116:119], a[88:91], v[120:123]
buffer_load_dwordx4 v236, s[8:11], s41 offen offset:0 lds
v_mfma_f32_16x16x32_bf16 v[124:127], a[120:123], a[88:91], v[124:127]
ds_read_b64_tr_b16 a[58:59], v229 offset:34816
v_mfma_f32_16x16x32_bf16 v[128:131], a[124:127], a[88:91], v[128:131]
v_mfma_f32_16x16x32_bf16 v[132:135], a[128:131], a[88:91], v[132:135]
ds_read_b64_tr_b16 a[60:61], v230 offset:32768
v_mfma_f32_16x16x32_bf16 v[136:139], a[132:135], a[88:91], v[136:139]
ds_read_b128 a[24:27], v232 offset:12288
v_mfma_f32_16x16x32_bf16 v[140:143], a[136:139], a[88:91], v[140:143]
buffer_load_dwordx4 v237, s[8:11], s41 offen offset:1024 lds
v_mfma_f32_16x16x32_bf16 v[144:147], a[108:111], a[92:95], v[144:147]
ds_read_b64_tr_b16 a[62:63], v230 offset:34816
v_mfma_f32_16x16x32_bf16 v[148:151], a[112:115], a[92:95], v[148:151]
v_mfma_f32_16x16x32_bf16 v[152:155], a[116:119], a[92:95], v[152:155]
ds_read_b64_tr_b16 a[64:65], v231 offset:32768
v_mfma_f32_16x16x32_bf16 v[156:159], a[120:123], a[92:95], v[156:159]
buffer_load_dwordx4 v238, s[8:11], s41 offen offset:2048 lds
v_mfma_f32_16x16x32_bf16 v[160:163], a[124:127], a[92:95], v[160:163]
ds_read_b128 a[28:31], v248 offset:12288
v_mfma_f32_16x16x32_bf16 v[164:167], a[128:131], a[92:95], v[164:167]
v_mfma_f32_16x16x32_bf16 v[168:171], a[108:111], a[96:99], v[168:171]
ds_read_b64_tr_b16 a[66:67], v231 offset:34816
v_mfma_f32_16x16x32_bf16 v[172:175], a[112:115], a[96:99], v[172:175]
buffer_load_dwordx4 v239, s[8:11], s41 offen offset:3072 lds
v_mfma_f32_16x16x32_bf16 v[176:179], a[116:119], a[96:99], v[176:179]
s_add_u32 s41, s41, 229376
v_mfma_f32_16x16x32_bf16 v[180:183], a[120:123], a[96:99], v[180:183]
v_add_u32 v232, s45, v232
v_mfma_f32_16x16x32_bf16 v[184:187], a[124:127], a[96:99], v[184:187]
v_add_u32 v248, s45, v248
v_mfma_f32_16x16x32_bf16 v[188:191], a[128:131], a[96:99], v[188:191]
v_mfma_f32_16x16x32_bf16 v[192:195], a[132:135], a[96:99], v[192:195]
v_mfma_f32_16x16x32_bf16 v[196:199], a[136:139], a[96:99], v[196:199]
v_mfma_f32_16x16x32_bf16 v[200:203], a[108:111], a[100:103], v[200:203]
v_mfma_f32_16x16x32_bf16 v[204:207], a[112:115], a[100:103], v[204:207]
v_mfma_f32_16x16x32_bf16 v[208:211], a[116:119], a[100:103], v[208:211]
v_mfma_f32_16x16x32_bf16 v[212:215], a[120:123], a[100:103], v[212:215]
v_mfma_f32_16x16x32_bf16 v[216:219], a[124:127], a[100:103], v[216:219]
v_mfma_f32_16x16x32_bf16 v[220:223], a[128:131], a[100:103], v[220:223]
s_waitcnt vmcnt(17) lgkmcnt(0)
s_barrier
v_mfma_f32_16x16x32_bf16 v[0:3], a[36:39], a[0:3], v[0:3]
ds_read_b64_tr_b16 a[108:109], v224 offset:49152
v_mfma_f32_16x16x32_bf16 v[4:7], a[40:43], a[0:3], v[4:7]
ds_read_b128 a[72:75], v233 offset:0
v_mfma_f32_16x16x32_bf16 v[8:11], a[44:47], a[0:3], v[8:11]
s_add_u32 m0, s38, s40
v_mfma_f32_16x16x32_bf16 v[12:15], a[48:51], a[0:3], v[12:15]
ds_read_b64_tr_b16 a[110:111], v224 offset:51200
v_mfma_f32_16x16x32_bf16 v[16:19], a[52:55], a[0:3], v[16:19]
buffer_load_dwordx4 v234, s[4:7], s37 offen offset:0 lds
v_mfma_f32_16x16x32_bf16 v[20:23], a[56:59], a[0:3], v[20:23]
ds_read_b64_tr_b16 a[112:113], v225 offset:49152
v_mfma_f32_16x16x32_bf16 v[24:27], a[60:63], a[0:3], v[24:27]
v_mfma_f32_16x16x32_bf16 v[28:31], a[64:67], a[0:3], v[28:31]
ds_read_b128 a[76:79], v249 offset:0
v_mfma_f32_16x16x32_bf16 v[32:35], a[36:39], a[4:7], v[32:35]
buffer_load_dwordx4 v235, s[4:7], s37 offen offset:1024 lds
v_mfma_f32_16x16x32_bf16 v[36:39], a[40:43], a[4:7], v[36:39]
ds_read_b64_tr_b16 a[114:115], v225 offset:51200
v_mfma_f32_16x16x32_bf16 v[40:43], a[44:47], a[4:7], v[40:43]
v_mfma_f32_16x16x32_bf16 v[44:47], a[48:51], a[4:7], v[44:47]
ds_read_b64_tr_b16 a[116:117], v226 offset:49152
v_mfma_f32_16x16x32_bf16 v[48:51], a[52:55], a[4:7], v[48:51]
ds_read_b128 a[80:83], v233 offset:4096
v_mfma_f32_16x16x32_bf16 v[52:55], a[56:59], a[4:7], v[52:55]
buffer_load_dwordx4 v234, s[4:7], s37 offen offset:2048 lds
v_mfma_f32_16x16x32_bf16 v[56:59], a[36:39], a[8:11], v[56:59]
ds_read_b64_tr_b16 a[118:119], v226 offset:51200
v_mfma_f32_16x16x32_bf16 v[60:63], a[40:43], a[8:11], v[60:63]
v_mfma_f32_16x16x32_bf16 v[64:67], a[44:47], a[8:11], v[64:67]
ds_read_b64_tr_b16 a[120:121], v227 offset:49152
v_mfma_f32_16x16x32_bf16 v[68:71], a[48:51], a[8:11], v[68:71]
v_mfma_f32_16x16x32_bf16 v[72:75], a[52:55], a[8:11], v[72:75]
ds_read_b128 a[84:87], v249 offset:4096
v_mfma_f32_16x16x32_bf16 v[76:79], a[56:59], a[8:11], v[76:79]
buffer_load_dwordx4 v235, s[4:7], s37 offen offset:3072 lds
v_mfma_f32_16x16x32_bf16 v[80:83], a[60:63], a[8:11], v[80:83]
ds_read_b64_tr_b16 a[122:123], v227 offset:51200
v_mfma_f32_16x16x32_bf16 v[84:87], a[64:67], a[8:11], v[84:87]
s_add_u32 s37, s37, 128
v_mfma_f32_16x16x32_bf16 v[88:91], a[36:39], a[12:15], v[88:91]
ds_read_b64_tr_b16 a[124:125], v228 offset:49152
v_mfma_f32_16x16x32_bf16 v[92:95], a[40:43], a[12:15], v[92:95]
ds_read_b128 a[88:91], v233 offset:8192
v_mfma_f32_16x16x32_bf16 v[96:99], a[44:47], a[12:15], v[96:99]
s_add_u32 s38, s38, 32768
v_mfma_f32_16x16x32_bf16 v[100:103], a[48:51], a[12:15], v[100:103]
ds_read_b64_tr_b16 a[126:127], v228 offset:51200
v_mfma_f32_16x16x32_bf16 v[104:107], a[52:55], a[12:15], v[104:107]
s_cmp_ge_u32 s38, 163840
v_mfma_f32_16x16x32_bf16 v[108:111], a[56:59], a[12:15], v[108:111]
ds_read_b64_tr_b16 a[128:129], v229 offset:49152
v_mfma_f32_16x16x32_bf16 v[112:115], a[36:39], a[16:19], v[112:115]
s_cselect_b32 s38, 65536, s38
v_mfma_f32_16x16x32_bf16 v[116:119], a[40:43], a[16:19], v[116:119]
ds_read_b128 a[92:95], v249 offset:8192
v_mfma_f32_16x16x32_bf16 v[120:123], a[44:47], a[16:19], v[120:123]
s_add_u32 m0, s43, 32768
v_mfma_f32_16x16x32_bf16 v[124:127], a[48:51], a[16:19], v[124:127]
ds_read_b64_tr_b16 a[130:131], v229 offset:51200
v_mfma_f32_16x16x32_bf16 v[128:131], a[52:55], a[16:19], v[128:131]
buffer_load_dwordx4 v236, s[8:11], s41 offen offset:0 lds
v_mfma_f32_16x16x32_bf16 v[132:135], a[56:59], a[16:19], v[132:135]
ds_read_b64_tr_b16 a[132:133], v230 offset:49152
v_mfma_f32_16x16x32_bf16 v[136:139], a[60:63], a[16:19], v[136:139]
ds_read_b128 a[96:99], v233 offset:12288
v_mfma_f32_16x16x32_bf16 v[140:143], a[64:67], a[16:19], v[140:143]
buffer_load_dwordx4 v237, s[8:11], s41 offen offset:1024 lds
v_mfma_f32_16x16x32_bf16 v[144:147], a[36:39], a[20:23], v[144:147]
ds_read_b64_tr_b16 a[134:135], v230 offset:51200
v_mfma_f32_16x16x32_bf16 v[148:151], a[40:43], a[20:23], v[148:151]
buffer_load_dwordx4 v238, s[8:11], s41 offen offset:2048 lds
v_mfma_f32_16x16x32_bf16 v[152:155], a[44:47], a[20:23], v[152:155]
ds_read_b64_tr_b16 a[136:137], v231 offset:49152
v_mfma_f32_16x16x32_bf16 v[156:159], a[48:51], a[20:23], v[156:159]
v_mfma_f32_16x16x32_bf16 v[160:163], a[52:55], a[20:23], v[160:163]
ds_read_b128 a[100:103], v249 offset:12288
v_mfma_f32_16x16x32_bf16 v[164:167], a[56:59], a[20:23], v[164:167]
v_mfma_f32_16x16x32_bf16 v[168:171], a[36:39], a[24:27], v[168:171]
ds_read_b64_tr_b16 a[138:139], v231 offset:51200
v_mfma_f32_16x16x32_bf16 v[172:175], a[40:43], a[24:27], v[172:175]
buffer_load_dwordx4 v239, s[8:11], s41 offen offset:3072 lds
v_mfma_f32_16x16x32_bf16 v[176:179], a[44:47], a[24:27], v[176:179]
s_add_u32 s41, s41, 229376
v_mfma_f32_16x16x32_bf16 v[180:183], a[48:51], a[24:27], v[180:183]
v_add_u32 v233, s45, v233
v_mfma_f32_16x16x32_bf16 v[184:187], a[52:55], a[24:27], v[184:187]
v_add_u32 v249, s45, v249
v_mfma_f32_16x16x32_bf16 v[188:191], a[56:59], a[24:27], v[188:191]
s_add_u32 s46, s46, s45
v_mfma_f32_16x16x32_bf16 v[192:195], a[60:63], a[24:27], v[192:195]
s_cmp_eq_u32 s46, 65536
v_mfma_f32_16x16x32_bf16 v[196:199], a[64:67], a[24:27], v[196:199]
s_cselect_b32 s45, s54, s53
v_mfma_f32_16x16x32_bf16 v[200:203], a[36:39], a[28:31], v[200:203]
v_mfma_f32_16x16x32_bf16 v[204:207], a[40:43], a[28:31], v[204:207]
v_mfma_f32_16x16x32_bf16 v[208:211], a[44:47], a[28:31], v[208:211]
v_mfma_f32_16x16x32_bf16 v[212:215], a[48:51], a[28:31], v[212:215]
v_mfma_f32_16x16x32_bf16 v[216:219], a[52:55], a[28:31], v[216:219]
v_mfma_f32_16x16x32_bf16 v[220:223], a[56:59], a[28:31], v[220:223]
s_waitcnt vmcnt(17) lgkmcnt(0)
s_barrier
v_mfma_f32_16x16x32_bf16 v[0:3], a[108:111], a[72:75], v[0:3]
ds_read_b64_tr_b16 a[36:37], v224 offset:0
v_mfma_f32_16x16x32_bf16 v[4:7], a[112:115], a[72:75], v[4:7]
ds_read_b128 a[0:3], v232 offset:0
v_mfma_f32_16x16x32_bf16 v[8:11], a[116:119], a[72:75], v[8:11]
buffer_load_dwordx4 a[252:255], v253, s[96:99], s94 offen
v_mfma_f32_16x16x32_bf16 v[12:15], a[120:123], a[72:75], v[12:15]
ds_read_b64_tr_b16 a[38:39], v224 offset:2048
v_mfma_f32_16x16x32_bf16 v[16:19], a[124:127], a[72:75], v[16:19]
s_add_u32 s94, s94, s93
v_mfma_f32_16x16x32_bf16 v[20:23], a[128:131], a[72:75], v[20:23]
ds_read_b64_tr_b16 a[40:41], v225 offset:0
v_mfma_f32_16x16x32_bf16 v[24:27], a[132:135], a[72:75], v[24:27]
s_add_u32 m0, s38, s39
v_mfma_f32_16x16x32_bf16 v[28:31], a[136:139], a[72:75], v[28:31]
ds_read_b128 a[4:7], v248 offset:0
v_mfma_f32_16x16x32_bf16 v[32:35], a[108:111], a[76:79], v[32:35]
buffer_load_dwordx4 v234, s[4:7], s36 offen offset:0 lds
v_mfma_f32_16x16x32_bf16 v[36:39], a[112:115], a[76:79], v[36:39]
ds_read_b64_tr_b16 a[42:43], v225 offset:2048
v_mfma_f32_16x16x32_bf16 v[40:43], a[116:119], a[76:79], v[40:43]
v_mfma_f32_16x16x32_bf16 v[44:47], a[120:123], a[76:79], v[44:47]
ds_read_b64_tr_b16 a[44:45], v226 offset:0
v_mfma_f32_16x16x32_bf16 v[48:51], a[124:127], a[76:79], v[48:51]
ds_read_b128 a[8:11], v232 offset:4096
v_mfma_f32_16x16x32_bf16 v[52:55], a[128:131], a[76:79], v[52:55]
buffer_load_dwordx4 v235, s[4:7], s36 offen offset:1024 lds
v_mfma_f32_16x16x32_bf16 v[56:59], a[108:111], a[80:83], v[56:59]
ds_read_b64_tr_b16 a[46:47], v226 offset:2048
v_mfma_f32_16x16x32_bf16 v[60:63], a[112:115], a[80:83], v[60:63]
v_mfma_f32_16x16x32_bf16 v[64:67], a[116:119], a[80:83], v[64:67]
ds_read_b64_tr_b16 a[48:49], v227 offset:0
v_mfma_f32_16x16x32_bf16 v[68:71], a[120:123], a[80:83], v[68:71]
buffer_load_dwordx4 v234, s[4:7], s36 offen offset:2048 lds
v_mfma_f32_16x16x32_bf16 v[72:75], a[124:127], a[80:83], v[72:75]
ds_read_b128 a[12:15], v248 offset:4096
v_mfma_f32_16x16x32_bf16 v[76:79], a[128:131], a[80:83], v[76:79]
v_mfma_f32_16x16x32_bf16 v[80:83], a[132:135], a[80:83], v[80:83]
ds_read_b64_tr_b16 a[50:51], v227 offset:2048
v_mfma_f32_16x16x32_bf16 v[84:87], a[136:139], a[80:83], v[84:87]
v_mfma_f32_16x16x32_bf16 v[88:91], a[108:111], a[84:87], v[88:91]
ds_read_b64_tr_b16 a[52:53], v228 offset:0
v_mfma_f32_16x16x32_bf16 v[92:95], a[112:115], a[84:87], v[92:95]
ds_read_b128 a[16:19], v232 offset:8192
v_mfma_f32_16x16x32_bf16 v[96:99], a[116:119], a[84:87], v[96:99]
buffer_load_dwordx4 v235, s[4:7], s36 offen offset:3072 lds
v_mfma_f32_16x16x32_bf16 v[100:103], a[120:123], a[84:87], v[100:103]
ds_read_b64_tr_b16 a[54:55], v228 offset:2048
v_mfma_f32_16x16x32_bf16 v[104:107], a[124:127], a[84:87], v[104:107]
s_add_u32 s36, s36, 128
v_mfma_f32_16x16x32_bf16 v[108:111], a[128:131], a[84:87], v[108:111]
ds_read_b64_tr_b16 a[56:57], v229 offset:0
v_mfma_f32_16x16x32_bf16 v[112:115], a[108:111], a[88:91], v[112:115]
s_add_u32 m0, s43, 49152
v_mfma_f32_16x16x32_bf16 v[116:119], a[112:115], a[88:91], v[116:119]
ds_read_b128 a[20:23], v248 offset:8192
v_mfma_f32_16x16x32_bf16 v[120:123], a[116:119], a[88:91], v[120:123]
buffer_load_dwordx4 v236, s[8:11], s41 offen offset:0 lds
v_mfma_f32_16x16x32_bf16 v[124:127], a[120:123], a[88:91], v[124:127]
ds_read_b64_tr_b16 a[58:59], v229 offset:2048
v_mfma_f32_16x16x32_bf16 v[128:131], a[124:127], a[88:91], v[128:131]
v_mfma_f32_16x16x32_bf16 v[132:135], a[128:131], a[88:91], v[132:135]
ds_read_b64_tr_b16 a[60:61], v230 offset:0
v_mfma_f32_16x16x32_bf16 v[136:139], a[132:135], a[88:91], v[136:139]
ds_read_b128 a[24:27], v232 offset:12288
v_mfma_f32_16x16x32_bf16 v[140:143], a[136:139], a[88:91], v[140:143]
buffer_load_dwordx4 v237, s[8:11], s41 offen offset:1024 lds
v_mfma_f32_16x16x32_bf16 v[144:147], a[108:111], a[92:95], v[144:147]
ds_read_b64_tr_b16 a[62:63], v230 offset:2048
v_mfma_f32_16x16x32_bf16 v[148:151], a[112:115], a[92:95], v[148:151]
v_mfma_f32_16x16x32_bf16 v[152:155], a[116:119], a[92:95], v[152:155]
ds_read_b64_tr_b16 a[64:65], v231 offset:0
v_mfma_f32_16x16x32_bf16 v[156:159], a[120:123], a[92:95], v[156:159]
buffer_load_dwordx4 v238, s[8:11], s41 offen offset:2048 lds
v_mfma_f32_16x16x32_bf16 v[160:163], a[124:127], a[92:95], v[160:163]
ds_read_b128 a[28:31], v248 offset:12288
v_mfma_f32_16x16x32_bf16 v[164:167], a[128:131], a[92:95], v[164:167]
v_mfma_f32_16x16x32_bf16 v[168:171], a[108:111], a[96:99], v[168:171]
ds_read_b64_tr_b16 a[66:67], v231 offset:2048
v_mfma_f32_16x16x32_bf16 v[172:175], a[112:115], a[96:99], v[172:175]
buffer_load_dwordx4 v239, s[8:11], s41 offen offset:3072 lds
v_mfma_f32_16x16x32_bf16 v[176:179], a[116:119], a[96:99], v[176:179]
s_add_u32 s41, s41, 229376
v_mfma_f32_16x16x32_bf16 v[180:183], a[120:123], a[96:99], v[180:183]
v_add_u32 v232, s45, v232
v_mfma_f32_16x16x32_bf16 v[184:187], a[124:127], a[96:99], v[184:187]
v_add_u32 v248, s45, v248
v_mfma_f32_16x16x32_bf16 v[188:191], a[128:131], a[96:99], v[188:191]
v_mfma_f32_16x16x32_bf16 v[192:195], a[132:135], a[96:99], v[192:195]
v_mfma_f32_16x16x32_bf16 v[196:199], a[136:139], a[96:99], v[196:199]
v_mfma_f32_16x16x32_bf16 v[200:203], a[108:111], a[100:103], v[200:203]
v_mfma_f32_16x16x32_bf16 v[204:207], a[112:115], a[100:103], v[204:207]
v_mfma_f32_16x16x32_bf16 v[208:211], a[116:119], a[100:103], v[208:211]
v_mfma_f32_16x16x32_bf16 v[212:215], a[120:123], a[100:103], v[212:215]
v_mfma_f32_16x16x32_bf16 v[216:219], a[124:127], a[100:103], v[216:219]
v_mfma_f32_16x16x32_bf16 v[220:223], a[128:131], a[100:103], v[220:223]
s_sub_u32 s34, s34, 1
s_cmp_lg_u32 s34, 0
s_cbranch_scc1 L1_loop_W
L1_nonce_W:
v_accvgpr_read_b32 v244, a168
v_accvgpr_read_b32 v245, a169
s_add_u32 s34, s34, 1
v_readfirstlane_b32 s58, v244
v_readfirstlane_b32 s59, v245
s_cmp_lg_u32 s58, 0
s_cbranch_scc1 L1_nonce_ok_W
s_cmp_gt_u32 s34, 0x80000
s_cbranch_scc1 L1_nonce_ok_W
s_sleep 2
buffer_load_dwordx2 a[168:169], v253, s[16:19], 0 offen sc1
s_waitcnt vmcnt(0)
s_branch L1_nonce_W
L1_nonce_ok_W:
v_mov_b32 v244, s58
v_mov_b32 v245, s59
v_accvgpr_write_b32 a168, v244
v_accvgpr_write_b32 a169, v245
s_waitcnt vmcnt(17) lgkmcnt(0)
s_barrier
v_mfma_f32_16x16x32_bf16 v[0:3], a[36:39], a[0:3], v[0:3]
ds_read_b64_tr_b16 a[108:109], v224 offset:16384
v_mfma_f32_16x16x32_bf16 v[4:7], a[40:43], a[0:3], v[4:7]
ds_read_b128 a[72:75], v233 offset:0
buffer_store_dword v241, v243, s[12:15], s3 offen sc1
v_mfma_f32_16x16x32_bf16 v[8:11], a[44:47], a[0:3], v[8:11]
s_mov_b32 s8, s24
s_and_b32 s9, s25, 0xffff
v_mfma_f32_16x16x32_bf16 v[12:15], a[48:51], a[0:3], v[12:15]
ds_read_b64_tr_b16 a[110:111], v224 offset:18432
s_mov_b32 s10, 0x200000
v_mfma_f32_16x16x32_bf16 v[16:19], a[52:55], a[0:3], v[16:19]
s_mov_b32 s11, 0x20000
s_mov_b32 s16, s26
v_mfma_f32_16x16x32_bf16 v[20:23], a[56:59], a[0:3], v[20:23]
ds_read_b64_tr_b16 a[112:113], v225 offset:16384
s_and_b32 s17, s27, 0xffff
v_mfma_f32_16x16x32_bf16 v[24:27], a[60:63], a[0:3], v[24:27]
s_mov_b32 s18, 0x700000
s_mov_b32 s19, 0x20000
v_mfma_f32_16x16x32_bf16 v[28:31], a[64:67], a[0:3], v[28:31]
ds_read_b128 a[76:79], v249 offset:0
s_add_u32 s42, s35, 2097152
v_mfma_f32_16x16x32_bf16 v[32:35], a[36:39], a[4:7], v[32:35]
buffer_load_dwordx4 a[252:255], v253, s[16:19], s42 offen
s_add_u32 s42, s35, 0
v_mfma_f32_16x16x32_bf16 v[36:39], a[40:43], a[4:7], v[36:39]
ds_read_b64_tr_b16 a[114:115], v225 offset:18432
buffer_load_dwordx4 a[252:255], v253, s[16:19], s42 offen
v_mfma_f32_16x16x32_bf16 v[40:43], a[44:47], a[4:7], v[40:43]
s_add_u32 s42, s35, 3145728
buffer_load_dwordx4 a[252:255], v253, s[16:19], s42 offen
v_mfma_f32_16x16x32_bf16 v[44:47], a[48:51], a[4:7], v[44:47]
ds_read_b64_tr_b16 a[116:117], v226 offset:16384
s_add_u32 s42, s35, 1048576
v_mfma_f32_16x16x32_bf16 v[48:51], a[52:55], a[4:7], v[48:51]
ds_read_b128 a[80:83], v233 offset:4096
buffer_load_dwordx4 a[252:255], v253, s[16:19], s42 offen
v_mfma_f32_16x16x32_bf16 v[52:55], a[56:59], a[4:7], v[52:55]
v_lshrrev_b32 v250, 4, v254
v_and_b32 v251, 15, v254
v_mfma_f32_16x16x32_bf16 v[56:59], a[36:39], a[8:11], v[56:59]
ds_read_b64_tr_b16 a[118:119], v226 offset:18432
v_lshlrev_b32 v252, 1, v250
v_mfma_f32_16x16x32_bf16 v[60:63], a[40:43], a[8:11], v[60:63]
v_xor_b32 v251, v252, v251
v_lshlrev_b32 v250, 11, v250
v_mfma_f32_16x16x32_bf16 v[64:67], a[44:47], a[8:11], v[64:67]
ds_read_b64_tr_b16 a[120:121], v227 offset:16384
v_lshl_add_u32 v244, v251, 4, v250
v_mfma_f32_16x16x32_bf16 v[68:71], a[48:51], a[8:11], v[68:71]
v_xor_b32 v251, 8, v251
v_lshl_add_u32 v251, v251, 4, v250
v_mfma_f32_16x16x32_bf16 v[72:75], a[52:55], a[8:11], v[72:75]
ds_read_b128 a[84:87], v249 offset:4096
v_add_u32 v245, 7168, v251
v_mfma_f32_16x16x32_bf16 v[76:79], a[56:59], a[8:11], v[76:79]
v_add_u32 v246, 14336, v244
v_add_u32 v247, 21504, v251
v_mfma_f32_16x16x32_bf16 v[80:83], a[60:63], a[8:11], v[80:83]
ds_read_b64_tr_b16 a[122:123], v227 offset:18432
v_mfma_f32_16x16x32_bf16 v[84:87], a[64:67], a[8:11], v[84:87]
v_mfma_f32_16x16x32_bf16 v[88:91], a[36:39], a[12:15], v[88:91]
ds_read_b64_tr_b16 a[124:125], v228 offset:16384
v_mfma_f32_16x16x32_bf16 v[92:95], a[40:43], a[12:15], v[92:95]
ds_read_b128 a[88:91], v233 offset:8192
v_mfma_f32_16x16x32_bf16 v[96:99], a[44:47], a[12:15], v[96:99]
v_mfma_f32_16x16x32_bf16 v[100:103], a[48:51], a[12:15], v[100:103]
ds_read_b64_tr_b16 a[126:127], v228 offset:18432
v_mfma_f32_16x16x32_bf16 v[104:107], a[52:55], a[12:15], v[104:107]
v_mfma_f32_16x16x32_bf16 v[108:111], a[56:59], a[12:15], v[108:111]
ds_read_b64_tr_b16 a[128:129], v229 offset:16384
v_mfma_f32_16x16x32_bf16 v[112:115], a[36:39], a[16:19], v[112:115]
v_mfma_f32_16x16x32_bf16 v[116:119], a[40:43], a[16:19], v[116:119]
ds_read_b128 a[92:95], v249 offset:8192
v_mfma_f32_16x16x32_bf16 v[120:123], a[44:47], a[16:19], v[120:123]
v_mfma_f32_16x16x32_bf16 v[124:127], a[48:51], a[16:19], v[124:127]
ds_read_b64_tr_b16 a[130:131], v229 offset:18432
v_mfma_f32_16x16x32_bf16 v[128:131], a[52:55], a[16:19], v[128:131]
v_mfma_f32_16x16x32_bf16 v[132:135], a[56:59], a[16:19], v[132:135]
ds_read_b64_tr_b16 a[132:133], v230 offset:16384
v_mfma_f32_16x16x32_bf16 v[136:139], a[60:63], a[16:19], v[136:139]
ds_read_b128 a[96:99], v233 offset:12288
v_mfma_f32_16x16x32_bf16 v[140:143], a[64:67], a[16:19], v[140:143]
v_mfma_f32_16x16x32_bf16 v[144:147], a[36:39], a[20:23], v[144:147]
ds_read_b64_tr_b16 a[134:135], v230 offset:18432
v_mfma_f32_16x16x32_bf16 v[148:151], a[40:43], a[20:23], v[148:151]
v_mfma_f32_16x16x32_bf16 v[152:155], a[44:47], a[20:23], v[152:155]
ds_read_b64_tr_b16 a[136:137], v231 offset:16384
v_mfma_f32_16x16x32_bf16 v[156:159], a[48:51], a[20:23], v[156:159]
v_mfma_f32_16x16x32_bf16 v[160:163], a[52:55], a[20:23], v[160:163]
ds_read_b128 a[100:103], v249 offset:12288
v_mfma_f32_16x16x32_bf16 v[164:167], a[56:59], a[20:23], v[164:167]
v_mfma_f32_16x16x32_bf16 v[168:171], a[36:39], a[24:27], v[168:171]
ds_read_b64_tr_b16 a[138:139], v231 offset:18432
v_mfma_f32_16x16x32_bf16 v[172:175], a[40:43], a[24:27], v[172:175]
v_add_u32 v233, s45, v233
v_mfma_f32_16x16x32_bf16 v[176:179], a[44:47], a[24:27], v[176:179]
v_add_u32 v249, s45, v249
v_mfma_f32_16x16x32_bf16 v[180:183], a[48:51], a[24:27], v[180:183]
s_add_u32 s46, s46, s45
v_mfma_f32_16x16x32_bf16 v[184:187], a[52:55], a[24:27], v[184:187]
s_cmp_eq_u32 s46, 65536
v_mfma_f32_16x16x32_bf16 v[188:191], a[56:59], a[24:27], v[188:191]
s_cselect_b32 s45, s54, s53
v_mfma_f32_16x16x32_bf16 v[192:195], a[60:63], a[24:27], v[192:195]
v_mfma_f32_16x16x32_bf16 v[196:199], a[64:67], a[24:27], v[196:199]
v_mfma_f32_16x16x32_bf16 v[200:203], a[36:39], a[28:31], v[200:203]
v_mfma_f32_16x16x32_bf16 v[204:207], a[40:43], a[28:31], v[204:207]
v_mfma_f32_16x16x32_bf16 v[208:211], a[44:47], a[28:31], v[208:211]
v_mfma_f32_16x16x32_bf16 v[212:215], a[48:51], a[28:31], v[212:215]
v_mfma_f32_16x16x32_bf16 v[216:219], a[52:55], a[28:31], v[216:219]
v_mfma_f32_16x16x32_bf16 v[220:223], a[56:59], a[28:31], v[220:223]
s_waitcnt vmcnt(14) lgkmcnt(0)
s_barrier
v_mfma_f32_16x16x32_bf16 v[0:3], a[108:111], a[72:75], v[0:3]
ds_read_b64_tr_b16 a[36:37], v224 offset:32768
v_mfma_f32_16x16x32_bf16 v[4:7], a[112:115], a[72:75], v[4:7]
ds_read_b128 a[0:3], v232 offset:0
s_add_u32 s42, s35, 4194304
v_mfma_f32_16x16x32_bf16 v[8:11], a[116:119], a[72:75], v[8:11]
buffer_load_dwordx4 a[252:255], v253, s[16:19], s42 offen
s_add_u32 s42, s35, 5242880
v_mfma_f32_16x16x32_bf16 v[12:15], a[120:123], a[72:75], v[12:15]
ds_read_b64_tr_b16 a[38:39], v224 offset:34816
buffer_load_dwordx4 a[252:255], v253, s[16:19], s42 offen
v_mfma_f32_16x16x32_bf16 v[16:19], a[124:127], a[72:75], v[16:19]
s_add_u32 s42, s35, 6291456
buffer_load_dwordx4 a[252:255], v253, s[16:19], s42 offen
v_mfma_f32_16x16x32_bf16 v[20:23], a[128:131], a[72:75], v[20:23]
ds_read_b64_tr_b16 a[40:41], v225 offset:32768
s_and_b32 s51, s2, 7
v_mfma_f32_16x16x32_bf16 v[24:27], a[132:135], a[72:75], v[24:27]
s_xor_b32 s94, s23, 1
s_lshr_b32 s92, s51, 1
v_mfma_f32_16x16x32_bf16 v[28:31], a[136:139], a[72:75], v[28:31]
ds_read_b128 a[4:7], v248 offset:0
s_lshl_b32 s92, s92, 2
v_mfma_f32_16x16x32_bf16 v[32:35], a[108:111], a[76:79], v[32:35]
s_and_b32 s53, s21, 3
s_add_u32 s92, s92, s53
v_mfma_f32_16x16x32_bf16 v[36:39], a[112:115], a[76:79], v[36:39]
ds_read_b64_tr_b16 a[42:43], v225 offset:34816
s_and_b32 s93, s51, 1
v_mfma_f32_16x16x32_bf16 v[40:43], a[116:119], a[76:79], v[40:43]
s_lshl_b32 s93, s93, 2
s_and_b32 s53, s22, 3
v_mfma_f32_16x16x32_bf16 v[44:47], a[120:123], a[76:79], v[44:47]
ds_read_b64_tr_b16 a[44:45], v226 offset:32768
s_add_u32 s93, s93, s53
v_mfma_f32_16x16x32_bf16 v[48:51], a[124:127], a[76:79], v[48:51]
ds_read_b128 a[8:11], v232 offset:4096
s_lshl_b32 s96, s94, 20
v_mfma_f32_16x16x32_bf16 v[52:55], a[128:131], a[76:79], v[52:55]
s_lshl_b32 s97, s20, 16
s_lshl_b32 s52, s93, 8
v_mfma_f32_16x16x32_bf16 v[56:59], a[108:111], a[80:83], v[56:59]
ds_read_b64_tr_b16 a[46:47], v226 offset:34816
s_add_u32 s97, s97, s52
v_mfma_f32_16x16x32_bf16 v[60:63], a[112:115], a[80:83], v[60:63]
s_add_u32 s96, s96, s97
s_lshl_b32 s98, s20, 13
v_mfma_f32_16x16x32_bf16 v[64:67], a[116:119], a[80:83], v[64:67]
ds_read_b64_tr_b16 a[48:49], v227 offset:32768
s_lshr_b32 s48, s92, 1
v_mfma_f32_16x16x32_bf16 v[68:71], a[120:123], a[80:83], v[68:71]
s_lshl_b32 s48, s48, 7
s_add_u32 s48, s48, 0x1440800
v_mfma_f32_16x16x32_bf16 v[72:75], a[124:127], a[80:83], v[72:75]
ds_read_b128 a[12:15], v248 offset:4096
s_lshr_b32 s51, s20, 1
v_mfma_f32_16x16x32_bf16 v[76:79], a[128:131], a[80:83], v[76:79]
s_and_b32 s59, s20, 1
s_lshl_b32 s55, s21, 4
v_mfma_f32_16x16x32_bf16 v[80:83], a[132:135], a[80:83], v[80:83]
ds_read_b64_tr_b16 a[50:51], v227 offset:34816
s_lshl_b32 s56, s51, 3
v_mfma_f32_16x16x32_bf16 v[84:87], a[136:139], a[80:83], v[84:87]
s_add_u32 s55, s55, s56
s_lshl_b32 s55, s55, 12
v_mfma_f32_16x16x32_bf16 v[88:91], a[108:111], a[84:87], v[88:91]
ds_read_b64_tr_b16 a[52:53], v228 offset:32768
s_mul_i32 s56, s22, 7
v_mfma_f32_16x16x32_bf16 v[92:95], a[112:115], a[84:87], v[92:95]
ds_read_b128 a[16:19], v232 offset:8192
s_add_u32 s56, s56, 32
v_mfma_f32_16x16x32_bf16 v[96:99], a[116:119], a[84:87], v[96:99]
s_lshl_b32 s58, s59, 2
s_lshl_b32 s57, s59, 12
v_mfma_f32_16x16x32_bf16 v[100:103], a[120:123], a[84:87], v[100:103]
ds_read_b64_tr_b16 a[54:55], v228 offset:34816
s_add_u32 s51, s56, 0
v_mfma_f32_16x16x32_bf16 v[104:107], a[124:127], a[84:87], v[104:107]
s_add_u32 s51, s51, s58
s_lshr_b32 s59, s51, 2
v_mfma_f32_16x16x32_bf16 v[108:111], a[128:131], a[84:87], v[108:111]
ds_read_b64_tr_b16 a[56:57], v229 offset:32768
s_lshl_b32 s59, s59, 19
v_mfma_f32_16x16x32_bf16 v[112:115], a[108:111], a[88:91], v[112:115]
s_and_b32 s51, s51, 3
s_lshl_b32 s51, s51, 10
v_mfma_f32_16x16x32_bf16 v[116:119], a[112:115], a[88:91], v[116:119]
ds_read_b128 a[20:23], v248 offset:8192
s_add_u32 s51, s51, s59
v_mfma_f32_16x16x32_bf16 v[120:123], a[116:119], a[88:91], v[120:123]
s_add_u32 s60, s51, s55
s_add_u32 s61, s60, 8192
v_mfma_f32_16x16x32_bf16 v[124:127], a[120:123], a[88:91], v[124:127]
ds_read_b64_tr_b16 a[58:59], v229 offset:34816
s_add_u32 s62, s60, 16384
v_mfma_f32_16x16x32_bf16 v[128:131], a[124:127], a[88:91], v[128:131]
s_add_u32 s63, s60, 24576
s_add_u32 s51, s56, 1
v_mfma_f32_16x16x32_bf16 v[132:135], a[128:131], a[88:91], v[132:135]
ds_read_b64_tr_b16 a[60:61], v230 offset:32768
s_add_u32 s51, s51, s58
v_mfma_f32_16x16x32_bf16 v[136:139], a[132:135], a[88:91], v[136:139]
ds_read_b128 a[24:27], v232 offset:12288
s_lshr_b32 s59, s51, 2
v_mfma_f32_16x16x32_bf16 v[140:143], a[136:139], a[88:91], v[140:143]
s_lshl_b32 s59, s59, 19
s_and_b32 s51, s51, 3
v_mfma_f32_16x16x32_bf16 v[144:147], a[108:111], a[92:95], v[144:147]
ds_read_b64_tr_b16 a[62:63], v230 offset:34816
s_lshl_b32 s51, s51, 10
v_mfma_f32_16x16x32_bf16 v[148:151], a[112:115], a[92:95], v[148:151]
s_add_u32 s51, s51, s59
s_add_u32 s64, s51, s55
v_mfma_f32_16x16x32_bf16 v[152:155], a[116:119], a[92:95], v[152:155]
ds_read_b64_tr_b16 a[64:65], v231 offset:32768
s_add_u32 s65, s64, 8192
v_mfma_f32_16x16x32_bf16 v[156:159], a[120:123], a[92:95], v[156:159]
s_add_u32 s66, s64, 16384
s_add_u32 s67, s64, 24576
v_mfma_f32_16x16x32_bf16 v[160:163], a[124:127], a[92:95], v[160:163]
ds_read_b128 a[28:31], v248 offset:12288
s_add_u32 s51, s56, 2
v_mfma_f32_16x16x32_bf16 v[164:167], a[128:131], a[92:95], v[164:167]
s_add_u32 s51, s51, s58
s_lshr_b32 s59, s51, 2
v_mfma_f32_16x16x32_bf16 v[168:171], a[108:111], a[96:99], v[168:171]
ds_read_b64_tr_b16 a[66:67], v231 offset:34816
s_lshl_b32 s59, s59, 19
v_mfma_f32_16x16x32_bf16 v[172:175], a[112:115], a[96:99], v[172:175]
s_and_b32 s51, s51, 3
s_lshl_b32 s51, s51, 10
v_mfma_f32_16x16x32_bf16 v[176:179], a[116:119], a[96:99], v[176:179]
s_add_u32 s51, s51, s59
s_add_u32 s68, s51, s55
v_mfma_f32_16x16x32_bf16 v[180:183], a[120:123], a[96:99], v[180:183]
s_add_u32 s69, s68, 8192
s_add_u32 s70, s68, 16384
v_mfma_f32_16x16x32_bf16 v[184:187], a[124:127], a[96:99], v[184:187]
s_add_u32 s71, s68, 24576
s_add_u32 s51, s56, 3
v_mfma_f32_16x16x32_bf16 v[188:191], a[128:131], a[96:99], v[188:191]
s_lshr_b32 s59, s51, 2
s_lshl_b32 s59, s59, 19
v_mfma_f32_16x16x32_bf16 v[192:195], a[132:135], a[96:99], v[192:195]
s_and_b32 s51, s51, 3
s_lshl_b32 s51, s51, 10
v_mfma_f32_16x16x32_bf16 v[196:199], a[136:139], a[96:99], v[196:199]
s_add_u32 s51, s51, s59
s_add_u32 s72, s51, s55
v_mfma_f32_16x16x32_bf16 v[200:203], a[108:111], a[100:103], v[200:203]
s_add_u32 s73, s72, 8192
s_add_u32 s74, s72, 16384
v_mfma_f32_16x16x32_bf16 v[204:207], a[112:115], a[100:103], v[204:207]
s_add_u32 s75, s72, 24576
v_add_u32 v250, s57, v253
v_mfma_f32_16x16x32_bf16 v[208:211], a[116:119], a[100:103], v[208:211]
v_xor_b32 v251, 0x1000, v250
v_mfma_f32_16x16x32_bf16 v[212:215], a[120:123], a[100:103], v[212:215]
v_add_u32 v232, s45, v232
v_mfma_f32_16x16x32_bf16 v[216:219], a[124:127], a[100:103], v[216:219]
v_add_u32 v248, s45, v248
v_mfma_f32_16x16x32_bf16 v[220:223], a[128:131], a[100:103], v[220:223]
s_waitcnt vmcnt(8) lgkmcnt(0)
s_barrier
v_mfma_f32_16x16x32_bf16 v[0:3], a[36:39], a[0:3], v[0:3]
ds_read_b64_tr_b16 a[108:109], v224 offset:49152
ds_read_b128 a[72:75], v233 offset:0
v_mfma_f32_16x16x32_bf16 v[4:7], a[40:43], a[0:3], v[4:7]
ds_read_b64_tr_b16 a[110:111], v224 offset:51200
v_mfma_f32_16x16x32_bf16 v[8:11], a[44:47], a[0:3], v[8:11]
ds_read_b64_tr_b16 a[112:113], v225 offset:49152
v_mfma_f32_16x16x32_bf16 v[12:15], a[48:51], a[0:3], v[12:15]
ds_read_b128 a[76:79], v249 offset:0
v_mfma_f32_16x16x32_bf16 v[16:19], a[52:55], a[0:3], v[16:19]
ds_read_b64_tr_b16 a[114:115], v225 offset:51200
v_mfma_f32_16x16x32_bf16 v[20:23], a[56:59], a[0:3], v[20:23]
ds_read_b64_tr_b16 a[116:117], v226 offset:49152
ds_read_b128 a[80:83], v233 offset:4096
v_mfma_f32_16x16x32_bf16 v[24:27], a[60:63], a[0:3], v[24:27]
ds_read_b64_tr_b16 a[118:119], v226 offset:51200
v_mfma_f32_16x16x32_bf16 v[28:31], a[64:67], a[0:3], v[28:31]
ds_read_b64_tr_b16 a[120:121], v227 offset:49152
v_mfma_f32_16x16x32_bf16 v[32:35], a[36:39], a[4:7], v[32:35]
ds_read_b128 a[84:87], v249 offset:4096
v_mfma_f32_16x16x32_bf16 v[36:39], a[40:43], a[4:7], v[36:39]
ds_read_b64_tr_b16 a[122:123], v227 offset:51200
v_mfma_f32_16x16x32_bf16 v[40:43], a[44:47], a[4:7], v[40:43]
ds_read_b64_tr_b16 a[124:125], v228 offset:49152
ds_read_b128 a[88:91], v233 offset:8192
v_mfma_f32_16x16x32_bf16 v[44:47], a[48:51], a[4:7], v[44:47]
ds_read_b64_tr_b16 a[126:127], v228 offset:51200
v_mfma_f32_16x16x32_bf16 v[48:51], a[52:55], a[4:7], v[48:51]
ds_read_b64_tr_b16 a[128:129], v229 offset:49152
v_mfma_f32_16x16x32_bf16 v[52:55], a[56:59], a[4:7], v[52:55]
ds_read_b128 a[92:95], v249 offset:8192
v_mfma_f32_16x16x32_bf16 v[56:59], a[36:39], a[8:11], v[56:59]
ds_read_b64_tr_b16 a[130:131], v229 offset:51200
v_mfma_f32_16x16x32_bf16 v[60:63], a[40:43], a[8:11], v[60:63]
ds_read_b64_tr_b16 a[132:133], v230 offset:49152
ds_read_b128 a[96:99], v233 offset:12288
v_mfma_f32_16x16x32_bf16 v[64:67], a[44:47], a[8:11], v[64:67]
ds_read_b64_tr_b16 a[134:135], v230 offset:51200
v_mfma_f32_16x16x32_bf16 v[68:71], a[48:51], a[8:11], v[68:71]
ds_read_b64_tr_b16 a[136:137], v231 offset:49152
v_mfma_f32_16x16x32_bf16 v[72:75], a[52:55], a[8:11], v[72:75]
ds_read_b128 a[100:103], v249 offset:12288
v_mfma_f32_16x16x32_bf16 v[76:79], a[56:59], a[8:11], v[76:79]
ds_read_b64_tr_b16 a[138:139], v231 offset:51200
v_mfma_f32_16x16x32_bf16 v[80:83], a[60:63], a[8:11], v[80:83]
v_mfma_f32_16x16x32_bf16 v[84:87], a[64:67], a[8:11], v[84:87]
v_mfma_f32_16x16x32_bf16 v[88:91], a[36:39], a[12:15], v[88:91]
v_mfma_f32_16x16x32_bf16 v[92:95], a[40:43], a[12:15], v[92:95]
v_mfma_f32_16x16x32_bf16 v[96:99], a[44:47], a[12:15], v[96:99]
v_mfma_f32_16x16x32_bf16 v[100:103], a[48:51], a[12:15], v[100:103]
v_mfma_f32_16x16x32_bf16 v[104:107], a[52:55], a[12:15], v[104:107]
v_mfma_f32_16x16x32_bf16 v[108:111], a[56:59], a[12:15], v[108:111]
s_waitcnt lgkmcnt(0)
s_barrier
v_mfma_f32_16x16x32_bf16 v[0:3], a[108:111], a[72:75], v[0:3]
s_add_u32 m0, s98, 0
v_mfma_f32_16x16x32_bf16 v[4:7], a[112:115], a[72:75], v[4:7]
buffer_load_dwordx4 v244, s[8:11], s96 offen offset:0 lds
v_mfma_f32_16x16x32_bf16 v[8:11], a[116:119], a[72:75], v[8:11]
buffer_load_dwordx4 v245, s[8:11], s96 offen offset:1024 lds
v_mfma_f32_16x16x32_bf16 v[12:15], a[120:123], a[72:75], v[12:15]
buffer_load_dwordx4 v246, s[8:11], s96 offen offset:2048 lds
v_mfma_f32_16x16x32_bf16 v[16:19], a[124:127], a[72:75], v[16:19]
buffer_load_dwordx4 v247, s[8:11], s96 offen offset:3072 lds
v_mfma_f32_16x16x32_bf16 v[20:23], a[128:131], a[72:75], v[20:23]
s_add_u32 m0, s98, 4096
v_mfma_f32_16x16x32_bf16 v[24:27], a[132:135], a[72:75], v[24:27]
s_add_u32 s52, s96, 32768
v_mfma_f32_16x16x32_bf16 v[28:31], a[136:139], a[72:75], v[28:31]
buffer_load_dwordx4 v244, s[8:11], s52 offen offset:0 lds
v_mfma_f32_16x16x32_bf16 v[32:35], a[108:111], a[76:79], v[32:35]
buffer_load_dwordx4 v245, s[8:11], s52 offen offset:1024 lds
v_mfma_f32_16x16x32_bf16 v[36:39], a[112:115], a[76:79], v[36:39]
buffer_load_dwordx4 v246, s[8:11], s52 offen offset:2048 lds
v_mfma_f32_16x16x32_bf16 v[40:43], a[116:119], a[76:79], v[40:43]
buffer_load_dwordx4 v247, s[8:11], s52 offen offset:3072 lds
v_mfma_f32_16x16x32_bf16 v[44:47], a[120:123], a[76:79], v[44:47]
s_add_u32 s96, s96, 262144
v_mfma_f32_16x16x32_bf16 v[48:51], a[124:127], a[76:79], v[48:51]
s_add_u32 m0, s98, 32768
v_mfma_f32_16x16x32_bf16 v[52:55], a[128:131], a[76:79], v[52:55]
buffer_load_dwordx4 v244, s[8:11], s96 offen offset:0 lds
v_mfma_f32_16x16x32_bf16 v[56:59], a[108:111], a[80:83], v[56:59]
buffer_load_dwordx4 v245, s[8:11], s96 offen offset:1024 lds
v_mfma_f32_16x16x32_bf16 v[60:63], a[112:115], a[80:83], v[60:63]
buffer_load_dwordx4 v246, s[8:11], s96 offen offset:2048 lds
v_mfma_f32_16x16x32_bf16 v[64:67], a[116:119], a[80:83], v[64:67]
buffer_load_dwordx4 v247, s[8:11], s96 offen offset:3072 lds
v_mfma_f32_16x16x32_bf16 v[68:71], a[120:123], a[80:83], v[68:71]
s_add_u32 m0, s98, 36864
v_lshrrev_b32 v240, 2, v253
v_mfma_f32_16x16x32_bf16 v[72:75], a[124:127], a[80:83], v[72:75]
s_add_u32 s52, s96, 32768
v_mfma_f32_16x16x32_bf16 v[76:79], a[128:131], a[80:83], v[76:79]
buffer_load_dwordx4 v244, s[8:11], s52 offen offset:0 lds
buffer_load_dword a178, v240, s[12:15], s48 offen sc1
v_mfma_f32_16x16x32_bf16 v[80:83], a[132:135], a[80:83], v[80:83]
buffer_load_dwordx4 v245, s[8:11], s52 offen offset:1024 lds
v_mfma_f32_16x16x32_bf16 v[84:87], a[136:139], a[80:83], v[84:87]
buffer_load_dwordx4 v246, s[8:11], s52 offen offset:2048 lds
v_mfma_f32_16x16x32_bf16 v[88:91], a[108:111], a[84:87], v[88:91]
buffer_load_dwordx4 v247, s[8:11], s52 offen offset:3072 lds
v_cvt_pk_bf16_f32 v0, v0, v1
v_cvt_pk_bf16_f32 v1, v2, v3
v_cvt_pk_bf16_f32 v2, v4, v5
v_cvt_pk_bf16_f32 v3, v6, v7
v_mfma_f32_16x16x32_bf16 v[92:95], a[112:115], a[84:87], v[92:95]
s_add_u32 s96, s96, 262144
v_pk_max_i16 v0, v0, 0
v_pk_max_i16 v1, v1, 0
v_pk_max_i16 v2, v2, 0
v_mfma_f32_16x16x32_bf16 v[96:99], a[116:119], a[84:87], v[96:99]
v_pk_max_i16 v3, v3, 0
buffer_store_dwordx4 v[0:3], v250, s[12:15], s60 offen sc1
v_cvt_pk_bf16_f32 v8, v8, v9
v_mfma_f32_16x16x32_bf16 v[100:103], a[120:123], a[84:87], v[100:103]
v_cvt_pk_bf16_f32 v9, v10, v11
v_cvt_pk_bf16_f32 v10, v12, v13
v_cvt_pk_bf16_f32 v11, v14, v15
v_mfma_f32_16x16x32_bf16 v[104:107], a[124:127], a[84:87], v[104:107]
v_pk_max_i16 v8, v8, 0
v_pk_max_i16 v9, v9, 0
v_pk_max_i16 v10, v10, 0
v_mfma_f32_16x16x32_bf16 v[108:111], a[128:131], a[84:87], v[108:111]
v_pk_max_i16 v11, v11, 0
buffer_store_dwordx4 v[8:11], v250, s[12:15], s64 offen sc1
v_cvt_pk_bf16_f32 v16, v16, v17
v_mfma_f32_16x16x32_bf16 v[112:115], a[36:39], a[16:19], v[112:115]
v_cvt_pk_bf16_f32 v17, v18, v19
v_cvt_pk_bf16_f32 v18, v20, v21
v_cvt_pk_bf16_f32 v19, v22, v23
v_mfma_f32_16x16x32_bf16 v[116:119], a[40:43], a[16:19], v[116:119]
v_pk_max_i16 v16, v16, 0
v_pk_max_i16 v17, v17, 0
v_pk_max_i16 v18, v18, 0
v_mfma_f32_16x16x32_bf16 v[120:123], a[44:47], a[16:19], v[120:123]
v_pk_max_i16 v19, v19, 0
buffer_store_dwordx4 v[16:19], v250, s[12:15], s68 offen sc1
v_cvt_pk_bf16_f32 v24, v24, v25
v_mfma_f32_16x16x32_bf16 v[124:127], a[48:51], a[16:19], v[124:127]
v_cvt_pk_bf16_f32 v25, v26, v27
v_cvt_pk_bf16_f32 v26, v28, v29
v_cvt_pk_bf16_f32 v27, v30, v31
v_mfma_f32_16x16x32_bf16 v[128:131], a[52:55], a[16:19], v[128:131]
v_pk_max_i16 v24, v24, 0
v_pk_max_i16 v25, v25, 0
v_pk_max_i16 v26, v26, 0
v_mfma_f32_16x16x32_bf16 v[132:135], a[56:59], a[16:19], v[132:135]
v_pk_max_i16 v27, v27, 0
buffer_store_dwordx4 v[24:27], v250, s[12:15], s72 offen sc1
v_cvt_pk_bf16_f32 v32, v32, v33
v_mfma_f32_16x16x32_bf16 v[136:139], a[60:63], a[16:19], v[136:139]
v_cvt_pk_bf16_f32 v33, v34, v35
v_cvt_pk_bf16_f32 v34, v36, v37
v_cvt_pk_bf16_f32 v35, v38, v39
v_mfma_f32_16x16x32_bf16 v[140:143], a[64:67], a[16:19], v[140:143]
v_pk_max_i16 v32, v32, 0
v_pk_max_i16 v33, v33, 0
v_pk_max_i16 v34, v34, 0
v_mfma_f32_16x16x32_bf16 v[112:115], a[108:111], a[88:91], v[112:115]
v_pk_max_i16 v35, v35, 0
buffer_store_dwordx4 v[32:35], v251, s[12:15], s60 offen sc1
v_mfma_f32_16x16x32_bf16 v[116:119], a[112:115], a[88:91], v[116:119]
v_cvt_pk_bf16_f32 v40, v40, v41
v_cvt_pk_bf16_f32 v41, v42, v43
v_cvt_pk_bf16_f32 v42, v44, v45
v_mfma_f32_16x16x32_bf16 v[120:123], a[116:119], a[88:91], v[120:123]
v_cvt_pk_bf16_f32 v43, v46, v47
v_pk_max_i16 v40, v40, 0
v_pk_max_i16 v41, v41, 0
v_mfma_f32_16x16x32_bf16 v[124:127], a[120:123], a[88:91], v[124:127]
v_pk_max_i16 v42, v42, 0
v_pk_max_i16 v43, v43, 0
buffer_store_dwordx4 v[40:43], v251, s[12:15], s64 offen sc1
v_mfma_f32_16x16x32_bf16 v[128:131], a[124:127], a[88:91], v[128:131]
v_cvt_pk_bf16_f32 v48, v48, v49
v_cvt_pk_bf16_f32 v49, v50, v51
v_cvt_pk_bf16_f32 v50, v52, v53
v_mfma_f32_16x16x32_bf16 v[132:135], a[128:131], a[88:91], v[132:135]
v_cvt_pk_bf16_f32 v51, v54, v55
v_pk_max_i16 v48, v48, 0
v_pk_max_i16 v49, v49, 0
v_mfma_f32_16x16x32_bf16 v[136:139], a[132:135], a[88:91], v[136:139]
v_pk_max_i16 v50, v50, 0
v_pk_max_i16 v51, v51, 0
buffer_store_dwordx4 v[48:51], v251, s[12:15], s68 offen sc1
v_mfma_f32_16x16x32_bf16 v[140:143], a[136:139], a[88:91], v[140:143]
v_cvt_pk_bf16_f32 v56, v56, v57
v_cvt_pk_bf16_f32 v57, v58, v59
v_cvt_pk_bf16_f32 v58, v60, v61
v_mfma_f32_16x16x32_bf16 v[144:147], a[36:39], a[20:23], v[144:147]
v_cvt_pk_bf16_f32 v59, v62, v63
v_pk_max_i16 v56, v56, 0
v_pk_max_i16 v57, v57, 0
v_mfma_f32_16x16x32_bf16 v[148:151], a[40:43], a[20:23], v[148:151]
v_pk_max_i16 v58, v58, 0
v_pk_max_i16 v59, v59, 0
buffer_store_dwordx4 v[56:59], v250, s[12:15], s61 offen sc1
v_mfma_f32_16x16x32_bf16 v[152:155], a[44:47], a[20:23], v[152:155]
v_cvt_pk_bf16_f32 v64, v64, v65
v_cvt_pk_bf16_f32 v65, v66, v67
v_cvt_pk_bf16_f32 v66, v68, v69
v_mfma_f32_16x16x32_bf16 v[156:159], a[48:51], a[20:23], v[156:159]
v_cvt_pk_bf16_f32 v67, v70, v71
v_pk_max_i16 v64, v64, 0
v_pk_max_i16 v65, v65, 0
v_mfma_f32_16x16x32_bf16 v[160:163], a[52:55], a[20:23], v[160:163]
v_pk_max_i16 v66, v66, 0
v_pk_max_i16 v67, v67, 0
buffer_store_dwordx4 v[64:67], v250, s[12:15], s65 offen sc1
v_mfma_f32_16x16x32_bf16 v[164:167], a[56:59], a[20:23], v[164:167]
v_cvt_pk_bf16_f32 v72, v72, v73
v_cvt_pk_bf16_f32 v73, v74, v75
v_cvt_pk_bf16_f32 v74, v76, v77
v_mfma_f32_16x16x32_bf16 v[144:147], a[108:111], a[92:95], v[144:147]
v_cvt_pk_bf16_f32 v75, v78, v79
v_pk_max_i16 v72, v72, 0
v_pk_max_i16 v73, v73, 0
v_mfma_f32_16x16x32_bf16 v[148:151], a[112:115], a[92:95], v[148:151]
v_pk_max_i16 v74, v74, 0
v_pk_max_i16 v75, v75, 0
buffer_store_dwordx4 v[72:75], v250, s[12:15], s69 offen sc1
v_mfma_f32_16x16x32_bf16 v[152:155], a[116:119], a[92:95], v[152:155]
v_cvt_pk_bf16_f32 v80, v80, v81
v_cvt_pk_bf16_f32 v81, v82, v83
v_cvt_pk_bf16_f32 v82, v84, v85
v_mfma_f32_16x16x32_bf16 v[156:159], a[120:123], a[92:95], v[156:159]
v_cvt_pk_bf16_f32 v83, v86, v87
v_pk_max_i16 v80, v80, 0
v_pk_max_i16 v81, v81, 0
v_mfma_f32_16x16x32_bf16 v[160:163], a[124:127], a[92:95], v[160:163]
v_pk_max_i16 v82, v82, 0
v_pk_max_i16 v83, v83, 0
buffer_store_dwordx4 v[80:83], v250, s[12:15], s73 offen sc1
v_mfma_f32_16x16x32_bf16 v[164:167], a[128:131], a[92:95], v[164:167]
v_cvt_pk_bf16_f32 v88, v88, v89
v_cvt_pk_bf16_f32 v89, v90, v91
v_cvt_pk_bf16_f32 v90, v92, v93
v_mfma_f32_16x16x32_bf16 v[168:171], a[36:39], a[24:27], v[168:171]
v_cvt_pk_bf16_f32 v91, v94, v95
v_pk_max_i16 v88, v88, 0
v_pk_max_i16 v89, v89, 0
v_mfma_f32_16x16x32_bf16 v[172:175], a[40:43], a[24:27], v[172:175]
v_pk_max_i16 v90, v90, 0
v_pk_max_i16 v91, v91, 0
buffer_store_dwordx4 v[88:91], v251, s[12:15], s61 offen sc1
v_mfma_f32_16x16x32_bf16 v[176:179], a[44:47], a[24:27], v[176:179]
v_cvt_pk_bf16_f32 v96, v96, v97
v_cvt_pk_bf16_f32 v97, v98, v99
v_cvt_pk_bf16_f32 v98, v100, v101
v_mfma_f32_16x16x32_bf16 v[180:183], a[48:51], a[24:27], v[180:183]
v_cvt_pk_bf16_f32 v99, v102, v103
v_pk_max_i16 v96, v96, 0
v_pk_max_i16 v97, v97, 0
v_mfma_f32_16x16x32_bf16 v[184:187], a[52:55], a[24:27], v[184:187]
v_pk_max_i16 v98, v98, 0
v_pk_max_i16 v99, v99, 0
buffer_store_dwordx4 v[96:99], v251, s[12:15], s65 offen sc1
v_mfma_f32_16x16x32_bf16 v[188:191], a[56:59], a[24:27], v[188:191]
v_cvt_pk_bf16_f32 v104, v104, v105
v_cvt_pk_bf16_f32 v105, v106, v107
v_cvt_pk_bf16_f32 v106, v108, v109
v_mfma_f32_16x16x32_bf16 v[192:195], a[60:63], a[24:27], v[192:195]
v_cvt_pk_bf16_f32 v107, v110, v111
v_pk_max_i16 v104, v104, 0
v_pk_max_i16 v105, v105, 0
v_mfma_f32_16x16x32_bf16 v[196:199], a[64:67], a[24:27], v[196:199]
v_pk_max_i16 v106, v106, 0
v_pk_max_i16 v107, v107, 0
buffer_store_dwordx4 v[104:107], v251, s[12:15], s69 offen sc1
v_mfma_f32_16x16x32_bf16 v[168:171], a[108:111], a[96:99], v[168:171]
v_cvt_pk_bf16_f32 v112, v112, v113
v_cvt_pk_bf16_f32 v113, v114, v115
v_cvt_pk_bf16_f32 v114, v116, v117
v_mfma_f32_16x16x32_bf16 v[172:175], a[112:115], a[96:99], v[172:175]
v_cvt_pk_bf16_f32 v115, v118, v119
v_pk_max_i16 v112, v112, 0
v_pk_max_i16 v113, v113, 0
v_mfma_f32_16x16x32_bf16 v[176:179], a[116:119], a[96:99], v[176:179]
v_pk_max_i16 v114, v114, 0
v_pk_max_i16 v115, v115, 0
buffer_store_dwordx4 v[112:115], v250, s[12:15], s62 offen sc1
v_mfma_f32_16x16x32_bf16 v[180:183], a[120:123], a[96:99], v[180:183]
v_cvt_pk_bf16_f32 v120, v120, v121
v_cvt_pk_bf16_f32 v121, v122, v123
v_cvt_pk_bf16_f32 v122, v124, v125
v_mfma_f32_16x16x32_bf16 v[184:187], a[124:127], a[96:99], v[184:187]
v_cvt_pk_bf16_f32 v123, v126, v127
v_pk_max_i16 v120, v120, 0
v_pk_max_i16 v121, v121, 0
v_mfma_f32_16x16x32_bf16 v[188:191], a[128:131], a[96:99], v[188:191]
v_pk_max_i16 v122, v122, 0
v_pk_max_i16 v123, v123, 0
buffer_store_dwordx4 v[120:123], v250, s[12:15], s66 offen sc1
v_mfma_f32_16x16x32_bf16 v[192:195], a[132:135], a[96:99], v[192:195]
v_cvt_pk_bf16_f32 v128, v128, v129
v_cvt_pk_bf16_f32 v129, v130, v131
v_cvt_pk_bf16_f32 v130, v132, v133
v_mfma_f32_16x16x32_bf16 v[196:199], a[136:139], a[96:99], v[196:199]
v_cvt_pk_bf16_f32 v131, v134, v135
v_pk_max_i16 v128, v128, 0
v_pk_max_i16 v129, v129, 0
v_mfma_f32_16x16x32_bf16 v[200:203], a[36:39], a[28:31], v[200:203]
v_pk_max_i16 v130, v130, 0
v_pk_max_i16 v131, v131, 0
buffer_store_dwordx4 v[128:131], v250, s[12:15], s70 offen sc1
v_mfma_f32_16x16x32_bf16 v[204:207], a[40:43], a[28:31], v[204:207]
v_cvt_pk_bf16_f32 v136, v136, v137
v_cvt_pk_bf16_f32 v137, v138, v139
v_cvt_pk_bf16_f32 v138, v140, v141
v_mfma_f32_16x16x32_bf16 v[208:211], a[44:47], a[28:31], v[208:211]
v_cvt_pk_bf16_f32 v139, v142, v143
v_pk_max_i16 v136, v136, 0
v_pk_max_i16 v137, v137, 0
v_mfma_f32_16x16x32_bf16 v[212:215], a[48:51], a[28:31], v[212:215]
v_pk_max_i16 v138, v138, 0
v_pk_max_i16 v139, v139, 0
buffer_store_dwordx4 v[136:139], v250, s[12:15], s74 offen sc1
v_mfma_f32_16x16x32_bf16 v[216:219], a[52:55], a[28:31], v[216:219]
v_cvt_pk_bf16_f32 v144, v144, v145
v_cvt_pk_bf16_f32 v145, v146, v147
v_cvt_pk_bf16_f32 v146, v148, v149
v_mfma_f32_16x16x32_bf16 v[220:223], a[56:59], a[28:31], v[220:223]
v_cvt_pk_bf16_f32 v147, v150, v151
v_pk_max_i16 v144, v144, 0
v_pk_max_i16 v145, v145, 0
v_pk_max_i16 v146, v146, 0
v_mfma_f32_16x16x32_bf16 v[200:203], a[108:111], a[100:103], v[200:203]
v_pk_max_i16 v147, v147, 0
buffer_store_dwordx4 v[144:147], v251, s[12:15], s62 offen sc1
v_cvt_pk_bf16_f32 v152, v152, v153
v_mfma_f32_16x16x32_bf16 v[204:207], a[112:115], a[100:103], v[204:207]
v_cvt_pk_bf16_f32 v153, v154, v155
v_cvt_pk_bf16_f32 v154, v156, v157
v_cvt_pk_bf16_f32 v155, v158, v159
v_mfma_f32_16x16x32_bf16 v[208:211], a[116:119], a[100:103], v[208:211]
v_pk_max_i16 v152, v152, 0
v_pk_max_i16 v153, v153, 0
v_pk_max_i16 v154, v154, 0
v_mfma_f32_16x16x32_bf16 v[212:215], a[120:123], a[100:103], v[212:215]
v_pk_max_i16 v155, v155, 0
buffer_store_dwordx4 v[152:155], v251, s[12:15], s66 offen sc1
v_cvt_pk_bf16_f32 v160, v160, v161
v_mfma_f32_16x16x32_bf16 v[216:219], a[124:127], a[100:103], v[216:219]
v_cvt_pk_bf16_f32 v161, v162, v163
v_cvt_pk_bf16_f32 v162, v164, v165
v_cvt_pk_bf16_f32 v163, v166, v167
v_mfma_f32_16x16x32_bf16 v[220:223], a[128:131], a[100:103], v[220:223]
v_pk_max_i16 v160, v160, 0
v_pk_max_i16 v161, v161, 0
v_pk_max_i16 v162, v162, 0
v_pk_max_i16 v163, v163, 0
buffer_store_dwordx4 v[160:163], v251, s[12:15], s70 offen sc1
v_cvt_pk_bf16_f32 v168, v168, v169
v_cvt_pk_bf16_f32 v169, v170, v171
v_cvt_pk_bf16_f32 v170, v172, v173
v_cvt_pk_bf16_f32 v171, v174, v175
v_pk_max_i16 v168, v168, 0
v_pk_max_i16 v169, v169, 0
v_pk_max_i16 v170, v170, 0
v_pk_max_i16 v171, v171, 0
buffer_store_dwordx4 v[168:171], v250, s[12:15], s63 offen sc1
v_cvt_pk_bf16_f32 v176, v176, v177
v_cvt_pk_bf16_f32 v177, v178, v179
v_cvt_pk_bf16_f32 v178, v180, v181
v_cvt_pk_bf16_f32 v179, v182, v183
v_pk_max_i16 v176, v176, 0
v_pk_max_i16 v177, v177, 0
v_pk_max_i16 v178, v178, 0
v_pk_max_i16 v179, v179, 0
buffer_store_dwordx4 v[176:179], v250, s[12:15], s67 offen sc1
v_cvt_pk_bf16_f32 v184, v184, v185
v_cvt_pk_bf16_f32 v185, v186, v187
v_cvt_pk_bf16_f32 v186, v188, v189
v_cvt_pk_bf16_f32 v187, v190, v191
v_pk_max_i16 v184, v184, 0
v_pk_max_i16 v185, v185, 0
v_pk_max_i16 v186, v186, 0
v_pk_max_i16 v187, v187, 0
buffer_store_dwordx4 v[184:187], v250, s[12:15], s71 offen sc1
v_cvt_pk_bf16_f32 v192, v192, v193
v_cvt_pk_bf16_f32 v193, v194, v195
v_cvt_pk_bf16_f32 v194, v196, v197
v_cvt_pk_bf16_f32 v195, v198, v199
v_pk_max_i16 v192, v192, 0
v_pk_max_i16 v193, v193, 0
v_pk_max_i16 v194, v194, 0
v_pk_max_i16 v195, v195, 0
buffer_store_dwordx4 v[192:195], v250, s[12:15], s75 offen sc1
v_cvt_pk_bf16_f32 v200, v200, v201
v_cvt_pk_bf16_f32 v201, v202, v203
v_cvt_pk_bf16_f32 v202, v204, v205
v_cvt_pk_bf16_f32 v203, v206, v207
v_pk_max_i16 v200, v200, 0
v_pk_max_i16 v201, v201, 0
v_pk_max_i16 v202, v202, 0
v_pk_max_i16 v203, v203, 0
buffer_store_dwordx4 v[200:203], v251, s[12:15], s63 offen sc1
v_cvt_pk_bf16_f32 v208, v208, v209
v_cvt_pk_bf16_f32 v209, v210, v211
v_cvt_pk_bf16_f32 v210, v212, v213
v_cvt_pk_bf16_f32 v211, v214, v215
v_pk_max_i16 v208, v208, 0
v_pk_max_i16 v209, v209, 0
v_pk_max_i16 v210, v210, 0
v_pk_max_i16 v211, v211, 0
buffer_store_dwordx4 v[208:211], v251, s[12:15], s67 offen sc1
v_cvt_pk_bf16_f32 v216, v216, v217
v_cvt_pk_bf16_f32 v217, v218, v219
v_cvt_pk_bf16_f32 v218, v220, v221
v_cvt_pk_bf16_f32 v219, v222, v223
v_pk_max_i16 v216, v216, 0
v_pk_max_i16 v217, v217, 0
v_pk_max_i16 v218, v218, 0
v_pk_max_i16 v219, v219, 0
buffer_store_dwordx4 v[216:219], v251, s[12:15], s71 offen sc1
s_waitcnt vmcnt(31)
s_nop 0
s_branch L2_start
L1_Q:
s_and_b32 s51, s20, 1
s_lshl_b32 s51, s51, 1
v_add_u32 v0, 0, v254
v_mul_u32_u24 v1, 2731, v0
v_lshrrev_b32 v1, 16, v1
v_mul_u32_u24 v2, 24, v1
v_sub_u32 v2, v0, v2
v_lshrrev_b32 v3, 3, v2
v_and_b32 v2, 7, v2
v_lshlrev_b32 v4, 1, v1
v_and_b32 v4, 4, v4
v_or_b32 v4, s51, v4
v_xor_b32 v2, v2, v4
v_lshlrev_b32 v2, 4, v2
v_lshl_add_u32 v2, v3, 11, v2
v_mul_u32_u24 v1, 6144, v1
v_add_u32 v2, v2, v1
v_subrev_u32 v236, 0, v2
v_add_u32 v0, 64, v254
v_mul_u32_u24 v1, 2731, v0
v_lshrrev_b32 v1, 16, v1
v_mul_u32_u24 v2, 24, v1
v_sub_u32 v2, v0, v2
v_lshrrev_b32 v3, 3, v2
v_and_b32 v2, 7, v2
v_lshlrev_b32 v4, 1, v1
v_and_b32 v4, 4, v4
v_or_b32 v4, s51, v4
v_xor_b32 v2, v2, v4
v_lshlrev_b32 v2, 4, v2
v_lshl_add_u32 v2, v3, 11, v2
v_mul_u32_u24 v1, 6144, v1
v_add_u32 v2, v2, v1
v_subrev_u32 v237, 1024, v2
v_add_u32 v0, 128, v254
v_mul_u32_u24 v1, 2731, v0
v_lshrrev_b32 v1, 16, v1
v_mul_u32_u24 v2, 24, v1
v_sub_u32 v2, v0, v2
v_lshrrev_b32 v3, 3, v2
v_and_b32 v2, 7, v2
v_lshlrev_b32 v4, 1, v1
v_and_b32 v4, 4, v4
v_or_b32 v4, s51, v4
v_xor_b32 v2, v2, v4
v_lshlrev_b32 v2, 4, v2
v_lshl_add_u32 v2, v3, 11, v2
v_mul_u32_u24 v1, 6144, v1
v_add_u32 v2, v2, v1
v_subrev_u32 v238, 2048, v2
s_and_b32 s52, s20, 1
v_lshrrev_b32 v0, 3, v254
v_lshlrev_b32 v0, 12, v0
v_lshrrev_b32 v1, 4, v254
s_lshl_b32 s53, s52, 2
v_or_b32 v1, s53, v1
v_and_b32 v2, 7, v254
v_xor_b32 v1, v1, v2
v_lshl_add_u32 v0, v1, 4, v0
s_lshl_b32 s53, s52, 11
v_add_u32 v228, s53, v0
s_lshl_b32 s50, s52, 10
s_add_u32 s50, s50, 32768
s_lshl_b32 s49, s21, 8
s_max_u32 s49, s49, 16
s_sub_u32 s49, s49, 16
s_lshl_b32 s49, s49, 11
s_mov_b32 s38, 49152
s_mul_i32 s43, s20, 3072
s_mul_i32 s41, s20, 49152
s_mul_i32 s51, s22, 128
s_add_u32 s41, s41, s51
s_mov_b32 s53, 34816
s_mov_b32 s54, -69632
s_mov_b32 s45, s53
s_mov_b32 s46, 0
s_waitcnt lgkmcnt(0)
s_mov_b32 s4, s60
s_and_b32 s5, s61, 0xffff
s_mov_b32 s6, 0x400000
s_mov_b32 s7, 0x20000
s_mov_b32 s8, s62
s_and_b32 s9, s63, 0xffff
s_mov_b32 s10, 0x600000
s_mov_b32 s11, 0x20000
s_add_u32 m0, s38, s39
s_nop 0
buffer_load_dwordx4 v234, s[4:7], s36 offen offset:0 lds
buffer_load_dwordx4 v235, s[4:7], s36 offen offset:1024 lds
buffer_load_dwordx4 v234, s[4:7], s36 offen offset:2048 lds
buffer_load_dwordx4 v235, s[4:7], s36 offen offset:3072 lds
s_add_u32 s36, s36, 128
s_add_u32 m0, s38, s40
s_nop 0
buffer_load_dwordx4 v234, s[4:7], s37 offen offset:0 lds
buffer_load_dwordx4 v235, s[4:7], s37 offen offset:1024 lds
buffer_load_dwordx4 v234, s[4:7], s37 offen offset:2048 lds
buffer_load_dwordx4 v235, s[4:7], s37 offen offset:3072 lds
s_add_u32 s37, s37, 128
s_add_u32 m0, s38, s50
s_nop 0
buffer_load_dwordx4 v228, s[4:7], s49 offen lds
s_add_u32 s49, s49, 128
s_add_u32 s38, s38, 34816
s_cmp_ge_u32 s38, 153600
s_cselect_b32 s38, 49152, s38
s_add_u32 m0, s43, 0
s_nop 0
buffer_load_dwordx4 v236, s[8:11], s41 offen offset:0 lds
buffer_load_dwordx4 v237, s[8:11], s41 offen offset:1024 lds
buffer_load_dwordx4 v238, s[8:11], s41 offen offset:2048 lds
s_add_u32 s41, s41, 196608
v_and_b32 v0, 15, v254
v_lshrrev_b32 v1, 4, v254
v_lshrrev_b32 v2, 1, v0
v_xor_b32 v2, v2, v1
v_lshlrev_b32 v2, 4, v2
v_lshl_add_u32 v2, v0, 7, v2
s_lshr_b32 s51, s20, 1
s_lshl_b32 s52, s51, 14
s_add_u32 s52, s52, 49152
v_add_u32 v232, s52, v2
v_xor_b32 v233, 64, v232
v_bfe_u32 v3, v254, 2, 2
v_and_b32 v4, 3, v254
v_lshlrev_b32 v4, 3, v4
v_lshl_add_u32 v5, v1, 3, v3
s_and_b32 s52, s20, 1
v_mul_u32_u24 v5, 384, v5
v_add_u32 v4, v4, v5
v_and_b32 v6, 1, v1
v_and_b32 v7, 2, v3
v_or_b32 v6, v6, v7
s_lshl_b32 s58, s52, 1
s_add_u32 s59, s58, 0
v_xor_b32 v7, s59, v6
v_lshl_add_u32 v224, v7, 5, v4
s_add_u32 s59, s58, 1
v_xor_b32 v7, s59, v6
v_lshl_add_u32 v225, v7, 5, v4
v_cmp_gt_u32 vcc, 8, v0
v_mov_b32 v7, 112
v_mov_b32 v8, 104
v_cndmask_b32 v7, v7, v8, vcc
s_cmp_eq_u32 s51, 0
s_cselect_b64 vcc, -1, 0
v_mov_b32 v8, 256
v_cndmask_b32 v7, v7, v8, vcc
v_add_u32 v7, v7, v0
v_bfe_u32 v8, v7, 1, 3
v_xor_b32 v8, v8, v1
v_lshlrev_b32 v8, 4, v8
v_lshl_add_u32 v8, v7, 7, v8
v_add_u32 v226, 49152, v8
v_xor_b32 v227, 64, v226
s_add_u32 m0, s38, s39
s_nop 0
buffer_load_dwordx4 v234, s[4:7], s36 offen offset:0 lds
buffer_load_dwordx4 v235, s[4:7], s36 offen offset:1024 lds
buffer_load_dwordx4 v234, s[4:7], s36 offen offset:2048 lds
buffer_load_dwordx4 v235, s[4:7], s36 offen offset:3072 lds
s_add_u32 s36, s36, 128
s_add_u32 m0, s43, 12288
s_nop 0
buffer_load_dwordx4 v236, s[8:11], s41 offen offset:0 lds
buffer_load_dwordx4 v237, s[8:11], s41 offen offset:1024 lds
buffer_load_dwordx4 v238, s[8:11], s41 offen offset:2048 lds
s_add_u32 s41, s41, 196608
s_mov_b32 s12, s78
s_and_b32 s13, s79, 0xffff
s_mov_b32 s14, 0x10000000
s_mov_b32 s15, 0x20000
s_mov_b32 s16, s72
s_and_b32 s17, s73, 0xffff
s_mov_b32 s18, 0x800
s_mov_b32 s19, 0x20000
s_mov_b64 s[24:25], s[64:65]
s_mov_b64 s[26:27], s[70:71]
s_mov_b64 s[28:29], s[74:75]
s_mov_b64 s[30:31], s[76:77]
s_mov_b64 s[32:33], s[78:79]
s_lshl_b32 s51, s2, 2
s_add_u32 s51, s51, s20
s_cmp_lt_u32 s51, 832
s_cselect_b64 s[0:1], s[68:69], s[64:65]
s_mov_b32 s92, 2097152
s_cselect_b32 s92, 7340032, s92
s_mov_b32 s93, 196608
s_cselect_b32 s93, 458752, s93
s_mov_b32 s94, 832
s_cselect_b32 s94, 384, s94
s_cselect_b32 s59, 4, 0
s_cmp_lt_u32 s51, 384
s_cselect_b64 s[0:1], s[62:63], s[0:1]
s_cselect_b32 s92, 6291456, s92
s_cselect_b32 s93, 393216, s93
s_cselect_b32 s94, 0, s94
s_sub_u32 s94, s51, s94
s_lshl_b32 s94, s94, 10
s_mul_i32 s59, s59, s93
s_add_u32 s94, s94, s59
s_add_u32 m0, s38, s40
s_nop 0
buffer_load_dwordx4 v234, s[4:7], s37 offen offset:0 lds
buffer_load_dwordx4 v235, s[4:7], s37 offen offset:1024 lds
buffer_load_dwordx4 v234, s[4:7], s37 offen offset:2048 lds
buffer_load_dwordx4 v235, s[4:7], s37 offen offset:3072 lds
s_add_u32 s37, s37, 128
s_add_u32 m0, s38, s50
s_nop 0
buffer_load_dwordx4 v228, s[4:7], s49 offen lds
s_add_u32 s49, s49, 128
s_add_u32 s38, s38, 34816
s_cmp_ge_u32 s38, 153600
s_cselect_b32 s38, 49152, s38
s_add_u32 m0, s43, 24576
s_nop 0
buffer_load_dwordx4 v236, s[8:11], s41 offen offset:0 lds
buffer_load_dwordx4 v237, s[8:11], s41 offen offset:1024 lds
buffer_load_dwordx4 v238, s[8:11], s41 offen offset:2048 lds
s_add_u32 s41, s41, 196608
s_lshr_b32 s51, s20, 1
v_lshlrev_b32 v7, 2, v1
v_sub_u32 v7, v0, v7
s_or_b32 s58, s21, s51
v_subrev_u32 v8, 0, v7
v_cmp_gt_u32 s[60:61], 8, v8
v_cmp_gt_i32 s[68:69], -8, v8
v_cmp_gt_i32 s[76:77], 0, v8
v_subrev_u32 v8, 1, v7
v_cmp_gt_u32 s[62:63], 8, v8
v_cmp_gt_i32 s[70:71], -8, v8
v_cmp_gt_i32 s[78:79], 0, v8
v_subrev_u32 v8, 2, v7
v_cmp_gt_u32 s[64:65], 8, v8
v_cmp_gt_i32 s[72:73], -8, v8
v_cmp_gt_i32 s[80:81], 0, v8
v_subrev_u32 v8, 3, v7
v_cmp_gt_u32 s[66:67], 8, v8
v_cmp_gt_i32 s[74:75], -8, v8
v_cmp_gt_i32 s[82:83], 0, v8
s_nop 1
s_cmp_eq_u32 s58, 0
s_mov_b32 s77, 0
s_cselect_b32 s76, 0, s76
s_cselect_b64 s[84:85], 0, s[68:69]
s_mov_b32 s79, 0
s_cselect_b32 s78, 0, s78
s_cselect_b64 s[86:87], 0, s[70:71]
s_mov_b32 s81, 0
s_cselect_b32 s80, 0, s80
s_cselect_b64 s[88:89], 0, s[72:73]
s_mov_b32 s83, 0
s_cselect_b32 s82, 0, s82
s_cselect_b64 s[90:91], 0, s[74:75]
v_mov_b32 v8, 0xffff0000
v_mov_b32 v9, 0xffff
v_cndmask_b32 v10, 0, v9, s[60:61]
v_cndmask_b32 v11, 0, v8, s[62:63]
v_or_b32 v10, v10, v11
v_accvgpr_write_b32 a170, v10
v_cndmask_b32 v10, 0, v9, s[64:65]
v_cndmask_b32 v11, 0, v8, s[66:67]
v_or_b32 v10, v10, v11
v_accvgpr_write_b32 a171, v10
v_cndmask_b32 v10, 0, v9, s[68:69]
v_cndmask_b32 v11, 0, v8, s[70:71]
v_or_b32 v10, v10, v11
v_accvgpr_write_b32 a172, v10
v_cndmask_b32 v10, 0, v9, s[72:73]
v_cndmask_b32 v11, 0, v8, s[74:75]
v_or_b32 v10, v10, v11
v_accvgpr_write_b32 a173, v10
v_cndmask_b32 v10, 0, v9, s[76:77]
v_cndmask_b32 v11, 0, v8, s[78:79]
v_or_b32 v10, v10, v11
v_accvgpr_write_b32 a174, v10
v_cndmask_b32 v10, 0, v9, s[80:81]
v_cndmask_b32 v11, 0, v8, s[82:83]
v_or_b32 v10, v10, v11
v_accvgpr_write_b32 a175, v10
v_cndmask_b32 v10, 0, v9, s[84:85]
v_cndmask_b32 v11, 0, v8, s[86:87]
v_or_b32 v10, v10, v11
v_accvgpr_write_b32 a176, v10
v_cndmask_b32 v10, 0, v9, s[88:89]
v_cndmask_b32 v11, 0, v8, s[90:91]
v_or_b32 v10, v10, v11
v_accvgpr_write_b32 a177, v10
v_lshlrev_b32 v253, 4, v254
s_waitcnt vmcnt(15) lgkmcnt(0)
s_barrier
ds_read_b64_tr_b16 a[36:37], v224 offset:0
ds_read_b128 a[0:3], v232 offset:0
ds_read_b64_tr_b16 a[38:39], v224 offset:1536
ds_read_b64_tr_b16 a[40:41], v225 offset:0
ds_read_b128 a[4:7], v232 offset:2048
ds_read_b64_tr_b16 a[42:43], v225 offset:1536
ds_read_b128 a[8:11], v232 offset:4096
ds_read_b64_tr_b16 a[44:45], v224 offset:128
ds_read_b128 a[12:15], v232 offset:6144
ds_read_b64_tr_b16 a[46:47], v224 offset:1664
ds_read_b64_tr_b16 a[48:49], v225 offset:128
ds_read_b128 a[16:19], v232 offset:8192
ds_read_b64_tr_b16 a[50:51], v225 offset:1664
ds_read_b128 a[20:23], v232 offset:10240
ds_read_b64_tr_b16 a[52:53], v224 offset:256
ds_read_b128 a[24:27], v232 offset:12288
ds_read_b64_tr_b16 a[54:55], v224 offset:1792
ds_read_b64_tr_b16 a[56:57], v225 offset:256
ds_read_b128 a[28:31], v232 offset:14336
ds_read_b64_tr_b16 a[58:59], v225 offset:1792
ds_read_b128 a[32:35], v226
v_add_u32 v232, s45, v232
v_add_u32 v226, s45, v226
s_or_b32 s51, s2, s20
s_cmp_eq_u32 s51, 0
s_cbranch_scc0 L1_nononce
s_memrealtime s[58:59]
s_mov_b32 s96, s30
s_and_b32 s97, s31, 0xffff
s_mov_b32 s98, 0x100
s_mov_b32 s99, 0x20000
s_waitcnt lgkmcnt(0)
s_or_b32 s58, s58, 1
v_mov_b32 v240, s58
v_mov_b32 v241, s59
v_mov_b32 v242, 0
buffer_store_dwordx2 v[240:241], v242, s[96:99], 0 offen sc1
L1_nononce:
s_waitcnt vmcnt(8) lgkmcnt(0)
s_barrier
v_mfma_f32_16x16x32_bf16 v[0:3], a[36:39], a[0:3], 0
ds_read_b64_tr_b16 a[108:109], v224 offset:12288
v_mfma_f32_16x16x32_bf16 v[4:7], a[40:43], a[0:3], 0
ds_read_b128 a[72:75], v233 offset:0
s_add_u32 m0, s38, s39
v_mfma_f32_16x16x32_bf16 v[64:67], a[44:47], a[0:3], 0
buffer_load_dwordx4 v234, s[4:7], s36 offen offset:0 lds
v_mfma_f32_16x16x32_bf16 v[68:71], a[48:51], a[0:3], 0
ds_read_b64_tr_b16 a[110:111], v224 offset:13824
buffer_load_dwordx4 v235, s[4:7], s36 offen offset:1024 lds
v_mfma_f32_16x16x32_bf16 v[136:139], a[0:3], a[52:55], 0
v_mfma_f32_16x16x32_bf16 v[140:143], a[0:3], a[56:59], 0
ds_read_b64_tr_b16 a[112:113], v225 offset:12288
v_mfma_f32_16x16x32_bf16 v[8:11], a[36:39], a[4:7], 0
buffer_load_dwordx4 v234, s[4:7], s36 offen offset:2048 lds
v_mfma_f32_16x16x32_bf16 v[12:15], a[40:43], a[4:7], 0
ds_read_b128 a[76:79], v233 offset:2048
v_mfma_f32_16x16x32_bf16 v[72:75], a[44:47], a[4:7], 0
v_mfma_f32_16x16x32_bf16 v[76:79], a[48:51], a[4:7], 0
ds_read_b64_tr_b16 a[114:115], v225 offset:13824
buffer_load_dwordx4 v235, s[4:7], s36 offen offset:3072 lds
v_mfma_f32_16x16x32_bf16 v[144:147], a[4:7], a[52:55], 0
s_add_u32 s36, s36, 128
s_add_u32 m0, s43, 36864
v_mfma_f32_16x16x32_bf16 v[148:151], a[4:7], a[56:59], 0
ds_read_b128 a[80:83], v233 offset:4096
v_mfma_f32_16x16x32_bf16 v[16:19], a[36:39], a[8:11], 0
v_mfma_f32_16x16x32_bf16 v[20:23], a[40:43], a[8:11], 0
ds_read_b64_tr_b16 a[116:117], v224 offset:12416
buffer_load_dwordx4 v236, s[8:11], s41 offen offset:0 lds
v_mfma_f32_16x16x32_bf16 v[80:83], a[44:47], a[8:11], 0
v_mfma_f32_16x16x32_bf16 v[84:87], a[48:51], a[8:11], 0
ds_read_b128 a[84:87], v233 offset:6144
buffer_load_dwordx4 v237, s[8:11], s41 offen offset:1024 lds
v_mfma_f32_16x16x32_bf16 v[152:155], a[8:11], a[52:55], 0
v_mfma_f32_16x16x32_bf16 v[156:159], a[8:11], a[56:59], 0
ds_read_b64_tr_b16 a[118:119], v224 offset:13952
v_mfma_f32_16x16x32_bf16 v[24:27], a[36:39], a[12:15], 0
buffer_load_dwordx4 v238, s[8:11], s41 offen offset:2048 lds
s_add_u32 s41, s41, 196608
v_mfma_f32_16x16x32_bf16 v[28:31], a[40:43], a[12:15], 0
ds_read_b64_tr_b16 a[120:121], v225 offset:12416
s_add_u32 m0, s38, s40
v_mfma_f32_16x16x32_bf16 v[88:91], a[44:47], a[12:15], 0
ds_read_b128 a[88:91], v233 offset:8192
v_mfma_f32_16x16x32_bf16 v[92:95], a[48:51], a[12:15], 0
v_mfma_f32_16x16x32_bf16 v[160:163], a[12:15], a[52:55], 0
ds_read_b64_tr_b16 a[122:123], v225 offset:13952
buffer_load_dwordx4 v234, s[4:7], s37 offen offset:0 lds
v_mfma_f32_16x16x32_bf16 v[164:167], a[12:15], a[56:59], 0
v_mfma_f32_16x16x32_bf16 v[32:35], a[36:39], a[16:19], 0
ds_read_b128 a[92:95], v233 offset:10240
buffer_load_dwordx4 v235, s[4:7], s37 offen offset:1024 lds
v_mfma_f32_16x16x32_bf16 v[36:39], a[40:43], a[16:19], 0
v_mfma_f32_16x16x32_bf16 v[96:99], a[44:47], a[16:19], 0
ds_read_b64_tr_b16 a[124:125], v224 offset:12544
v_mfma_f32_16x16x32_bf16 v[100:103], a[48:51], a[16:19], 0
buffer_load_dwordx4 v234, s[4:7], s37 offen offset:2048 lds
v_mfma_f32_16x16x32_bf16 v[168:171], a[16:19], a[52:55], 0
ds_read_b128 a[96:99], v233 offset:12288
v_mfma_f32_16x16x32_bf16 v[172:175], a[16:19], a[56:59], 0
v_mfma_f32_16x16x32_bf16 v[40:43], a[36:39], a[20:23], 0
ds_read_b64_tr_b16 a[126:127], v224 offset:14080
buffer_load_dwordx4 v235, s[4:7], s37 offen offset:3072 lds
v_mfma_f32_16x16x32_bf16 v[44:47], a[40:43], a[20:23], 0
s_add_u32 s37, s37, 128
s_add_u32 m0, s38, s50
v_mfma_f32_16x16x32_bf16 v[104:107], a[44:47], a[20:23], 0
ds_read_b64_tr_b16 a[128:129], v225 offset:12544
v_mfma_f32_16x16x32_bf16 v[108:111], a[48:51], a[20:23], 0
v_mfma_f32_16x16x32_bf16 v[176:179], a[20:23], a[52:55], 0
ds_read_b128 a[100:103], v233 offset:14336
buffer_load_dwordx4 v228, s[4:7], s49 offen lds
v_mfma_f32_16x16x32_bf16 v[180:183], a[20:23], a[56:59], 0
s_add_u32 s49, s49, 128
s_add_u32 s38, s38, 34816
v_mfma_f32_16x16x32_bf16 v[48:51], a[36:39], a[24:27], 0
ds_read_b64_tr_b16 a[130:131], v225 offset:14080
s_cmp_ge_u32 s38, 153600
v_mfma_f32_16x16x32_bf16 v[52:55], a[40:43], a[24:27], 0
s_cselect_b32 s38, 49152, s38
s_add_u32 m0, s43, 0
v_mfma_f32_16x16x32_bf16 v[112:115], a[44:47], a[24:27], 0
ds_read_b128 a[104:107], v227
buffer_load_dwordx4 v236, s[8:11], s41 offen offset:0 lds
v_mfma_f32_16x16x32_bf16 v[116:119], a[48:51], a[24:27], 0
buffer_load_dwordx4 v237, s[8:11], s41 offen offset:1024 lds
v_mfma_f32_16x16x32_bf16 v[184:187], a[24:27], a[52:55], 0
v_add_u32 v233, s45, v233
v_mfma_f32_16x16x32_bf16 v[188:191], a[24:27], a[56:59], 0
v_add_u32 v227, s45, v227
v_mfma_f32_16x16x32_bf16 v[56:59], a[36:39], a[28:31], 0
buffer_load_dwordx4 v238, s[8:11], s41 offen offset:2048 lds
s_add_u32 s41, s41, 196608
v_mfma_f32_16x16x32_bf16 v[60:63], a[40:43], a[28:31], 0
s_lshl_b32 s51, s21, 5
s_add_u32 s51, s51, s95
v_mfma_f32_16x16x32_bf16 v[120:123], a[44:47], a[28:31], 0
s_lshl_b32 s51, s51, 2
s_add_u32 s51, s51, s20
v_mfma_f32_16x16x32_bf16 v[124:127], a[48:51], a[28:31], 0
s_lshl_b32 s3, s51, 7
s_lshl_b32 s57, s51, 12
v_mfma_f32_16x16x32_bf16 v[192:195], a[28:31], a[52:55], 0
s_add_u32 s3, s3, 0x1400000
s_lshl_b32 s51, s2, 2
v_mfma_f32_16x16x32_bf16 v[196:199], a[28:31], a[56:59], 0
s_add_u32 s51, s51, s20
s_lshl_b32 s35, s51, 10
v_mfma_f32_16x16x32_bf16 v[128:131], a[44:47], a[32:35], 0
s_mov_b32 s96, s0
s_and_b32 s97, s1, 0xffff
v_mfma_f32_16x16x32_bf16 v[132:135], a[48:51], a[32:35], 0
s_mov_b32 s98, s92
s_mov_b32 s99, 0x20000
v_mfma_f32_16x16x32_bf16 v[200:203], a[32:35], a[52:55], 0
s_add_u32 s46, s46, s45
v_mfma_f32_16x16x32_bf16 v[204:207], a[32:35], a[56:59], 0
s_cmp_eq_u32 s46, 69632
s_cselect_b32 s45, s54, s53
s_waitcnt vmcnt(15) lgkmcnt(0)
s_barrier
v_mfma_f32_16x16x32_bf16 v[0:3], a[108:111], a[72:75], v[0:3]
ds_read_b64_tr_b16 a[36:37], v224 offset:24576
v_mfma_f32_16x16x32_bf16 v[4:7], a[112:115], a[72:75], v[4:7]
ds_read_b128 a[0:3], v232 offset:0
v_mfma_f32_16x16x32_bf16 v[64:67], a[116:119], a[72:75], v[64:67]
buffer_load_dwordx4 a[144:147], v253, s[4:7], s57 offen offset:0
v_mfma_f32_16x16x32_bf16 v[68:71], a[120:123], a[72:75], v[68:71]
ds_read_b64_tr_b16 a[38:39], v224 offset:26112
v_mfma_f32_16x16x32_bf16 v[136:139], a[72:75], a[124:127], v[136:139]
buffer_load_dwordx4 a[148:151], v253, s[4:7], s57 offen offset:1024
v_mfma_f32_16x16x32_bf16 v[140:143], a[72:75], a[128:131], v[140:143]
ds_read_b64_tr_b16 a[40:41], v225 offset:24576
v_mfma_f32_16x16x32_bf16 v[8:11], a[108:111], a[76:79], v[8:11]
v_mfma_f32_16x16x32_bf16 v[12:15], a[112:115], a[76:79], v[12:15]
ds_read_b128 a[4:7], v232 offset:2048
v_mfma_f32_16x16x32_bf16 v[72:75], a[116:119], a[76:79], v[72:75]
buffer_load_dwordx4 a[152:155], v253, s[4:7], s57 offen offset:2048
v_mfma_f32_16x16x32_bf16 v[76:79], a[120:123], a[76:79], v[76:79]
ds_read_b64_tr_b16 a[42:43], v225 offset:26112
v_mfma_f32_16x16x32_bf16 v[144:147], a[76:79], a[124:127], v[144:147]
buffer_load_dwordx4 a[156:159], v253, s[4:7], s57 offen offset:3072
v_mfma_f32_16x16x32_bf16 v[148:151], a[76:79], a[128:131], v[148:151]
ds_read_b128 a[8:11], v232 offset:4096
v_mfma_f32_16x16x32_bf16 v[16:19], a[108:111], a[80:83], v[16:19]
v_mfma_f32_16x16x32_bf16 v[20:23], a[112:115], a[80:83], v[20:23]
ds_read_b64_tr_b16 a[44:45], v224 offset:24704
v_mfma_f32_16x16x32_bf16 v[80:83], a[116:119], a[80:83], v[80:83]
buffer_load_dwordx4 a[160:163], v253, s[16:19], 0 offen offset:0
v_mfma_f32_16x16x32_bf16 v[84:87], a[120:123], a[80:83], v[84:87]
ds_read_b128 a[12:15], v232 offset:6144
v_mfma_f32_16x16x32_bf16 v[152:155], a[80:83], a[124:127], v[152:155]
buffer_load_dwordx4 a[164:167], v253, s[16:19], 0 offen offset:1024
v_mfma_f32_16x16x32_bf16 v[156:159], a[80:83], a[128:131], v[156:159]
ds_read_b64_tr_b16 a[46:47], v224 offset:26240
v_mfma_f32_16x16x32_bf16 v[24:27], a[108:111], a[84:87], v[24:27]
v_mfma_f32_16x16x32_bf16 v[28:31], a[112:115], a[84:87], v[28:31]
ds_read_b64_tr_b16 a[48:49], v225 offset:24704
v_mfma_f32_16x16x32_bf16 v[88:91], a[116:119], a[84:87], v[88:91]
ds_read_b128 a[16:19], v232 offset:8192
v_mfma_f32_16x16x32_bf16 v[92:95], a[120:123], a[84:87], v[92:95]
buffer_load_dwordx4 a[252:255], v253, s[96:99], s94 offen
v_mfma_f32_16x16x32_bf16 v[160:163], a[84:87], a[124:127], v[160:163]
ds_read_b64_tr_b16 a[50:51], v225 offset:26240
v_mfma_f32_16x16x32_bf16 v[164:167], a[84:87], a[128:131], v[164:167]
s_add_u32 s94, s94, s93
v_mfma_f32_16x16x32_bf16 v[32:35], a[108:111], a[88:91], v[32:35]
ds_read_b128 a[20:23], v232 offset:10240
v_mfma_f32_16x16x32_bf16 v[36:39], a[112:115], a[88:91], v[36:39]
s_add_u32 m0, s38, s39
v_mfma_f32_16x16x32_bf16 v[96:99], a[116:119], a[88:91], v[96:99]
ds_read_b64_tr_b16 a[52:53], v224 offset:24832
v_mfma_f32_16x16x32_bf16 v[100:103], a[120:123], a[88:91], v[100:103]
buffer_load_dwordx4 v234, s[4:7], s36 offen offset:0 lds
v_mfma_f32_16x16x32_bf16 v[168:171], a[88:91], a[124:127], v[168:171]
ds_read_b128 a[24:27], v232 offset:12288
v_mfma_f32_16x16x32_bf16 v[172:175], a[88:91], a[128:131], v[172:175]
buffer_load_dwordx4 v235, s[4:7], s36 offen offset:1024 lds
v_mfma_f32_16x16x32_bf16 v[40:43], a[108:111], a[92:95], v[40:43]
ds_read_b64_tr_b16 a[54:55], v224 offset:26368
v_mfma_f32_16x16x32_bf16 v[44:47], a[112:115], a[92:95], v[44:47]
buffer_load_dwordx4 v234, s[4:7], s36 offen offset:2048 lds
v_mfma_f32_16x16x32_bf16 v[104:107], a[116:119], a[92:95], v[104:107]
ds_read_b64_tr_b16 a[56:57], v225 offset:24832
v_mfma_f32_16x16x32_bf16 v[108:111], a[120:123], a[92:95], v[108:111]
buffer_load_dwordx4 v235, s[4:7], s36 offen offset:3072 lds
v_mfma_f32_16x16x32_bf16 v[176:179], a[92:95], a[124:127], v[176:179]
ds_read_b128 a[28:31], v232 offset:14336
v_mfma_f32_16x16x32_bf16 v[180:183], a[92:95], a[128:131], v[180:183]
s_add_u32 s36, s36, 128
v_mfma_f32_16x16x32_bf16 v[48:51], a[108:111], a[96:99], v[48:51]
ds_read_b64_tr_b16 a[58:59], v225 offset:26368
v_mfma_f32_16x16x32_bf16 v[52:55], a[112:115], a[96:99], v[52:55]
s_add_u32 m0, s43, 12288
v_mfma_f32_16x16x32_bf16 v[112:115], a[116:119], a[96:99], v[112:115]
ds_read_b128 a[32:35], v226
v_mfma_f32_16x16x32_bf16 v[116:119], a[120:123], a[96:99], v[116:119]
buffer_load_dwordx4 v236, s[8:11], s41 offen offset:0 lds
v_mfma_f32_16x16x32_bf16 v[184:187], a[96:99], a[124:127], v[184:187]
buffer_load_dwordx4 v237, s[8:11], s41 offen offset:1024 lds
v_mfma_f32_16x16x32_bf16 v[188:191], a[96:99], a[128:131], v[188:191]
buffer_load_dwordx4 v238, s[8:11], s41 offen offset:2048 lds
v_mfma_f32_16x16x32_bf16 v[56:59], a[108:111], a[100:103], v[56:59]
s_add_u32 s41, s41, 196608
v_mfma_f32_16x16x32_bf16 v[60:63], a[112:115], a[100:103], v[60:63]
v_add_u32 v232, s45, v232
v_mfma_f32_16x16x32_bf16 v[120:123], a[116:119], a[100:103], v[120:123]
v_add_u32 v226, s45, v226
v_mfma_f32_16x16x32_bf16 v[124:127], a[120:123], a[100:103], v[124:127]
v_mfma_f32_16x16x32_bf16 v[192:195], a[100:103], a[124:127], v[192:195]
v_mfma_f32_16x16x32_bf16 v[196:199], a[100:103], a[128:131], v[196:199]
v_mfma_f32_16x16x32_bf16 v[128:131], a[116:119], a[104:107], v[128:131]
v_mfma_f32_16x16x32_bf16 v[132:135], a[120:123], a[104:107], v[132:135]
v_mfma_f32_16x16x32_bf16 v[200:203], a[104:107], a[124:127], v[200:203]
v_mfma_f32_16x16x32_bf16 v[204:207], a[104:107], a[128:131], v[204:207]
s_waitcnt vmcnt(22) lgkmcnt(0)
s_barrier
v_mfma_f32_16x16x32_bf16 v[0:3], a[36:39], a[0:3], v[0:3]
ds_read_b64_tr_b16 a[108:109], v224 offset:36864
v_mfma_f32_16x16x32_bf16 v[4:7], a[40:43], a[0:3], v[4:7]
ds_read_b128 a[72:75], v233 offset:0
s_add_u32 m0, s38, s40
v_mfma_f32_16x16x32_bf16 v[64:67], a[44:47], a[0:3], v[64:67]
buffer_load_dwordx4 v234, s[4:7], s37 offen offset:0 lds
v_mfma_f32_16x16x32_bf16 v[68:71], a[48:51], a[0:3], v[68:71]
ds_read_b64_tr_b16 a[110:111], v224 offset:38400
v_mfma_f32_16x16x32_bf16 v[136:139], a[0:3], a[52:55], v[136:139]
v_mfma_f32_16x16x32_bf16 v[140:143], a[0:3], a[56:59], v[140:143]
ds_read_b64_tr_b16 a[112:113], v225 offset:36864
buffer_load_dwordx4 v235, s[4:7], s37 offen offset:1024 lds
v_mfma_f32_16x16x32_bf16 v[8:11], a[36:39], a[4:7], v[8:11]
v_mfma_f32_16x16x32_bf16 v[12:15], a[40:43], a[4:7], v[12:15]
ds_read_b128 a[76:79], v233 offset:2048
v_mfma_f32_16x16x32_bf16 v[72:75], a[44:47], a[4:7], v[72:75]
v_mfma_f32_16x16x32_bf16 v[76:79], a[48:51], a[4:7], v[76:79]
ds_read_b64_tr_b16 a[114:115], v225 offset:38400
buffer_load_dwordx4 v234, s[4:7], s37 offen offset:2048 lds
v_mfma_f32_16x16x32_bf16 v[144:147], a[4:7], a[52:55], v[144:147]
v_mfma_f32_16x16x32_bf16 v[148:151], a[4:7], a[56:59], v[148:151]
ds_read_b128 a[80:83], v233 offset:4096
v_mfma_f32_16x16x32_bf16 v[16:19], a[36:39], a[8:11], v[16:19]
v_mfma_f32_16x16x32_bf16 v[20:23], a[40:43], a[8:11], v[20:23]
ds_read_b64_tr_b16 a[116:117], v224 offset:36992
buffer_load_dwordx4 v235, s[4:7], s37 offen offset:3072 lds
v_mfma_f32_16x16x32_bf16 v[80:83], a[44:47], a[8:11], v[80:83]
s_add_u32 s37, s37, 128
s_add_u32 m0, s38, s50
v_mfma_f32_16x16x32_bf16 v[84:87], a[48:51], a[8:11], v[84:87]
ds_read_b128 a[84:87], v233 offset:6144
v_mfma_f32_16x16x32_bf16 v[152:155], a[8:11], a[52:55], v[152:155]
v_mfma_f32_16x16x32_bf16 v[156:159], a[8:11], a[56:59], v[156:159]
ds_read_b64_tr_b16 a[118:119], v224 offset:38528
v_mfma_f32_16x16x32_bf16 v[24:27], a[36:39], a[12:15], v[24:27]
buffer_load_dwordx4 v228, s[4:7], s49 offen lds
s_add_u32 s49, s49, 128
v_mfma_f32_16x16x32_bf16 v[28:31], a[40:43], a[12:15], v[28:31]
ds_read_b64_tr_b16 a[120:121], v225 offset:36992
s_add_u32 s38, s38, 34816
v_mfma_f32_16x16x32_bf16 v[88:91], a[44:47], a[12:15], v[88:91]
ds_read_b128 a[88:91], v233 offset:8192
s_cmp_ge_u32 s38, 153600
v_mfma_f32_16x16x32_bf16 v[92:95], a[48:51], a[12:15], v[92:95]
s_cselect_b32 s38, 49152, s38
s_add_u32 m0, s43, 24576
v_mfma_f32_16x16x32_bf16 v[160:163], a[12:15], a[52:55], v[160:163]
ds_read_b64_tr_b16 a[122:123], v225 offset:38528
buffer_load_dwordx4 v236, s[8:11], s41 offen offset:0 lds
v_mfma_f32_16x16x32_bf16 v[164:167], a[12:15], a[56:59], v[164:167]
v_mfma_f32_16x16x32_bf16 v[32:35], a[36:39], a[16:19], v[32:35]
ds_read_b128 a[92:95], v233 offset:10240
v_mfma_f32_16x16x32_bf16 v[36:39], a[40:43], a[16:19], v[36:39]
buffer_load_dwordx4 v237, s[8:11], s41 offen offset:1024 lds
v_mfma_f32_16x16x32_bf16 v[96:99], a[44:47], a[16:19], v[96:99]
ds_read_b64_tr_b16 a[124:125], v224 offset:37120
v_mfma_f32_16x16x32_bf16 v[100:103], a[48:51], a[16:19], v[100:103]
v_mfma_f32_16x16x32_bf16 v[168:171], a[16:19], a[52:55], v[168:171]
ds_read_b128 a[96:99], v233 offset:12288
v_mfma_f32_16x16x32_bf16 v[172:175], a[16:19], a[56:59], v[172:175]
buffer_load_dwordx4 v238, s[8:11], s41 offen offset:2048 lds
s_add_u32 s41, s41, 196608
v_mfma_f32_16x16x32_bf16 v[40:43], a[36:39], a[20:23], v[40:43]
ds_read_b64_tr_b16 a[126:127], v224 offset:38656
s_getpc_b64 s[16:17]
L1_pc_Q:
v_mfma_f32_16x16x32_bf16 v[44:47], a[40:43], a[20:23], v[44:47]
s_add_u32 s16, s16, gated_mix__sliding_local_dilated__dense_activation_relu__prompt_kernel-L1_pc_Q
s_addc_u32 s17, s17, -1
v_mfma_f32_16x16x32_bf16 v[104:107], a[44:47], a[20:23], v[104:107]
ds_read_b64_tr_b16 a[128:129], v225 offset:37120
s_and_b32 s17, s17, 0xffff
v_mfma_f32_16x16x32_bf16 v[108:111], a[48:51], a[20:23], v[108:111]
s_mov_b32 s18, code_end-gated_mix__sliding_local_dilated__dense_activation_relu__prompt_kernel
s_bfe_u32 s51, s2, 0x20003
v_mfma_f32_16x16x32_bf16 v[176:179], a[20:23], a[52:55], v[176:179]
ds_read_b128 a[100:103], v233 offset:14336
s_lshl_b32 s51, s51, 2
v_mfma_f32_16x16x32_bf16 v[180:183], a[20:23], a[56:59], v[180:183]
s_add_u32 s51, s51, s20
s_mul_i32 s51, s51, 3072
v_mfma_f32_16x16x32_bf16 v[48:51], a[36:39], a[24:27], v[48:51]
ds_read_b64_tr_b16 a[130:131], v225 offset:38656
buffer_load_dwordx4 a[252:255], v253, s[16:19], s51 offen offset:0
v_mfma_f32_16x16x32_bf16 v[52:55], a[40:43], a[24:27], v[52:55]
buffer_load_dwordx4 a[252:255], v253, s[16:19], s51 offen offset:1024
v_mfma_f32_16x16x32_bf16 v[112:115], a[44:47], a[24:27], v[112:115]
ds_read_b128 a[104:107], v227
v_mfma_f32_16x16x32_bf16 v[116:119], a[48:51], a[24:27], v[116:119]
v_add_u32 v233, s45, v233
v_mfma_f32_16x16x32_bf16 v[184:187], a[24:27], a[52:55], v[184:187]
v_add_u32 v227, s45, v227
v_mfma_f32_16x16x32_bf16 v[188:191], a[24:27], a[56:59], v[188:191]
buffer_load_dwordx4 a[252:255], v253, s[16:19], s51 offen offset:2048
s_mov_b32 s16, s30
v_mfma_f32_16x16x32_bf16 v[56:59], a[36:39], a[28:31], v[56:59]
s_and_b32 s17, s31, 0xffff
s_mov_b32 s18, 0x8
v_mfma_f32_16x16x32_bf16 v[60:63], a[40:43], a[28:31], v[60:63]
s_mov_b32 s19, 0x20000
v_mfma_f32_16x16x32_bf16 v[120:123], a[44:47], a[28:31], v[120:123]
s_add_u32 s46, s46, s45
v_mfma_f32_16x16x32_bf16 v[124:127], a[48:51], a[28:31], v[124:127]
s_cmp_eq_u32 s46, 69632
v_mfma_f32_16x16x32_bf16 v[192:195], a[28:31], a[52:55], v[192:195]
s_cselect_b32 s45, s54, s53
v_mfma_f32_16x16x32_bf16 v[196:199], a[28:31], a[56:59], v[196:199]
v_mfma_f32_16x16x32_bf16 v[128:131], a[44:47], a[32:35], v[128:131]
v_mfma_f32_16x16x32_bf16 v[132:135], a[48:51], a[32:35], v[132:135]
v_mfma_f32_16x16x32_bf16 v[200:203], a[32:35], a[52:55], v[200:203]
v_mfma_f32_16x16x32_bf16 v[204:207], a[32:35], a[56:59], v[204:207]
s_waitcnt vmcnt(19) lgkmcnt(0)
s_barrier
v_mfma_f32_16x16x32_bf16 v[0:3], a[108:111], a[72:75], v[0:3]
ds_read_b64_tr_b16 a[36:37], v224 offset:0
v_mov_b32 v240, 0x3f803f80
v_mfma_f32_16x16x32_bf16 v[4:7], a[112:115], a[72:75], v[4:7]
ds_read_b128 a[0:3], v232 offset:0
v_mov_b32 v241, 0
v_mfma_f32_16x16x32_bf16 v[64:67], a[116:119], a[72:75], v[64:67]
buffer_load_dwordx4 a[252:255], v253, s[96:99], s94 offen
v_mov_b32 v242, 0
v_mfma_f32_16x16x32_bf16 v[68:71], a[120:123], a[72:75], v[68:71]
ds_read_b64_tr_b16 a[38:39], v224 offset:1536
v_mov_b32 v252, 0xffff0000
v_mfma_f32_16x16x32_bf16 v[136:139], a[72:75], a[124:127], v[136:139]
s_add_u32 s94, s94, s93
v_accvgpr_read_b32 v243, a160
v_mfma_f32_16x16x32_bf16 v[140:143], a[72:75], a[128:131], v[140:143]
ds_read_b64_tr_b16 a[40:41], v225 offset:0
v_accvgpr_read_b32 v244, a144
v_mfma_f32_16x16x32_bf16 v[8:11], a[108:111], a[76:79], v[8:11]
s_add_u32 m0, s38, s39
v_accvgpr_read_b32 v251, a152
v_mfma_f32_16x16x32_bf16 v[12:15], a[112:115], a[76:79], v[12:15]
ds_read_b128 a[4:7], v232 offset:2048
v_lshlrev_b32 v245, 16, v243
v_mfma_f32_16x16x32_bf16 v[72:75], a[116:119], a[76:79], v[72:75]
buffer_load_dwordx4 v234, s[4:7], s36 offen offset:0 lds
v_and_b32 v246, v252, v243
v_mfma_f32_16x16x32_bf16 v[76:79], a[120:123], a[76:79], v[76:79]
ds_read_b64_tr_b16 a[42:43], v225 offset:1536
v_lshlrev_b32 v247, 16, v244
v_mfma_f32_16x16x32_bf16 v[144:147], a[76:79], a[124:127], v[144:147]
buffer_load_dwordx4 v235, s[4:7], s36 offen offset:1024 lds
v_and_b32 v244, v252, v244
v_mfma_f32_16x16x32_bf16 v[148:151], a[76:79], a[128:131], v[148:151]
ds_read_b128 a[8:11], v232 offset:4096
v_lshlrev_b32 v250, 16, v251
v_mfma_f32_16x16x32_bf16 v[16:19], a[108:111], a[80:83], v[16:19]
v_and_b32 v251, v252, v251
v_mul_f32 v247, v247, v245
v_mfma_f32_16x16x32_bf16 v[20:23], a[112:115], a[80:83], v[20:23]
ds_read_b64_tr_b16 a[44:45], v224 offset:128
v_mul_f32 v244, v244, v246
v_mfma_f32_16x16x32_bf16 v[80:83], a[116:119], a[80:83], v[80:83]
v_mul_f32 v250, v250, v245
v_mul_f32 v251, v251, v246
v_mfma_f32_16x16x32_bf16 v[84:87], a[120:123], a[80:83], v[84:87]
ds_read_b128 a[12:15], v232 offset:6144
v_cvt_pk_bf16_f32 v247, v247, v244
v_mfma_f32_16x16x32_bf16 v[152:155], a[80:83], a[124:127], v[152:155]
buffer_load_dwordx4 v234, s[4:7], s36 offen offset:2048 lds
v_cvt_pk_bf16_f32 v250, v250, v251
v_mfma_f32_16x16x32_bf16 v[156:159], a[80:83], a[128:131], v[156:159]
ds_read_b64_tr_b16 a[46:47], v224 offset:1664
v_dot2_f32_bf16 v241, v247, v240, v241
v_mfma_f32_16x16x32_bf16 v[24:27], a[108:111], a[84:87], v[24:27]
v_dot2_f32_bf16 v242, v250, v240, v242
v_accvgpr_read_b32 v243, a161
v_mfma_f32_16x16x32_bf16 v[28:31], a[112:115], a[84:87], v[28:31]
ds_read_b64_tr_b16 a[48:49], v225 offset:128
v_accvgpr_read_b32 v244, a145
v_mfma_f32_16x16x32_bf16 v[88:91], a[116:119], a[84:87], v[88:91]
ds_read_b128 a[16:19], v232 offset:8192
v_accvgpr_read_b32 v251, a153
v_mfma_f32_16x16x32_bf16 v[92:95], a[120:123], a[84:87], v[92:95]
buffer_load_dwordx4 v235, s[4:7], s36 offen offset:3072 lds
v_lshlrev_b32 v245, 16, v243
v_mfma_f32_16x16x32_bf16 v[160:163], a[84:87], a[124:127], v[160:163]
ds_read_b64_tr_b16 a[50:51], v225 offset:1664
v_and_b32 v246, v252, v243
v_mfma_f32_16x16x32_bf16 v[164:167], a[84:87], a[128:131], v[164:167]
s_add_u32 s36, s36, 128
v_lshlrev_b32 v247, 16, v244
v_mfma_f32_16x16x32_bf16 v[32:35], a[108:111], a[88:91], v[32:35]
ds_read_b128 a[20:23], v232 offset:10240
v_and_b32 v244, v252, v244
v_mfma_f32_16x16x32_bf16 v[36:39], a[112:115], a[88:91], v[36:39]
s_add_u32 m0, s43, 36864
v_lshlrev_b32 v250, 16, v251
v_mfma_f32_16x16x32_bf16 v[96:99], a[116:119], a[88:91], v[96:99]
ds_read_b64_tr_b16 a[52:53], v224 offset:256
v_and_b32 v251, v252, v251
v_mfma_f32_16x16x32_bf16 v[100:103], a[120:123], a[88:91], v[100:103]
buffer_load_dwordx4 v236, s[8:11], s41 offen offset:0 lds
v_mul_f32 v247, v247, v245
v_mfma_f32_16x16x32_bf16 v[168:171], a[88:91], a[124:127], v[168:171]
ds_read_b128 a[24:27], v232 offset:12288
v_mul_f32 v244, v244, v246
v_mfma_f32_16x16x32_bf16 v[172:175], a[88:91], a[128:131], v[172:175]
v_mul_f32 v250, v250, v245
v_mul_f32 v251, v251, v246
v_mfma_f32_16x16x32_bf16 v[40:43], a[108:111], a[92:95], v[40:43]
ds_read_b64_tr_b16 a[54:55], v224 offset:1792
v_cvt_pk_bf16_f32 v247, v247, v244
v_mfma_f32_16x16x32_bf16 v[44:47], a[112:115], a[92:95], v[44:47]
buffer_load_dwordx4 v237, s[8:11], s41 offen offset:1024 lds
v_cvt_pk_bf16_f32 v250, v250, v251
v_mfma_f32_16x16x32_bf16 v[104:107], a[116:119], a[92:95], v[104:107]
ds_read_b64_tr_b16 a[56:57], v225 offset:256
v_dot2_f32_bf16 v241, v247, v240, v241
v_mfma_f32_16x16x32_bf16 v[108:111], a[120:123], a[92:95], v[108:111]
v_dot2_f32_bf16 v242, v250, v240, v242
v_accvgpr_read_b32 v243, a162
v_mfma_f32_16x16x32_bf16 v[176:179], a[92:95], a[124:127], v[176:179]
ds_read_b128 a[28:31], v232 offset:14336
v_accvgpr_read_b32 v244, a146
v_mfma_f32_16x16x32_bf16 v[180:183], a[92:95], a[128:131], v[180:183]
buffer_load_dwordx4 v238, s[8:11], s41 offen offset:2048 lds
v_accvgpr_read_b32 v251, a154
v_mfma_f32_16x16x32_bf16 v[48:51], a[108:111], a[96:99], v[48:51]
ds_read_b64_tr_b16 a[58:59], v225 offset:1792
v_lshlrev_b32 v245, 16, v243
v_mfma_f32_16x16x32_bf16 v[52:55], a[112:115], a[96:99], v[52:55]
s_add_u32 s41, s41, 196608
v_and_b32 v246, v252, v243
v_mfma_f32_16x16x32_bf16 v[112:115], a[116:119], a[96:99], v[112:115]
ds_read_b128 a[32:35], v226
v_lshlrev_b32 v247, 16, v244
v_mfma_f32_16x16x32_bf16 v[116:119], a[120:123], a[96:99], v[116:119]
v_add_u32 v232, s45, v232
v_and_b32 v244, v252, v244
v_mfma_f32_16x16x32_bf16 v[184:187], a[96:99], a[124:127], v[184:187]
buffer_load_dwordx2 a[168:169], v253, s[16:19], 0 offen sc1
v_lshlrev_b32 v250, 16, v251
v_mfma_f32_16x16x32_bf16 v[188:191], a[96:99], a[128:131], v[188:191]
v_add_u32 v226, s45, v226
v_and_b32 v251, v252, v251
v_mfma_f32_16x16x32_bf16 v[56:59], a[108:111], a[100:103], v[56:59]
v_mul_f32 v247, v247, v245
v_mul_f32 v244, v244, v246
v_mfma_f32_16x16x32_bf16 v[60:63], a[112:115], a[100:103], v[60:63]
v_mul_f32 v250, v250, v245
v_mul_f32 v251, v251, v246
v_mfma_f32_16x16x32_bf16 v[120:123], a[116:119], a[100:103], v[120:123]
v_cvt_pk_bf16_f32 v247, v247, v244
v_cvt_pk_bf16_f32 v250, v250, v251
v_mfma_f32_16x16x32_bf16 v[124:127], a[120:123], a[100:103], v[124:127]
v_dot2_f32_bf16 v241, v247, v240, v241
v_dot2_f32_bf16 v242, v250, v240, v242
v_mfma_f32_16x16x32_bf16 v[192:195], a[100:103], a[124:127], v[192:195]
v_accvgpr_read_b32 v243, a163
v_accvgpr_read_b32 v244, a147
v_mfma_f32_16x16x32_bf16 v[196:199], a[100:103], a[128:131], v[196:199]
v_accvgpr_read_b32 v251, a155
v_lshlrev_b32 v245, 16, v243
v_mfma_f32_16x16x32_bf16 v[128:131], a[116:119], a[104:107], v[128:131]
v_and_b32 v246, v252, v243
v_lshlrev_b32 v247, 16, v244
v_mfma_f32_16x16x32_bf16 v[132:135], a[120:123], a[104:107], v[132:135]
v_and_b32 v244, v252, v244
v_lshlrev_b32 v250, 16, v251
v_mfma_f32_16x16x32_bf16 v[200:203], a[104:107], a[124:127], v[200:203]
v_and_b32 v251, v252, v251
v_mul_f32 v247, v247, v245
v_mfma_f32_16x16x32_bf16 v[204:207], a[104:107], a[128:131], v[204:207]
v_mul_f32 v244, v244, v246
v_mul_f32 v250, v250, v245
v_mul_f32 v251, v251, v246
v_cvt_pk_bf16_f32 v247, v247, v244
v_cvt_pk_bf16_f32 v250, v250, v251
v_dot2_f32_bf16 v241, v247, v240, v241
v_dot2_f32_bf16 v242, v250, v240, v242
v_accvgpr_read_b32 v243, a164
v_accvgpr_read_b32 v244, a148
v_accvgpr_read_b32 v251, a156
v_lshlrev_b32 v245, 16, v243
v_and_b32 v246, v252, v243
v_lshlrev_b32 v247, 16, v244
v_and_b32 v244, v252, v244
v_lshlrev_b32 v250, 16, v251
v_and_b32 v251, v252, v251
v_mul_f32 v247, v247, v245
v_mul_f32 v244, v244, v246
v_mul_f32 v250, v250, v245
v_mul_f32 v251, v251, v246
v_cvt_pk_bf16_f32 v247, v247, v244
v_cvt_pk_bf16_f32 v250, v250, v251
v_dot2_f32_bf16 v241, v247, v240, v241
v_dot2_f32_bf16 v242, v250, v240, v242
v_accvgpr_read_b32 v243, a165
v_accvgpr_read_b32 v244, a149
v_accvgpr_read_b32 v251, a157
v_lshlrev_b32 v245, 16, v243
v_and_b32 v246, v252, v243
v_lshlrev_b32 v247, 16, v244
v_and_b32 v244, v252, v244
v_lshlrev_b32 v250, 16, v251
v_and_b32 v251, v252, v251
v_mul_f32 v247, v247, v245
v_mul_f32 v244, v244, v246
v_mul_f32 v250, v250, v245
v_mul_f32 v251, v251, v246
v_cvt_pk_bf16_f32 v247, v247, v244
v_cvt_pk_bf16_f32 v250, v250, v251
v_dot2_f32_bf16 v241, v247, v240, v241
v_dot2_f32_bf16 v242, v250, v240, v242
v_accvgpr_read_b32 v243, a166
v_accvgpr_read_b32 v244, a150
v_accvgpr_read_b32 v251, a158
v_lshlrev_b32 v245, 16, v243
v_and_b32 v246, v252, v243
v_lshlrev_b32 v247, 16, v244
v_and_b32 v244, v252, v244
v_lshlrev_b32 v250, 16, v251
v_and_b32 v251, v252, v251
v_mul_f32 v247, v247, v245
v_mul_f32 v244, v244, v246
v_mul_f32 v250, v250, v245
v_mul_f32 v251, v251, v246
v_cvt_pk_bf16_f32 v247, v247, v244
v_cvt_pk_bf16_f32 v250, v250, v251
v_dot2_f32_bf16 v241, v247, v240, v241
v_dot2_f32_bf16 v242, v250, v240, v242
v_accvgpr_read_b32 v243, a167
v_accvgpr_read_b32 v244, a151
v_accvgpr_read_b32 v251, a159
v_lshlrev_b32 v245, 16, v243
v_and_b32 v246, v252, v243
v_lshlrev_b32 v247, 16, v244
v_and_b32 v244, v252, v244
v_lshlrev_b32 v250, 16, v251
v_and_b32 v251, v252, v251
v_mul_f32 v247, v247, v245
v_mul_f32 v244, v244, v246
v_mul_f32 v250, v250, v245
v_mul_f32 v251, v251, v246
v_cvt_pk_bf16_f32 v247, v247, v244
v_cvt_pk_bf16_f32 v250, v250, v251
v_dot2_f32_bf16 v241, v247, v240, v241
v_dot2_f32_bf16 v242, v250, v240, v242
s_nop 1
v_add_f32_dpp v241, v241, v241 row_ror:8 row_mask:0xf bank_mask:0xf
v_add_f32_dpp v242, v242, v242 row_ror:8 row_mask:0xf bank_mask:0xf
s_nop 0
v_add_f32_dpp v241, v241, v241 row_ror:4 row_mask:0xf bank_mask:0xf
v_add_f32_dpp v242, v242, v242 row_ror:4 row_mask:0xf bank_mask:0xf
s_nop 0
v_add_f32_dpp v241, v241, v241 row_ror:2 row_mask:0xf bank_mask:0xf
v_add_f32_dpp v242, v242, v242 row_ror:2 row_mask:0xf bank_mask:0xf
s_nop 0
v_add_f32_dpp v241, v241, v241 row_ror:1 row_mask:0xf bank_mask:0xf
v_add_f32_dpp v242, v242, v242 row_ror:1 row_mask:0xf bank_mask:0xf
v_mov_b32 v243, v241
v_mov_b32 v244, v242
s_nop 0
v_permlane32_swap_b32 v241, v243
v_permlane32_swap_b32 v242, v244
v_add_f32 v241, v241, v243
v_add_f32 v242, v242, v244
v_mov_b32 v243, v241
v_mov_b32 v244, v242
s_nop 0
v_permlane16_swap_b32 v241, v243
v_permlane16_swap_b32 v242, v244
v_add_f32 v241, v241, v243
v_add_f32 v242, v242, v244
v_and_b32 v243, 1, v254
v_cmp_eq_u32 vcc, 1, v243
v_lshlrev_b32 v243, 2, v254
v_and_b32 v245, 2, v254
v_cndmask_b32 v241, v241, v242, vcc
v_cvt_pk_bf16_f32 v241, v241, v241
v_and_b32 v241, v252, v241
v_mul_f32 v241, 0xbfb8aa3b, v241
v_exp_f32 v241, v241
v_cmp_gt_u32 vcc, 32, v254
v_add_f32 v241, 1.0, v241
v_rcp_f32 v241, v241
v_mov_b32 v244, 0x7fff0000
v_cvt_pk_bf16_f32 v241, v241, v241
v_and_b32 v241, v252, v241
v_sub_f32 v242, 1.0, v241
v_cndmask_b32 v243, v244, v243, vcc
v_cmp_eq_u32 vcc, 2, v245
v_cvt_pk_bf16_f32 v242, v242, v242
v_and_b32 v242, v252, v242
v_cndmask_b32 v241, v241, v242, vcc
s_mov_b32 s34, 5
.p2align 6
L1_loop_Q:
s_waitcnt vmcnt(16) lgkmcnt(0)
s_barrier
v_mfma_f32_16x16x32_bf16 v[0:3], a[36:39], a[0:3], v[0:3]
ds_read_b64_tr_b16 a[108:109], v224 offset:12288
v_mfma_f32_16x16x32_bf16 v[4:7], a[40:43], a[0:3], v[4:7]
ds_read_b128 a[72:75], v233 offset:0
v_mfma_f32_16x16x32_bf16 v[64:67], a[44:47], a[0:3], v[64:67]
s_add_u32 m0, s38, s40
v_mfma_f32_16x16x32_bf16 v[68:71], a[48:51], a[0:3], v[68:71]
ds_read_b64_tr_b16 a[110:111], v224 offset:13824
v_mfma_f32_16x16x32_bf16 v[136:139], a[0:3], a[52:55], v[136:139]
buffer_load_dwordx4 v234, s[4:7], s37 offen offset:0 lds
v_mfma_f32_16x16x32_bf16 v[140:143], a[0:3], a[56:59], v[140:143]
ds_read_b64_tr_b16 a[112:113], v225 offset:12288
v_mfma_f32_16x16x32_bf16 v[8:11], a[36:39], a[4:7], v[8:11]
buffer_load_dwordx4 v235, s[4:7], s37 offen offset:1024 lds
v_mfma_f32_16x16x32_bf16 v[12:15], a[40:43], a[4:7], v[12:15]
ds_read_b128 a[76:79], v233 offset:2048
v_mfma_f32_16x16x32_bf16 v[72:75], a[44:47], a[4:7], v[72:75]
v_mfma_f32_16x16x32_bf16 v[76:79], a[48:51], a[4:7], v[76:79]
ds_read_b64_tr_b16 a[114:115], v225 offset:13824
v_mfma_f32_16x16x32_bf16 v[144:147], a[4:7], a[52:55], v[144:147]
v_mfma_f32_16x16x32_bf16 v[148:151], a[4:7], a[56:59], v[148:151]
ds_read_b128 a[80:83], v233 offset:4096
v_mfma_f32_16x16x32_bf16 v[16:19], a[36:39], a[8:11], v[16:19]
buffer_load_dwordx4 v234, s[4:7], s37 offen offset:2048 lds
v_mfma_f32_16x16x32_bf16 v[20:23], a[40:43], a[8:11], v[20:23]
ds_read_b64_tr_b16 a[116:117], v224 offset:12416
v_mfma_f32_16x16x32_bf16 v[80:83], a[44:47], a[8:11], v[80:83]
v_mfma_f32_16x16x32_bf16 v[84:87], a[48:51], a[8:11], v[84:87]
ds_read_b128 a[84:87], v233 offset:6144
v_mfma_f32_16x16x32_bf16 v[152:155], a[8:11], a[52:55], v[152:155]
v_mfma_f32_16x16x32_bf16 v[156:159], a[8:11], a[56:59], v[156:159]
ds_read_b64_tr_b16 a[118:119], v224 offset:13952
v_mfma_f32_16x16x32_bf16 v[24:27], a[36:39], a[12:15], v[24:27]
buffer_load_dwordx4 v235, s[4:7], s37 offen offset:3072 lds
v_mfma_f32_16x16x32_bf16 v[28:31], a[40:43], a[12:15], v[28:31]
ds_read_b64_tr_b16 a[120:121], v225 offset:12416
v_mfma_f32_16x16x32_bf16 v[88:91], a[44:47], a[12:15], v[88:91]
ds_read_b128 a[88:91], v233 offset:8192
v_mfma_f32_16x16x32_bf16 v[92:95], a[48:51], a[12:15], v[92:95]
s_add_u32 s37, s37, 128
v_mfma_f32_16x16x32_bf16 v[160:163], a[12:15], a[52:55], v[160:163]
ds_read_b64_tr_b16 a[122:123], v225 offset:13952
v_mfma_f32_16x16x32_bf16 v[164:167], a[12:15], a[56:59], v[164:167]
s_add_u32 m0, s38, s50
v_mfma_f32_16x16x32_bf16 v[32:35], a[36:39], a[16:19], v[32:35]
ds_read_b128 a[92:95], v233 offset:10240
v_mfma_f32_16x16x32_bf16 v[36:39], a[40:43], a[16:19], v[36:39]
buffer_load_dwordx4 v228, s[4:7], s49 offen lds
v_mfma_f32_16x16x32_bf16 v[96:99], a[44:47], a[16:19], v[96:99]
ds_read_b64_tr_b16 a[124:125], v224 offset:12544
v_mfma_f32_16x16x32_bf16 v[100:103], a[48:51], a[16:19], v[100:103]
s_add_u32 s49, s49, 128
v_mfma_f32_16x16x32_bf16 v[168:171], a[16:19], a[52:55], v[168:171]
ds_read_b128 a[96:99], v233 offset:12288
v_mfma_f32_16x16x32_bf16 v[172:175], a[16:19], a[56:59], v[172:175]
s_add_u32 s38, s38, 34816
v_mfma_f32_16x16x32_bf16 v[40:43], a[36:39], a[20:23], v[40:43]
ds_read_b64_tr_b16 a[126:127], v224 offset:14080
v_mfma_f32_16x16x32_bf16 v[44:47], a[40:43], a[20:23], v[44:47]
s_cmp_ge_u32 s38, 153600
v_mfma_f32_16x16x32_bf16 v[104:107], a[44:47], a[20:23], v[104:107]
ds_read_b64_tr_b16 a[128:129], v225 offset:12544
v_mfma_f32_16x16x32_bf16 v[108:111], a[48:51], a[20:23], v[108:111]
s_cselect_b32 s38, 49152, s38
v_mfma_f32_16x16x32_bf16 v[176:179], a[20:23], a[52:55], v[176:179]
ds_read_b128 a[100:103], v233 offset:14336
v_mfma_f32_16x16x32_bf16 v[180:183], a[20:23], a[56:59], v[180:183]
s_add_u32 m0, s43, 0
v_mfma_f32_16x16x32_bf16 v[48:51], a[36:39], a[24:27], v[48:51]
ds_read_b64_tr_b16 a[130:131], v225 offset:14080
v_mfma_f32_16x16x32_bf16 v[52:55], a[40:43], a[24:27], v[52:55]
buffer_load_dwordx4 v236, s[8:11], s41 offen offset:0 lds
v_mfma_f32_16x16x32_bf16 v[112:115], a[44:47], a[24:27], v[112:115]
ds_read_b128 a[104:107], v227
v_mfma_f32_16x16x32_bf16 v[116:119], a[48:51], a[24:27], v[116:119]
buffer_load_dwordx4 v237, s[8:11], s41 offen offset:1024 lds
v_mfma_f32_16x16x32_bf16 v[184:187], a[24:27], a[52:55], v[184:187]
buffer_load_dwordx4 v238, s[8:11], s41 offen offset:2048 lds
v_mfma_f32_16x16x32_bf16 v[188:191], a[24:27], a[56:59], v[188:191]
s_add_u32 s41, s41, 196608
v_mfma_f32_16x16x32_bf16 v[56:59], a[36:39], a[28:31], v[56:59]
v_add_u32 v233, s45, v233
v_mfma_f32_16x16x32_bf16 v[60:63], a[40:43], a[28:31], v[60:63]
v_add_u32 v227, s45, v227
v_mfma_f32_16x16x32_bf16 v[120:123], a[44:47], a[28:31], v[120:123]
s_add_u32 s46, s46, s45
v_mfma_f32_16x16x32_bf16 v[124:127], a[48:51], a[28:31], v[124:127]
s_cmp_eq_u32 s46, 69632
v_mfma_f32_16x16x32_bf16 v[192:195], a[28:31], a[52:55], v[192:195]
s_cselect_b32 s45, s54, s53
v_mfma_f32_16x16x32_bf16 v[196:199], a[28:31], a[56:59], v[196:199]
v_mfma_f32_16x16x32_bf16 v[128:131], a[44:47], a[32:35], v[128:131]
v_mfma_f32_16x16x32_bf16 v[132:135], a[48:51], a[32:35], v[132:135]
v_mfma_f32_16x16x32_bf16 v[200:203], a[32:35], a[52:55], v[200:203]
v_mfma_f32_16x16x32_bf16 v[204:207], a[32:35], a[56:59], v[204:207]
s_waitcnt vmcnt(16) lgkmcnt(0)
s_barrier
v_mfma_f32_16x16x32_bf16 v[0:3], a[108:111], a[72:75], v[0:3]
ds_read_b64_tr_b16 a[36:37], v224 offset:24576
v_mfma_f32_16x16x32_bf16 v[4:7], a[112:115], a[72:75], v[4:7]
ds_read_b128 a[0:3], v232 offset:0
v_mfma_f32_16x16x32_bf16 v[64:67], a[116:119], a[72:75], v[64:67]
buffer_load_dwordx4 a[252:255], v253, s[96:99], s94 offen
v_mfma_f32_16x16x32_bf16 v[68:71], a[120:123], a[72:75], v[68:71]
ds_read_b64_tr_b16 a[38:39], v224 offset:26112
v_mfma_f32_16x16x32_bf16 v[136:139], a[72:75], a[124:127], v[136:139]
s_add_u32 s94, s94, s93
v_mfma_f32_16x16x32_bf16 v[140:143], a[72:75], a[128:131], v[140:143]
ds_read_b64_tr_b16 a[40:41], v225 offset:24576
v_mfma_f32_16x16x32_bf16 v[8:11], a[108:111], a[76:79], v[8:11]
s_add_u32 m0, s38, s39
v_mfma_f32_16x16x32_bf16 v[12:15], a[112:115], a[76:79], v[12:15]
ds_read_b128 a[4:7], v232 offset:2048
v_mfma_f32_16x16x32_bf16 v[72:75], a[116:119], a[76:79], v[72:75]
buffer_load_dwordx4 v234, s[4:7], s36 offen offset:0 lds
v_mfma_f32_16x16x32_bf16 v[76:79], a[120:123], a[76:79], v[76:79]
ds_read_b64_tr_b16 a[42:43], v225 offset:26112
v_mfma_f32_16x16x32_bf16 v[144:147], a[76:79], a[124:127], v[144:147]
v_mfma_f32_16x16x32_bf16 v[148:151], a[76:79], a[128:131], v[148:151]
ds_read_b128 a[8:11], v232 offset:4096
v_mfma_f32_16x16x32_bf16 v[16:19], a[108:111], a[80:83], v[16:19]
buffer_load_dwordx4 v235, s[4:7], s36 offen offset:1024 lds
v_mfma_f32_16x16x32_bf16 v[20:23], a[112:115], a[80:83], v[20:23]
ds_read_b64_tr_b16 a[44:45], v224 offset:24704
v_mfma_f32_16x16x32_bf16 v[80:83], a[116:119], a[80:83], v[80:83]
v_mfma_f32_16x16x32_bf16 v[84:87], a[120:123], a[80:83], v[84:87]
ds_read_b128 a[12:15], v232 offset:6144
v_mfma_f32_16x16x32_bf16 v[152:155], a[80:83], a[124:127], v[152:155]
v_mfma_f32_16x16x32_bf16 v[156:159], a[80:83], a[128:131], v[156:159]
ds_read_b64_tr_b16 a[46:47], v224 offset:26240
v_mfma_f32_16x16x32_bf16 v[24:27], a[108:111], a[84:87], v[24:27]
buffer_load_dwordx4 v234, s[4:7], s36 offen offset:2048 lds
v_mfma_f32_16x16x32_bf16 v[28:31], a[112:115], a[84:87], v[28:31]
ds_read_b64_tr_b16 a[48:49], v225 offset:24704
v_mfma_f32_16x16x32_bf16 v[88:91], a[116:119], a[84:87], v[88:91]
ds_read_b128 a[16:19], v232 offset:8192
v_mfma_f32_16x16x32_bf16 v[92:95], a[120:123], a[84:87], v[92:95]
v_mfma_f32_16x16x32_bf16 v[160:163], a[84:87], a[124:127], v[160:163]
ds_read_b64_tr_b16 a[50:51], v225 offset:26240
v_mfma_f32_16x16x32_bf16 v[164:167], a[84:87], a[128:131], v[164:167]
buffer_load_dwordx4 v235, s[4:7], s36 offen offset:3072 lds
v_mfma_f32_16x16x32_bf16 v[32:35], a[108:111], a[88:91], v[32:35]
ds_read_b128 a[20:23], v232 offset:10240
v_mfma_f32_16x16x32_bf16 v[36:39], a[112:115], a[88:91], v[36:39]
s_add_u32 s36, s36, 128
v_mfma_f32_16x16x32_bf16 v[96:99], a[116:119], a[88:91], v[96:99]
ds_read_b64_tr_b16 a[52:53], v224 offset:24832
v_mfma_f32_16x16x32_bf16 v[100:103], a[120:123], a[88:91], v[100:103]
s_add_u32 m0, s43, 12288
v_mfma_f32_16x16x32_bf16 v[168:171], a[88:91], a[124:127], v[168:171]
ds_read_b128 a[24:27], v232 offset:12288
v_mfma_f32_16x16x32_bf16 v[172:175], a[88:91], a[128:131], v[172:175]
buffer_load_dwordx4 v236, s[8:11], s41 offen offset:0 lds
v_mfma_f32_16x16x32_bf16 v[40:43], a[108:111], a[92:95], v[40:43]
ds_read_b64_tr_b16 a[54:55], v224 offset:26368
v_mfma_f32_16x16x32_bf16 v[44:47], a[112:115], a[92:95], v[44:47]
v_mfma_f32_16x16x32_bf16 v[104:107], a[116:119], a[92:95], v[104:107]
ds_read_b64_tr_b16 a[56:57], v225 offset:24832
v_mfma_f32_16x16x32_bf16 v[108:111], a[120:123], a[92:95], v[108:111]
v_mfma_f32_16x16x32_bf16 v[176:179], a[92:95], a[124:127], v[176:179]
ds_read_b128 a[28:31], v232 offset:14336
v_mfma_f32_16x16x32_bf16 v[180:183], a[92:95], a[128:131], v[180:183]
buffer_load_dwordx4 v237, s[8:11], s41 offen offset:1024 lds
v_mfma_f32_16x16x32_bf16 v[48:51], a[108:111], a[96:99], v[48:51]
ds_read_b64_tr_b16 a[58:59], v225 offset:26368
v_mfma_f32_16x16x32_bf16 v[52:55], a[112:115], a[96:99], v[52:55]
v_mfma_f32_16x16x32_bf16 v[112:115], a[116:119], a[96:99], v[112:115]
ds_read_b128 a[32:35], v226
v_mfma_f32_16x16x32_bf16 v[116:119], a[120:123], a[96:99], v[116:119]
buffer_load_dwordx4 v238, s[8:11], s41 offen offset:2048 lds
v_mfma_f32_16x16x32_bf16 v[184:187], a[96:99], a[124:127], v[184:187]
s_add_u32 s41, s41, 196608
v_mfma_f32_16x16x32_bf16 v[188:191], a[96:99], a[128:131], v[188:191]
v_add_u32 v232, s45, v232
v_mfma_f32_16x16x32_bf16 v[56:59], a[108:111], a[100:103], v[56:59]
v_add_u32 v226, s45, v226
v_mfma_f32_16x16x32_bf16 v[60:63], a[112:115], a[100:103], v[60:63]
v_mfma_f32_16x16x32_bf16 v[120:123], a[116:119], a[100:103], v[120:123]
v_mfma_f32_16x16x32_bf16 v[124:127], a[120:123], a[100:103], v[124:127]
v_mfma_f32_16x16x32_bf16 v[192:195], a[100:103], a[124:127], v[192:195]
v_mfma_f32_16x16x32_bf16 v[196:199], a[100:103], a[128:131], v[196:199]
v_mfma_f32_16x16x32_bf16 v[128:131], a[116:119], a[104:107], v[128:131]
v_mfma_f32_16x16x32_bf16 v[132:135], a[120:123], a[104:107], v[132:135]
v_mfma_f32_16x16x32_bf16 v[200:203], a[104:107], a[124:127], v[200:203]
v_mfma_f32_16x16x32_bf16 v[204:207], a[104:107], a[128:131], v[204:207]
s_waitcnt vmcnt(16) lgkmcnt(0)
s_barrier
v_mfma_f32_16x16x32_bf16 v[0:3], a[36:39], a[0:3], v[0:3]
ds_read_b64_tr_b16 a[108:109], v224 offset:36864
v_mfma_f32_16x16x32_bf16 v[4:7], a[40:43], a[0:3], v[4:7]
ds_read_b128 a[72:75], v233 offset:0
v_mfma_f32_16x16x32_bf16 v[64:67], a[44:47], a[0:3], v[64:67]
s_add_u32 m0, s38, s40
v_mfma_f32_16x16x32_bf16 v[68:71], a[48:51], a[0:3], v[68:71]
ds_read_b64_tr_b16 a[110:111], v224 offset:38400
v_mfma_f32_16x16x32_bf16 v[136:139], a[0:3], a[52:55], v[136:139]
buffer_load_dwordx4 v234, s[4:7], s37 offen offset:0 lds
v_mfma_f32_16x16x32_bf16 v[140:143], a[0:3], a[56:59], v[140:143]
ds_read_b64_tr_b16 a[112:113], v225 offset:36864
v_mfma_f32_16x16x32_bf16 v[8:11], a[36:39], a[4:7], v[8:11]
buffer_load_dwordx4 v235, s[4:7], s37 offen offset:1024 lds
v_mfma_f32_16x16x32_bf16 v[12:15], a[40:43], a[4:7], v[12:15]
ds_read_b128 a[76:79], v233 offset:2048
v_mfma_f32_16x16x32_bf16 v[72:75], a[44:47], a[4:7], v[72:75]
v_mfma_f32_16x16x32_bf16 v[76:79], a[48:51], a[4:7], v[76:79]
ds_read_b64_tr_b16 a[114:115], v225 offset:38400
v_mfma_f32_16x16x32_bf16 v[144:147], a[4:7], a[52:55], v[144:147]
v_mfma_f32_16x16x32_bf16 v[148:151], a[4:7], a[56:59], v[148:151]
ds_read_b128 a[80:83], v233 offset:4096
v_mfma_f32_16x16x32_bf16 v[16:19], a[36:39], a[8:11], v[16:19]
buffer_load_dwordx4 v234, s[4:7], s37 offen offset:2048 lds
v_mfma_f32_16x16x32_bf16 v[20:23], a[40:43], a[8:11], v[20:23]
ds_read_b64_tr_b16 a[116:117], v224 offset:36992
v_mfma_f32_16x16x32_bf16 v[80:83], a[44:47], a[8:11], v[80:83]
v_mfma_f32_16x16x32_bf16 v[84:87], a[48:51], a[8:11], v[84:87]
ds_read_b128 a[84:87], v233 offset:6144
v_mfma_f32_16x16x32_bf16 v[152:155], a[8:11], a[52:55], v[152:155]
v_mfma_f32_16x16x32_bf16 v[156:159], a[8:11], a[56:59], v[156:159]
ds_read_b64_tr_b16 a[118:119], v224 offset:38528
v_mfma_f32_16x16x32_bf16 v[24:27], a[36:39], a[12:15], v[24:27]
buffer_load_dwordx4 v235, s[4:7], s37 offen offset:3072 lds
v_mfma_f32_16x16x32_bf16 v[28:31], a[40:43], a[12:15], v[28:31]
ds_read_b64_tr_b16 a[120:121], v225 offset:36992
v_mfma_f32_16x16x32_bf16 v[88:91], a[44:47], a[12:15], v[88:91]
ds_read_b128 a[88:91], v233 offset:8192
v_mfma_f32_16x16x32_bf16 v[92:95], a[48:51], a[12:15], v[92:95]
s_add_u32 s37, s37, 128
v_mfma_f32_16x16x32_bf16 v[160:163], a[12:15], a[52:55], v[160:163]
ds_read_b64_tr_b16 a[122:123], v225 offset:38528
v_mfma_f32_16x16x32_bf16 v[164:167], a[12:15], a[56:59], v[164:167]
s_add_u32 m0, s38, s50
v_mfma_f32_16x16x32_bf16 v[32:35], a[36:39], a[16:19], v[32:35]
ds_read_b128 a[92:95], v233 offset:10240
v_mfma_f32_16x16x32_bf16 v[36:39], a[40:43], a[16:19], v[36:39]
buffer_load_dwordx4 v228, s[4:7], s49 offen lds
v_mfma_f32_16x16x32_bf16 v[96:99], a[44:47], a[16:19], v[96:99]
ds_read_b64_tr_b16 a[124:125], v224 offset:37120
v_mfma_f32_16x16x32_bf16 v[100:103], a[48:51], a[16:19], v[100:103]
s_add_u32 s49, s49, 128
v_mfma_f32_16x16x32_bf16 v[168:171], a[16:19], a[52:55], v[168:171]
ds_read_b128 a[96:99], v233 offset:12288
v_mfma_f32_16x16x32_bf16 v[172:175], a[16:19], a[56:59], v[172:175]
s_add_u32 s38, s38, 34816
v_mfma_f32_16x16x32_bf16 v[40:43], a[36:39], a[20:23], v[40:43]
ds_read_b64_tr_b16 a[126:127], v224 offset:38656
v_mfma_f32_16x16x32_bf16 v[44:47], a[40:43], a[20:23], v[44:47]
s_cmp_ge_u32 s38, 153600
v_mfma_f32_16x16x32_bf16 v[104:107], a[44:47], a[20:23], v[104:107]
ds_read_b64_tr_b16 a[128:129], v225 offset:37120
v_mfma_f32_16x16x32_bf16 v[108:111], a[48:51], a[20:23], v[108:111]
s_cselect_b32 s38, 49152, s38
v_mfma_f32_16x16x32_bf16 v[176:179], a[20:23], a[52:55], v[176:179]
ds_read_b128 a[100:103], v233 offset:14336
v_mfma_f32_16x16x32_bf16 v[180:183], a[20:23], a[56:59], v[180:183]
s_add_u32 m0, s43, 24576
v_mfma_f32_16x16x32_bf16 v[48:51], a[36:39], a[24:27], v[48:51]
ds_read_b64_tr_b16 a[130:131], v225 offset:38656
v_mfma_f32_16x16x32_bf16 v[52:55], a[40:43], a[24:27], v[52:55]
buffer_load_dwordx4 v236, s[8:11], s41 offen offset:0 lds
v_mfma_f32_16x16x32_bf16 v[112:115], a[44:47], a[24:27], v[112:115]
ds_read_b128 a[104:107], v227
v_mfma_f32_16x16x32_bf16 v[116:119], a[48:51], a[24:27], v[116:119]
buffer_load_dwordx4 v237, s[8:11], s41 offen offset:1024 lds
v_mfma_f32_16x16x32_bf16 v[184:187], a[24:27], a[52:55], v[184:187]
buffer_load_dwordx4 v238, s[8:11], s41 offen offset:2048 lds
v_mfma_f32_16x16x32_bf16 v[188:191], a[24:27], a[56:59], v[188:191]
s_add_u32 s41, s41, 196608
v_mfma_f32_16x16x32_bf16 v[56:59], a[36:39], a[28:31], v[56:59]
v_add_u32 v233, s45, v233
v_mfma_f32_16x16x32_bf16 v[60:63], a[40:43], a[28:31], v[60:63]
v_add_u32 v227, s45, v227
v_mfma_f32_16x16x32_bf16 v[120:123], a[44:47], a[28:31], v[120:123]
s_add_u32 s46, s46, s45
v_mfma_f32_16x16x32_bf16 v[124:127], a[48:51], a[28:31], v[124:127]
s_cmp_eq_u32 s46, 69632
v_mfma_f32_16x16x32_bf16 v[192:195], a[28:31], a[52:55], v[192:195]
s_cselect_b32 s45, s54, s53
v_mfma_f32_16x16x32_bf16 v[196:199], a[28:31], a[56:59], v[196:199]
v_mfma_f32_16x16x32_bf16 v[128:131], a[44:47], a[32:35], v[128:131]
v_mfma_f32_16x16x32_bf16 v[132:135], a[48:51], a[32:35], v[132:135]
v_mfma_f32_16x16x32_bf16 v[200:203], a[32:35], a[52:55], v[200:203]
v_mfma_f32_16x16x32_bf16 v[204:207], a[32:35], a[56:59], v[204:207]
s_waitcnt vmcnt(16) lgkmcnt(0)
s_barrier
v_mfma_f32_16x16x32_bf16 v[0:3], a[108:111], a[72:75], v[0:3]
ds_read_b64_tr_b16 a[36:37], v224 offset:0
v_mfma_f32_16x16x32_bf16 v[4:7], a[112:115], a[72:75], v[4:7]
ds_read_b128 a[0:3], v232 offset:0
v_mfma_f32_16x16x32_bf16 v[64:67], a[116:119], a[72:75], v[64:67]
buffer_load_dwordx4 a[252:255], v253, s[96:99], s94 offen
v_mfma_f32_16x16x32_bf16 v[68:71], a[120:123], a[72:75], v[68:71]
ds_read_b64_tr_b16 a[38:39], v224 offset:1536
v_mfma_f32_16x16x32_bf16 v[136:139], a[72:75], a[124:127], v[136:139]
s_add_u32 s94, s94, s93
v_mfma_f32_16x16x32_bf16 v[140:143], a[72:75], a[128:131], v[140:143]
ds_read_b64_tr_b16 a[40:41], v225 offset:0
v_mfma_f32_16x16x32_bf16 v[8:11], a[108:111], a[76:79], v[8:11]
s_add_u32 m0, s38, s39
v_mfma_f32_16x16x32_bf16 v[12:15], a[112:115], a[76:79], v[12:15]
ds_read_b128 a[4:7], v232 offset:2048
v_mfma_f32_16x16x32_bf16 v[72:75], a[116:119], a[76:79], v[72:75]
buffer_load_dwordx4 v234, s[4:7], s36 offen offset:0 lds
v_mfma_f32_16x16x32_bf16 v[76:79], a[120:123], a[76:79], v[76:79]
ds_read_b64_tr_b16 a[42:43], v225 offset:1536
v_mfma_f32_16x16x32_bf16 v[144:147], a[76:79], a[124:127], v[144:147]
v_mfma_f32_16x16x32_bf16 v[148:151], a[76:79], a[128:131], v[148:151]
ds_read_b128 a[8:11], v232 offset:4096
v_mfma_f32_16x16x32_bf16 v[16:19], a[108:111], a[80:83], v[16:19]
buffer_load_dwordx4 v235, s[4:7], s36 offen offset:1024 lds
v_mfma_f32_16x16x32_bf16 v[20:23], a[112:115], a[80:83], v[20:23]
ds_read_b64_tr_b16 a[44:45], v224 offset:128
v_mfma_f32_16x16x32_bf16 v[80:83], a[116:119], a[80:83], v[80:83]
v_mfma_f32_16x16x32_bf16 v[84:87], a[120:123], a[80:83], v[84:87]
ds_read_b128 a[12:15], v232 offset:6144
v_mfma_f32_16x16x32_bf16 v[152:155], a[80:83], a[124:127], v[152:155]
v_mfma_f32_16x16x32_bf16 v[156:159], a[80:83], a[128:131], v[156:159]
ds_read_b64_tr_b16 a[46:47], v224 offset:1664
v_mfma_f32_16x16x32_bf16 v[24:27], a[108:111], a[84:87], v[24:27]
buffer_load_dwordx4 v234, s[4:7], s36 offen offset:2048 lds
v_mfma_f32_16x16x32_bf16 v[28:31], a[112:115], a[84:87], v[28:31]
ds_read_b64_tr_b16 a[48:49], v225 offset:128
v_mfma_f32_16x16x32_bf16 v[88:91], a[116:119], a[84:87], v[88:91]
ds_read_b128 a[16:19], v232 offset:8192
v_mfma_f32_16x16x32_bf16 v[92:95], a[120:123], a[84:87], v[92:95]
v_mfma_f32_16x16x32_bf16 v[160:163], a[84:87], a[124:127], v[160:163]
ds_read_b64_tr_b16 a[50:51], v225 offset:1664
v_mfma_f32_16x16x32_bf16 v[164:167], a[84:87], a[128:131], v[164:167]
buffer_load_dwordx4 v235, s[4:7], s36 offen offset:3072 lds
v_mfma_f32_16x16x32_bf16 v[32:35], a[108:111], a[88:91], v[32:35]
ds_read_b128 a[20:23], v232 offset:10240
v_mfma_f32_16x16x32_bf16 v[36:39], a[112:115], a[88:91], v[36:39]
s_add_u32 s36, s36, 128
v_mfma_f32_16x16x32_bf16 v[96:99], a[116:119], a[88:91], v[96:99]
ds_read_b64_tr_b16 a[52:53], v224 offset:256
v_mfma_f32_16x16x32_bf16 v[100:103], a[120:123], a[88:91], v[100:103]
s_add_u32 m0, s43, 36864
v_mfma_f32_16x16x32_bf16 v[168:171], a[88:91], a[124:127], v[168:171]
ds_read_b128 a[24:27], v232 offset:12288
v_mfma_f32_16x16x32_bf16 v[172:175], a[88:91], a[128:131], v[172:175]
buffer_load_dwordx4 v236, s[8:11], s41 offen offset:0 lds
v_mfma_f32_16x16x32_bf16 v[40:43], a[108:111], a[92:95], v[40:43]
ds_read_b64_tr_b16 a[54:55], v224 offset:1792
v_mfma_f32_16x16x32_bf16 v[44:47], a[112:115], a[92:95], v[44:47]
v_mfma_f32_16x16x32_bf16 v[104:107], a[116:119], a[92:95], v[104:107]
ds_read_b64_tr_b16 a[56:57], v225 offset:256
v_mfma_f32_16x16x32_bf16 v[108:111], a[120:123], a[92:95], v[108:111]
v_mfma_f32_16x16x32_bf16 v[176:179], a[92:95], a[124:127], v[176:179]
ds_read_b128 a[28:31], v232 offset:14336
v_mfma_f32_16x16x32_bf16 v[180:183], a[92:95], a[128:131], v[180:183]
buffer_load_dwordx4 v237, s[8:11], s41 offen offset:1024 lds
v_mfma_f32_16x16x32_bf16 v[48:51], a[108:111], a[96:99], v[48:51]
ds_read_b64_tr_b16 a[58:59], v225 offset:1792
v_mfma_f32_16x16x32_bf16 v[52:55], a[112:115], a[96:99], v[52:55]
v_mfma_f32_16x16x32_bf16 v[112:115], a[116:119], a[96:99], v[112:115]
ds_read_b128 a[32:35], v226
v_mfma_f32_16x16x32_bf16 v[116:119], a[120:123], a[96:99], v[116:119]
buffer_load_dwordx4 v238, s[8:11], s41 offen offset:2048 lds
v_mfma_f32_16x16x32_bf16 v[184:187], a[96:99], a[124:127], v[184:187]
s_add_u32 s41, s41, 196608
v_mfma_f32_16x16x32_bf16 v[188:191], a[96:99], a[128:131], v[188:191]
v_add_u32 v232, s45, v232
v_mfma_f32_16x16x32_bf16 v[56:59], a[108:111], a[100:103], v[56:59]
v_add_u32 v226, s45, v226
v_mfma_f32_16x16x32_bf16 v[60:63], a[112:115], a[100:103], v[60:63]
v_mfma_f32_16x16x32_bf16 v[120:123], a[116:119], a[100:103], v[120:123]
v_mfma_f32_16x16x32_bf16 v[124:127], a[120:123], a[100:103], v[124:127]
v_mfma_f32_16x16x32_bf16 v[192:195], a[100:103], a[124:127], v[192:195]
v_mfma_f32_16x16x32_bf16 v[196:199], a[100:103], a[128:131], v[196:199]
v_mfma_f32_16x16x32_bf16 v[128:131], a[116:119], a[104:107], v[128:131]
v_mfma_f32_16x16x32_bf16 v[132:135], a[120:123], a[104:107], v[132:135]
v_mfma_f32_16x16x32_bf16 v[200:203], a[104:107], a[124:127], v[200:203]
v_mfma_f32_16x16x32_bf16 v[204:207], a[104:107], a[128:131], v[204:207]
s_sub_u32 s34, s34, 1
s_cmp_lg_u32 s34, 0
s_cbranch_scc1 L1_loop_Q
s_waitcnt vmcnt(16) lgkmcnt(0)
s_barrier
v_mfma_f32_16x16x32_bf16 v[0:3], a[36:39], a[0:3], v[0:3]
ds_read_b64_tr_b16 a[108:109], v224 offset:12288
v_mfma_f32_16x16x32_bf16 v[4:7], a[40:43], a[0:3], v[4:7]
ds_read_b128 a[72:75], v233 offset:0
s_add_u32 m0, s38, s40
v_mfma_f32_16x16x32_bf16 v[64:67], a[44:47], a[0:3], v[64:67]
buffer_load_dwordx4 v234, s[4:7], s37 offen offset:0 lds
v_mfma_f32_16x16x32_bf16 v[68:71], a[48:51], a[0:3], v[68:71]
ds_read_b64_tr_b16 a[110:111], v224 offset:13824
buffer_load_dwordx4 v235, s[4:7], s37 offen offset:1024 lds
v_mfma_f32_16x16x32_bf16 v[136:139], a[0:3], a[52:55], v[136:139]
v_mfma_f32_16x16x32_bf16 v[140:143], a[0:3], a[56:59], v[140:143]
ds_read_b64_tr_b16 a[112:113], v225 offset:12288
v_mfma_f32_16x16x32_bf16 v[8:11], a[36:39], a[4:7], v[8:11]
buffer_load_dwordx4 v234, s[4:7], s37 offen offset:2048 lds
v_mfma_f32_16x16x32_bf16 v[12:15], a[40:43], a[4:7], v[12:15]
ds_read_b128 a[76:79], v233 offset:2048
v_mfma_f32_16x16x32_bf16 v[72:75], a[44:47], a[4:7], v[72:75]
v_mfma_f32_16x16x32_bf16 v[76:79], a[48:51], a[4:7], v[76:79]
ds_read_b64_tr_b16 a[114:115], v225 offset:13824
buffer_load_dwordx4 v235, s[4:7], s37 offen offset:3072 lds
v_mfma_f32_16x16x32_bf16 v[144:147], a[4:7], a[52:55], v[144:147]
s_add_u32 s37, s37, 128
s_add_u32 m0, s38, s50
v_mfma_f32_16x16x32_bf16 v[148:151], a[4:7], a[56:59], v[148:151]
ds_read_b128 a[80:83], v233 offset:4096
v_mfma_f32_16x16x32_bf16 v[16:19], a[36:39], a[8:11], v[16:19]
v_mfma_f32_16x16x32_bf16 v[20:23], a[40:43], a[8:11], v[20:23]
ds_read_b64_tr_b16 a[116:117], v224 offset:12416
buffer_load_dwordx4 v228, s[4:7], s49 offen lds
v_mfma_f32_16x16x32_bf16 v[80:83], a[44:47], a[8:11], v[80:83]
s_add_u32 s49, s49, 128
s_add_u32 s38, s38, 34816
v_mfma_f32_16x16x32_bf16 v[84:87], a[48:51], a[8:11], v[84:87]
ds_read_b128 a[84:87], v233 offset:6144
s_cmp_ge_u32 s38, 153600
v_mfma_f32_16x16x32_bf16 v[152:155], a[8:11], a[52:55], v[152:155]
s_cselect_b32 s38, 49152, s38
s_add_u32 m0, s43, 0
v_mfma_f32_16x16x32_bf16 v[156:159], a[8:11], a[56:59], v[156:159]
ds_read_b64_tr_b16 a[118:119], v224 offset:13952
buffer_load_dwordx4 v236, s[8:11], s41 offen offset:0 lds
v_mfma_f32_16x16x32_bf16 v[24:27], a[36:39], a[12:15], v[24:27]
buffer_load_dwordx4 v237, s[8:11], s41 offen offset:1024 lds
v_mfma_f32_16x16x32_bf16 v[28:31], a[40:43], a[12:15], v[28:31]
ds_read_b64_tr_b16 a[120:121], v225 offset:12416
v_mfma_f32_16x16x32_bf16 v[88:91], a[44:47], a[12:15], v[88:91]
ds_read_b128 a[88:91], v233 offset:8192
buffer_load_dwordx4 v238, s[8:11], s41 offen offset:2048 lds
v_mfma_f32_16x16x32_bf16 v[92:95], a[48:51], a[12:15], v[92:95]
s_add_u32 s41, s41, 196608
s_lshr_b32 s51, s20, 1
v_mfma_f32_16x16x32_bf16 v[160:163], a[12:15], a[52:55], v[160:163]
ds_read_b64_tr_b16 a[122:123], v225 offset:13952
s_and_b32 s59, s20, 1
v_mfma_f32_16x16x32_bf16 v[164:167], a[12:15], a[56:59], v[164:167]
s_lshl_b32 s55, s21, 4
s_lshl_b32 s56, s51, 3
v_mfma_f32_16x16x32_bf16 v[32:35], a[36:39], a[16:19], v[32:35]
ds_read_b128 a[92:95], v233 offset:10240
s_add_u32 s55, s55, s56
v_mfma_f32_16x16x32_bf16 v[36:39], a[40:43], a[16:19], v[36:39]
s_lshl_b32 s55, s55, 12
s_lshr_b32 s56, s22, 1
v_mfma_f32_16x16x32_bf16 v[96:99], a[44:47], a[16:19], v[96:99]
ds_read_b64_tr_b16 a[124:125], v224 offset:12544
s_lshl_b32 s56, s56, 19
v_mfma_f32_16x16x32_bf16 v[100:103], a[48:51], a[16:19], v[100:103]
s_add_u32 s55, s55, s56
s_and_b32 s56, s22, 1
v_mfma_f32_16x16x32_bf16 v[168:171], a[16:19], a[52:55], v[168:171]
ds_read_b128 a[96:99], v233 offset:12288
s_lshl_b32 s56, s56, 11
v_mfma_f32_16x16x32_bf16 v[172:175], a[16:19], a[56:59], v[172:175]
s_add_u32 s55, s55, s56
s_lshl_b32 s56, s59, 10
v_mfma_f32_16x16x32_bf16 v[40:43], a[36:39], a[20:23], v[40:43]
ds_read_b64_tr_b16 a[126:127], v224 offset:14080
s_add_u32 s55, s55, s56
v_mfma_f32_16x16x32_bf16 v[44:47], a[40:43], a[20:23], v[44:47]
s_mov_b32 s56, s55
v_mov_b32 v244, -1
v_mfma_f32_16x16x32_bf16 v[104:107], a[44:47], a[20:23], v[104:107]
ds_read_b64_tr_b16 a[128:129], v225 offset:12544
v_mov_b32 v245, -1
v_mfma_f32_16x16x32_bf16 v[108:111], a[48:51], a[20:23], v[108:111]
v_mov_b32 v246, -1
v_mov_b32 v247, -1
v_mfma_f32_16x16x32_bf16 v[176:179], a[20:23], a[52:55], v[176:179]
ds_read_b128 a[100:103], v233 offset:14336
buffer_store_dwordx4 v[244:247], v253, s[12:15], s56 offen sc1
v_mfma_f32_16x16x32_bf16 v[180:183], a[20:23], a[56:59], v[180:183]
s_add_u32 s56, s56, 4096
buffer_store_dwordx4 v[244:247], v253, s[12:15], s56 offen sc1
v_mfma_f32_16x16x32_bf16 v[48:51], a[36:39], a[24:27], v[48:51]
ds_read_b64_tr_b16 a[130:131], v225 offset:14080
s_add_u32 s56, s56, 4096
v_mfma_f32_16x16x32_bf16 v[52:55], a[40:43], a[24:27], v[52:55]
buffer_store_dwordx4 v[244:247], v253, s[12:15], s56 offen sc1
s_add_u32 s56, s56, 4096
v_mfma_f32_16x16x32_bf16 v[112:115], a[44:47], a[24:27], v[112:115]
ds_read_b128 a[104:107], v227
buffer_store_dwordx4 v[244:247], v253, s[12:15], s56 offen sc1
v_mfma_f32_16x16x32_bf16 v[116:119], a[48:51], a[24:27], v[116:119]
s_add_u32 s56, s56, 4096
buffer_store_dwordx4 v[244:247], v253, s[12:15], s56 offen sc1
v_mfma_f32_16x16x32_bf16 v[184:187], a[24:27], a[52:55], v[184:187]
s_add_u32 s56, s56, 4096
buffer_store_dwordx4 v[244:247], v253, s[12:15], s56 offen sc1
v_mfma_f32_16x16x32_bf16 v[188:191], a[24:27], a[56:59], v[188:191]
s_add_u32 s56, s56, 4096
buffer_store_dwordx4 v[244:247], v253, s[12:15], s56 offen sc1
v_mfma_f32_16x16x32_bf16 v[56:59], a[36:39], a[28:31], v[56:59]
s_add_u32 s56, s56, 4096
buffer_store_dwordx4 v[244:247], v253, s[12:15], s56 offen sc1
v_mfma_f32_16x16x32_bf16 v[60:63], a[40:43], a[28:31], v[60:63]
s_add_u32 s56, s56, 4096
v_mfma_f32_16x16x32_bf16 v[120:123], a[44:47], a[28:31], v[120:123]
v_add_u32 v233, s45, v233
v_mfma_f32_16x16x32_bf16 v[124:127], a[48:51], a[28:31], v[124:127]
v_add_u32 v227, s45, v227
v_mfma_f32_16x16x32_bf16 v[192:195], a[28:31], a[52:55], v[192:195]
s_add_u32 s46, s46, s45
v_mfma_f32_16x16x32_bf16 v[196:199], a[28:31], a[56:59], v[196:199]
s_cmp_eq_u32 s46, 69632
v_mfma_f32_16x16x32_bf16 v[128:131], a[44:47], a[32:35], v[128:131]
s_cselect_b32 s45, s54, s53
v_mfma_f32_16x16x32_bf16 v[132:135], a[48:51], a[32:35], v[132:135]
v_mfma_f32_16x16x32_bf16 v[200:203], a[32:35], a[52:55], v[200:203]
v_mfma_f32_16x16x32_bf16 v[204:207], a[32:35], a[56:59], v[204:207]
s_waitcnt vmcnt(24) lgkmcnt(0)
s_barrier
v_mfma_f32_16x16x32_bf16 v[0:3], a[108:111], a[72:75], v[0:3]
ds_read_b64_tr_b16 a[36:37], v224 offset:24576
v_mfma_f32_16x16x32_bf16 v[4:7], a[112:115], a[72:75], v[4:7]
ds_read_b128 a[0:3], v232 offset:0
v_mfma_f32_16x16x32_bf16 v[64:67], a[116:119], a[72:75], v[64:67]
buffer_load_dwordx4 a[252:255], v253, s[96:99], s94 offen
v_mfma_f32_16x16x32_bf16 v[68:71], a[120:123], a[72:75], v[68:71]
ds_read_b64_tr_b16 a[38:39], v224 offset:26112
v_mfma_f32_16x16x32_bf16 v[136:139], a[72:75], a[124:127], v[136:139]
s_add_u32 s94, s94, s93
v_mfma_f32_16x16x32_bf16 v[140:143], a[72:75], a[128:131], v[140:143]
ds_read_b64_tr_b16 a[40:41], v225 offset:24576
v_mfma_f32_16x16x32_bf16 v[8:11], a[108:111], a[76:79], v[8:11]
s_add_u32 m0, s38, s39
v_mfma_f32_16x16x32_bf16 v[12:15], a[112:115], a[76:79], v[12:15]
ds_read_b128 a[4:7], v232 offset:2048
v_mfma_f32_16x16x32_bf16 v[72:75], a[116:119], a[76:79], v[72:75]
buffer_load_dwordx4 v234, s[4:7], s36 offen offset:0 lds
v_mfma_f32_16x16x32_bf16 v[76:79], a[120:123], a[76:79], v[76:79]
ds_read_b64_tr_b16 a[42:43], v225 offset:26112
v_mfma_f32_16x16x32_bf16 v[144:147], a[76:79], a[124:127], v[144:147]
v_mfma_f32_16x16x32_bf16 v[148:151], a[76:79], a[128:131], v[148:151]
ds_read_b128 a[8:11], v232 offset:4096
v_mfma_f32_16x16x32_bf16 v[16:19], a[108:111], a[80:83], v[16:19]
buffer_load_dwordx4 v235, s[4:7], s36 offen offset:1024 lds
v_mfma_f32_16x16x32_bf16 v[20:23], a[112:115], a[80:83], v[20:23]
ds_read_b64_tr_b16 a[44:45], v224 offset:24704
v_mfma_f32_16x16x32_bf16 v[80:83], a[116:119], a[80:83], v[80:83]
v_mfma_f32_16x16x32_bf16 v[84:87], a[120:123], a[80:83], v[84:87]
ds_read_b128 a[12:15], v232 offset:6144
v_mfma_f32_16x16x32_bf16 v[152:155], a[80:83], a[124:127], v[152:155]
v_mfma_f32_16x16x32_bf16 v[156:159], a[80:83], a[128:131], v[156:159]
ds_read_b64_tr_b16 a[46:47], v224 offset:26240
v_mfma_f32_16x16x32_bf16 v[24:27], a[108:111], a[84:87], v[24:27]
buffer_load_dwordx4 v234, s[4:7], s36 offen offset:2048 lds
v_mfma_f32_16x16x32_bf16 v[28:31], a[112:115], a[84:87], v[28:31]
ds_read_b64_tr_b16 a[48:49], v225 offset:24704
v_mfma_f32_16x16x32_bf16 v[88:91], a[116:119], a[84:87], v[88:91]
ds_read_b128 a[16:19], v232 offset:8192
v_mfma_f32_16x16x32_bf16 v[92:95], a[120:123], a[84:87], v[92:95]
v_mfma_f32_16x16x32_bf16 v[160:163], a[84:87], a[124:127], v[160:163]
ds_read_b64_tr_b16 a[50:51], v225 offset:26240
v_mfma_f32_16x16x32_bf16 v[164:167], a[84:87], a[128:131], v[164:167]
buffer_load_dwordx4 v235, s[4:7], s36 offen offset:3072 lds
v_mfma_f32_16x16x32_bf16 v[32:35], a[108:111], a[88:91], v[32:35]
ds_read_b128 a[20:23], v232 offset:10240
v_mfma_f32_16x16x32_bf16 v[36:39], a[112:115], a[88:91], v[36:39]
s_add_u32 s36, s36, 128
v_mfma_f32_16x16x32_bf16 v[96:99], a[116:119], a[88:91], v[96:99]
ds_read_b64_tr_b16 a[52:53], v224 offset:24832
v_mfma_f32_16x16x32_bf16 v[100:103], a[120:123], a[88:91], v[100:103]
s_add_u32 m0, s43, 12288
v_mfma_f32_16x16x32_bf16 v[168:171], a[88:91], a[124:127], v[168:171]
ds_read_b128 a[24:27], v232 offset:12288
v_mfma_f32_16x16x32_bf16 v[172:175], a[88:91], a[128:131], v[172:175]
buffer_load_dwordx4 v236, s[8:11], s41 offen offset:0 lds
v_mfma_f32_16x16x32_bf16 v[40:43], a[108:111], a[92:95], v[40:43]
ds_read_b64_tr_b16 a[54:55], v224 offset:26368
v_mfma_f32_16x16x32_bf16 v[44:47], a[112:115], a[92:95], v[44:47]
v_mfma_f32_16x16x32_bf16 v[104:107], a[116:119], a[92:95], v[104:107]
ds_read_b64_tr_b16 a[56:57], v225 offset:24832
v_mfma_f32_16x16x32_bf16 v[108:111], a[120:123], a[92:95], v[108:111]
v_mfma_f32_16x16x32_bf16 v[176:179], a[92:95], a[124:127], v[176:179]
ds_read_b128 a[28:31], v232 offset:14336
v_mfma_f32_16x16x32_bf16 v[180:183], a[92:95], a[128:131], v[180:183]
buffer_load_dwordx4 v237, s[8:11], s41 offen offset:1024 lds
v_mfma_f32_16x16x32_bf16 v[48:51], a[108:111], a[96:99], v[48:51]
ds_read_b64_tr_b16 a[58:59], v225 offset:26368
v_mfma_f32_16x16x32_bf16 v[52:55], a[112:115], a[96:99], v[52:55]
v_mfma_f32_16x16x32_bf16 v[112:115], a[116:119], a[96:99], v[112:115]
ds_read_b128 a[32:35], v226
v_mfma_f32_16x16x32_bf16 v[116:119], a[120:123], a[96:99], v[116:119]
buffer_load_dwordx4 v238, s[8:11], s41 offen offset:2048 lds
v_mfma_f32_16x16x32_bf16 v[184:187], a[96:99], a[124:127], v[184:187]
s_add_u32 s41, s41, 196608
v_mfma_f32_16x16x32_bf16 v[188:191], a[96:99], a[128:131], v[188:191]
v_add_u32 v232, s45, v232
v_mfma_f32_16x16x32_bf16 v[56:59], a[108:111], a[100:103], v[56:59]
v_add_u32 v226, s45, v226
v_mfma_f32_16x16x32_bf16 v[60:63], a[112:115], a[100:103], v[60:63]
v_mfma_f32_16x16x32_bf16 v[120:123], a[116:119], a[100:103], v[120:123]
v_mfma_f32_16x16x32_bf16 v[124:127], a[120:123], a[100:103], v[124:127]
v_mfma_f32_16x16x32_bf16 v[192:195], a[100:103], a[124:127], v[192:195]
v_mfma_f32_16x16x32_bf16 v[196:199], a[100:103], a[128:131], v[196:199]
v_mfma_f32_16x16x32_bf16 v[128:131], a[116:119], a[104:107], v[128:131]
v_mfma_f32_16x16x32_bf16 v[132:135], a[120:123], a[104:107], v[132:135]
v_mfma_f32_16x16x32_bf16 v[200:203], a[104:107], a[124:127], v[200:203]
v_mfma_f32_16x16x32_bf16 v[204:207], a[104:107], a[128:131], v[204:207]
s_waitcnt vmcnt(24) lgkmcnt(0)
s_barrier
v_mfma_f32_16x16x32_bf16 v[0:3], a[36:39], a[0:3], v[0:3]
ds_read_b64_tr_b16 a[108:109], v224 offset:36864
v_mfma_f32_16x16x32_bf16 v[4:7], a[40:43], a[0:3], v[4:7]
ds_read_b128 a[72:75], v233 offset:0
v_mfma_f32_16x16x32_bf16 v[64:67], a[44:47], a[0:3], v[64:67]
s_add_u32 m0, s38, s40
v_mfma_f32_16x16x32_bf16 v[68:71], a[48:51], a[0:3], v[68:71]
ds_read_b64_tr_b16 a[110:111], v224 offset:38400
v_mfma_f32_16x16x32_bf16 v[136:139], a[0:3], a[52:55], v[136:139]
buffer_load_dwordx4 v234, s[4:7], s37 offen offset:0 lds
v_mfma_f32_16x16x32_bf16 v[140:143], a[0:3], a[56:59], v[140:143]
ds_read_b64_tr_b16 a[112:113], v225 offset:36864
v_mfma_f32_16x16x32_bf16 v[8:11], a[36:39], a[4:7], v[8:11]
buffer_load_dwordx4 v235, s[4:7], s37 offen offset:1024 lds
v_mfma_f32_16x16x32_bf16 v[12:15], a[40:43], a[4:7], v[12:15]
ds_read_b128 a[76:79], v233 offset:2048
v_mfma_f32_16x16x32_bf16 v[72:75], a[44:47], a[4:7], v[72:75]
v_mfma_f32_16x16x32_bf16 v[76:79], a[48:51], a[4:7], v[76:79]
ds_read_b64_tr_b16 a[114:115], v225 offset:38400
v_mfma_f32_16x16x32_bf16 v[144:147], a[4:7], a[52:55], v[144:147]
v_mfma_f32_16x16x32_bf16 v[148:151], a[4:7], a[56:59], v[148:151]
ds_read_b128 a[80:83], v233 offset:4096
v_mfma_f32_16x16x32_bf16 v[16:19], a[36:39], a[8:11], v[16:19]
buffer_load_dwordx4 v234, s[4:7], s37 offen offset:2048 lds
v_mfma_f32_16x16x32_bf16 v[20:23], a[40:43], a[8:11], v[20:23]
ds_read_b64_tr_b16 a[116:117], v224 offset:36992
v_mfma_f32_16x16x32_bf16 v[80:83], a[44:47], a[8:11], v[80:83]
v_mfma_f32_16x16x32_bf16 v[84:87], a[48:51], a[8:11], v[84:87]
ds_read_b128 a[84:87], v233 offset:6144
v_mfma_f32_16x16x32_bf16 v[152:155], a[8:11], a[52:55], v[152:155]
v_mfma_f32_16x16x32_bf16 v[156:159], a[8:11], a[56:59], v[156:159]
ds_read_b64_tr_b16 a[118:119], v224 offset:38528
v_mfma_f32_16x16x32_bf16 v[24:27], a[36:39], a[12:15], v[24:27]
buffer_load_dwordx4 v235, s[4:7], s37 offen offset:3072 lds
v_mfma_f32_16x16x32_bf16 v[28:31], a[40:43], a[12:15], v[28:31]
ds_read_b64_tr_b16 a[120:121], v225 offset:36992
v_mfma_f32_16x16x32_bf16 v[88:91], a[44:47], a[12:15], v[88:91]
ds_read_b128 a[88:91], v233 offset:8192
v_mfma_f32_16x16x32_bf16 v[92:95], a[48:51], a[12:15], v[92:95]
s_add_u32 s37, s37, 128
v_mfma_f32_16x16x32_bf16 v[160:163], a[12:15], a[52:55], v[160:163]
ds_read_b64_tr_b16 a[122:123], v225 offset:38528
v_mfma_f32_16x16x32_bf16 v[164:167], a[12:15], a[56:59], v[164:167]
s_add_u32 m0, s38, s50
v_mfma_f32_16x16x32_bf16 v[32:35], a[36:39], a[16:19], v[32:35]
ds_read_b128 a[92:95], v233 offset:10240
v_mfma_f32_16x16x32_bf16 v[36:39], a[40:43], a[16:19], v[36:39]
buffer_load_dwordx4 v228, s[4:7], s49 offen lds
v_mfma_f32_16x16x32_bf16 v[96:99], a[44:47], a[16:19], v[96:99]
ds_read_b64_tr_b16 a[124:125], v224 offset:37120
v_mfma_f32_16x16x32_bf16 v[100:103], a[48:51], a[16:19], v[100:103]
s_add_u32 s49, s49, 128
v_mfma_f32_16x16x32_bf16 v[168:171], a[16:19], a[52:55], v[168:171]
ds_read_b128 a[96:99], v233 offset:12288
v_mfma_f32_16x16x32_bf16 v[172:175], a[16:19], a[56:59], v[172:175]
s_add_u32 s38, s38, 34816
v_mfma_f32_16x16x32_bf16 v[40:43], a[36:39], a[20:23], v[40:43]
ds_read_b64_tr_b16 a[126:127], v224 offset:38656
v_mfma_f32_16x16x32_bf16 v[44:47], a[40:43], a[20:23], v[44:47]
s_cmp_ge_u32 s38, 153600
v_mfma_f32_16x16x32_bf16 v[104:107], a[44:47], a[20:23], v[104:107]
ds_read_b64_tr_b16 a[128:129], v225 offset:37120
v_mfma_f32_16x16x32_bf16 v[108:111], a[48:51], a[20:23], v[108:111]
s_cselect_b32 s38, 49152, s38
v_mfma_f32_16x16x32_bf16 v[176:179], a[20:23], a[52:55], v[176:179]
ds_read_b128 a[100:103], v233 offset:14336
v_mfma_f32_16x16x32_bf16 v[180:183], a[20:23], a[56:59], v[180:183]
s_add_u32 m0, s43, 24576
v_mfma_f32_16x16x32_bf16 v[48:51], a[36:39], a[24:27], v[48:51]
ds_read_b64_tr_b16 a[130:131], v225 offset:38656
v_mfma_f32_16x16x32_bf16 v[52:55], a[40:43], a[24:27], v[52:55]
buffer_load_dwordx4 v236, s[8:11], s41 offen offset:0 lds
v_mfma_f32_16x16x32_bf16 v[112:115], a[44:47], a[24:27], v[112:115]
ds_read_b128 a[104:107], v227
v_mfma_f32_16x16x32_bf16 v[116:119], a[48:51], a[24:27], v[116:119]
buffer_load_dwordx4 v237, s[8:11], s41 offen offset:1024 lds
v_mfma_f32_16x16x32_bf16 v[184:187], a[24:27], a[52:55], v[184:187]
buffer_load_dwordx4 v238, s[8:11], s41 offen offset:2048 lds
v_mfma_f32_16x16x32_bf16 v[188:191], a[24:27], a[56:59], v[188:191]
s_add_u32 s41, s41, 196608
v_mfma_f32_16x16x32_bf16 v[56:59], a[36:39], a[28:31], v[56:59]
v_add_u32 v233, s45, v233
v_mfma_f32_16x16x32_bf16 v[60:63], a[40:43], a[28:31], v[60:63]
v_add_u32 v227, s45, v227
v_mfma_f32_16x16x32_bf16 v[120:123], a[44:47], a[28:31], v[120:123]
s_add_u32 s46, s46, s45
v_mfma_f32_16x16x32_bf16 v[124:127], a[48:51], a[28:31], v[124:127]
s_cmp_eq_u32 s46, 69632
v_mfma_f32_16x16x32_bf16 v[192:195], a[28:31], a[52:55], v[192:195]
s_cselect_b32 s45, s54, s53
v_mfma_f32_16x16x32_bf16 v[196:199], a[28:31], a[56:59], v[196:199]
v_mfma_f32_16x16x32_bf16 v[128:131], a[44:47], a[32:35], v[128:131]
v_mfma_f32_16x16x32_bf16 v[132:135], a[48:51], a[32:35], v[132:135]
v_mfma_f32_16x16x32_bf16 v[200:203], a[32:35], a[52:55], v[200:203]
v_mfma_f32_16x16x32_bf16 v[204:207], a[32:35], a[56:59], v[204:207]
s_waitcnt vmcnt(24) lgkmcnt(0)
s_barrier
v_mfma_f32_16x16x32_bf16 v[0:3], a[108:111], a[72:75], v[0:3]
ds_read_b64_tr_b16 a[36:37], v224 offset:0
v_mfma_f32_16x16x32_bf16 v[4:7], a[112:115], a[72:75], v[4:7]
ds_read_b128 a[0:3], v232 offset:0
v_mfma_f32_16x16x32_bf16 v[64:67], a[116:119], a[72:75], v[64:67]
buffer_load_dwordx4 a[252:255], v253, s[96:99], s94 offen
v_mfma_f32_16x16x32_bf16 v[68:71], a[120:123], a[72:75], v[68:71]
ds_read_b64_tr_b16 a[38:39], v224 offset:1536
v_mfma_f32_16x16x32_bf16 v[136:139], a[72:75], a[124:127], v[136:139]
s_add_u32 s94, s94, s93
v_mfma_f32_16x16x32_bf16 v[140:143], a[72:75], a[128:131], v[140:143]
ds_read_b64_tr_b16 a[40:41], v225 offset:0
v_mfma_f32_16x16x32_bf16 v[8:11], a[108:111], a[76:79], v[8:11]
s_add_u32 m0, s38, s39
v_mfma_f32_16x16x32_bf16 v[12:15], a[112:115], a[76:79], v[12:15]
ds_read_b128 a[4:7], v232 offset:2048
v_mfma_f32_16x16x32_bf16 v[72:75], a[116:119], a[76:79], v[72:75]
buffer_load_dwordx4 v234, s[4:7], s36 offen offset:0 lds
v_mfma_f32_16x16x32_bf16 v[76:79], a[120:123], a[76:79], v[76:79]
ds_read_b64_tr_b16 a[42:43], v225 offset:1536
v_mfma_f32_16x16x32_bf16 v[144:147], a[76:79], a[124:127], v[144:147]
v_mfma_f32_16x16x32_bf16 v[148:151], a[76:79], a[128:131], v[148:151]
ds_read_b128 a[8:11], v232 offset:4096
v_mfma_f32_16x16x32_bf16 v[16:19], a[108:111], a[80:83], v[16:19]
buffer_load_dwordx4 v235, s[4:7], s36 offen offset:1024 lds
v_mfma_f32_16x16x32_bf16 v[20:23], a[112:115], a[80:83], v[20:23]
ds_read_b64_tr_b16 a[44:45], v224 offset:128
v_mfma_f32_16x16x32_bf16 v[80:83], a[116:119], a[80:83], v[80:83]
v_mfma_f32_16x16x32_bf16 v[84:87], a[120:123], a[80:83], v[84:87]
ds_read_b128 a[12:15], v232 offset:6144
v_mfma_f32_16x16x32_bf16 v[152:155], a[80:83], a[124:127], v[152:155]
v_mfma_f32_16x16x32_bf16 v[156:159], a[80:83], a[128:131], v[156:159]
ds_read_b64_tr_b16 a[46:47], v224 offset:1664
v_mfma_f32_16x16x32_bf16 v[24:27], a[108:111], a[84:87], v[24:27]
buffer_load_dwordx4 v234, s[4:7], s36 offen offset:2048 lds
v_mfma_f32_16x16x32_bf16 v[28:31], a[112:115], a[84:87], v[28:31]
ds_read_b64_tr_b16 a[48:49], v225 offset:128
v_mfma_f32_16x16x32_bf16 v[88:91], a[116:119], a[84:87], v[88:91]
ds_read_b128 a[16:19], v232 offset:8192
v_mfma_f32_16x16x32_bf16 v[92:95], a[120:123], a[84:87], v[92:95]
v_mfma_f32_16x16x32_bf16 v[160:163], a[84:87], a[124:127], v[160:163]
ds_read_b64_tr_b16 a[50:51], v225 offset:1664
v_mfma_f32_16x16x32_bf16 v[164:167], a[84:87], a[128:131], v[164:167]
buffer_load_dwordx4 v235, s[4:7], s36 offen offset:3072 lds
v_mfma_f32_16x16x32_bf16 v[32:35], a[108:111], a[88:91], v[32:35]
ds_read_b128 a[20:23], v232 offset:10240
v_mfma_f32_16x16x32_bf16 v[36:39], a[112:115], a[88:91], v[36:39]
s_add_u32 s36, s36, 128
v_mfma_f32_16x16x32_bf16 v[96:99], a[116:119], a[88:91], v[96:99]
ds_read_b64_tr_b16 a[52:53], v224 offset:256
v_mfma_f32_16x16x32_bf16 v[100:103], a[120:123], a[88:91], v[100:103]
s_add_u32 m0, s43, 36864
v_mfma_f32_16x16x32_bf16 v[168:171], a[88:91], a[124:127], v[168:171]
ds_read_b128 a[24:27], v232 offset:12288
v_mfma_f32_16x16x32_bf16 v[172:175], a[88:91], a[128:131], v[172:175]
buffer_load_dwordx4 v236, s[8:11], s41 offen offset:0 lds
v_mfma_f32_16x16x32_bf16 v[40:43], a[108:111], a[92:95], v[40:43]
ds_read_b64_tr_b16 a[54:55], v224 offset:1792
v_mfma_f32_16x16x32_bf16 v[44:47], a[112:115], a[92:95], v[44:47]
v_mfma_f32_16x16x32_bf16 v[104:107], a[116:119], a[92:95], v[104:107]
ds_read_b64_tr_b16 a[56:57], v225 offset:256
v_mfma_f32_16x16x32_bf16 v[108:111], a[120:123], a[92:95], v[108:111]
v_mfma_f32_16x16x32_bf16 v[176:179], a[92:95], a[124:127], v[176:179]
ds_read_b128 a[28:31], v232 offset:14336
v_mfma_f32_16x16x32_bf16 v[180:183], a[92:95], a[128:131], v[180:183]
buffer_load_dwordx4 v237, s[8:11], s41 offen offset:1024 lds
v_mfma_f32_16x16x32_bf16 v[48:51], a[108:111], a[96:99], v[48:51]
ds_read_b64_tr_b16 a[58:59], v225 offset:1792
v_mfma_f32_16x16x32_bf16 v[52:55], a[112:115], a[96:99], v[52:55]
v_mfma_f32_16x16x32_bf16 v[112:115], a[116:119], a[96:99], v[112:115]
ds_read_b128 a[32:35], v226
v_mfma_f32_16x16x32_bf16 v[116:119], a[120:123], a[96:99], v[116:119]
buffer_load_dwordx4 v238, s[8:11], s41 offen offset:2048 lds
v_mfma_f32_16x16x32_bf16 v[184:187], a[96:99], a[124:127], v[184:187]
s_add_u32 s41, s41, 196608
v_mfma_f32_16x16x32_bf16 v[188:191], a[96:99], a[128:131], v[188:191]
v_add_u32 v232, s45, v232
v_mfma_f32_16x16x32_bf16 v[56:59], a[108:111], a[100:103], v[56:59]
v_add_u32 v226, s45, v226
v_mfma_f32_16x16x32_bf16 v[60:63], a[112:115], a[100:103], v[60:63]
v_mfma_f32_16x16x32_bf16 v[120:123], a[116:119], a[100:103], v[120:123]
v_mfma_f32_16x16x32_bf16 v[124:127], a[120:123], a[100:103], v[124:127]
v_mfma_f32_16x16x32_bf16 v[192:195], a[100:103], a[124:127], v[192:195]
v_mfma_f32_16x16x32_bf16 v[196:199], a[100:103], a[128:131], v[196:199]
v_mfma_f32_16x16x32_bf16 v[128:131], a[116:119], a[104:107], v[128:131]
v_mfma_f32_16x16x32_bf16 v[132:135], a[120:123], a[104:107], v[132:135]
v_mfma_f32_16x16x32_bf16 v[200:203], a[104:107], a[124:127], v[200:203]
v_mfma_f32_16x16x32_bf16 v[204:207], a[104:107], a[128:131], v[204:207]
L1_nonce_Q:
v_accvgpr_read_b32 v244, a168
v_accvgpr_read_b32 v245, a169
s_add_u32 s34, s34, 1
v_readfirstlane_b32 s58, v244
v_readfirstlane_b32 s59, v245
s_cmp_lg_u32 s58, 0
s_cbranch_scc1 L1_nonce_ok_Q
s_cmp_gt_u32 s34, 0x80000
s_cbranch_scc1 L1_nonce_ok_Q
s_sleep 2
buffer_load_dwordx2 a[168:169], v253, s[16:19], 0 offen sc1
s_waitcnt vmcnt(0)
s_branch L1_nonce_Q
L1_nonce_ok_Q:
v_mov_b32 v244, s58
v_mov_b32 v245, s59
v_accvgpr_write_b32 a168, v244
v_accvgpr_write_b32 a169, v245
s_waitcnt vmcnt(16) lgkmcnt(0)
s_barrier
v_mfma_f32_16x16x32_bf16 v[0:3], a[36:39], a[0:3], v[0:3]
ds_read_b64_tr_b16 a[108:109], v224 offset:12288
v_mfma_f32_16x16x32_bf16 v[4:7], a[40:43], a[0:3], v[4:7]
ds_read_b128 a[72:75], v233 offset:0
s_lshl_b32 s51, s21, 4
v_mfma_f32_16x16x32_bf16 v[64:67], a[44:47], a[0:3], v[64:67]
s_add_u32 s51, s51, s22
s_lshl_b32 s51, s51, 3
v_mfma_f32_16x16x32_bf16 v[68:71], a[48:51], a[0:3], v[68:71]
ds_read_b64_tr_b16 a[110:111], v224 offset:13824
s_add_u32 s51, s51, 0x1440800
v_mfma_f32_16x16x32_bf16 v[136:139], a[0:3], a[52:55], v[136:139]
s_cmp_eq_u32 s20, 0
s_cselect_b32 s51, s51, 0x40000000
v_mfma_f32_16x16x32_bf16 v[140:143], a[0:3], a[56:59], v[140:143]
ds_read_b64_tr_b16 a[112:113], v225 offset:12288
v_mov_b32 v235, 0
v_mfma_f32_16x16x32_bf16 v[8:11], a[36:39], a[4:7], v[8:11]
buffer_store_dwordx2 v[244:245], v235, s[12:15], s51 offen sc1
buffer_store_dword v241, v243, s[12:15], s3 offen sc1
v_mfma_f32_16x16x32_bf16 v[12:15], a[40:43], a[4:7], v[12:15]
ds_read_b128 a[76:79], v233 offset:2048
s_mov_b32 s8, s24
v_mfma_f32_16x16x32_bf16 v[72:75], a[44:47], a[4:7], v[72:75]
s_and_b32 s9, s25, 0xffff
s_mov_b32 s10, 0x200000
v_mfma_f32_16x16x32_bf16 v[76:79], a[48:51], a[4:7], v[76:79]
ds_read_b64_tr_b16 a[114:115], v225 offset:13824
s_mov_b32 s11, 0x20000
v_mfma_f32_16x16x32_bf16 v[144:147], a[4:7], a[52:55], v[144:147]
s_mov_b32 s16, s26
s_and_b32 s17, s27, 0xffff
v_mfma_f32_16x16x32_bf16 v[148:151], a[4:7], a[56:59], v[148:151]
ds_read_b128 a[80:83], v233 offset:4096
s_mov_b32 s18, 0x700000
v_mfma_f32_16x16x32_bf16 v[16:19], a[36:39], a[8:11], v[16:19]
s_mov_b32 s19, 0x20000
s_add_u32 s42, s35, 2097152
v_mfma_f32_16x16x32_bf16 v[20:23], a[40:43], a[8:11], v[20:23]
ds_read_b64_tr_b16 a[116:117], v224 offset:12416
buffer_load_dwordx4 a[252:255], v253, s[16:19], s42 offen
v_mfma_f32_16x16x32_bf16 v[80:83], a[44:47], a[8:11], v[80:83]
s_add_u32 s42, s35, 0
buffer_load_dwordx4 a[252:255], v253, s[16:19], s42 offen
v_mfma_f32_16x16x32_bf16 v[84:87], a[48:51], a[8:11], v[84:87]
ds_read_b128 a[84:87], v233 offset:6144
s_add_u32 s42, s35, 3145728
v_mfma_f32_16x16x32_bf16 v[152:155], a[8:11], a[52:55], v[152:155]
buffer_load_dwordx4 a[252:255], v253, s[16:19], s42 offen
s_add_u32 s42, s35, 1048576
v_mfma_f32_16x16x32_bf16 v[156:159], a[8:11], a[56:59], v[156:159]
ds_read_b64_tr_b16 a[118:119], v224 offset:13952
buffer_load_dwordx4 a[252:255], v253, s[16:19], s42 offen
v_mfma_f32_16x16x32_bf16 v[24:27], a[36:39], a[12:15], v[24:27]
v_lshrrev_b32 v250, 4, v254
v_and_b32 v251, 15, v254
v_mfma_f32_16x16x32_bf16 v[28:31], a[40:43], a[12:15], v[28:31]
ds_read_b64_tr_b16 a[120:121], v225 offset:12416
v_lshlrev_b32 v252, 1, v250
v_mfma_f32_16x16x32_bf16 v[88:91], a[44:47], a[12:15], v[88:91]
ds_read_b128 a[88:91], v233 offset:8192
v_xor_b32 v251, v252, v251
v_mfma_f32_16x16x32_bf16 v[92:95], a[48:51], a[12:15], v[92:95]
v_lshlrev_b32 v250, 11, v250
v_lshl_add_u32 v244, v251, 4, v250
v_mfma_f32_16x16x32_bf16 v[160:163], a[12:15], a[52:55], v[160:163]
ds_read_b64_tr_b16 a[122:123], v225 offset:13952
v_xor_b32 v251, 8, v251
v_mfma_f32_16x16x32_bf16 v[164:167], a[12:15], a[56:59], v[164:167]
v_lshl_add_u32 v251, v251, 4, v250
v_add_u32 v245, 7168, v251
v_mfma_f32_16x16x32_bf16 v[32:35], a[36:39], a[16:19], v[32:35]
ds_read_b128 a[92:95], v233 offset:10240
v_add_u32 v246, 14336, v244
v_mfma_f32_16x16x32_bf16 v[36:39], a[40:43], a[16:19], v[36:39]
v_add_u32 v247, 21504, v251
v_mfma_f32_16x16x32_bf16 v[96:99], a[44:47], a[16:19], v[96:99]
ds_read_b64_tr_b16 a[124:125], v224 offset:12544
v_mfma_f32_16x16x32_bf16 v[100:103], a[48:51], a[16:19], v[100:103]
v_mfma_f32_16x16x32_bf16 v[168:171], a[16:19], a[52:55], v[168:171]
ds_read_b128 a[96:99], v233 offset:12288
v_mfma_f32_16x16x32_bf16 v[172:175], a[16:19], a[56:59], v[172:175]
v_mfma_f32_16x16x32_bf16 v[40:43], a[36:39], a[20:23], v[40:43]
ds_read_b64_tr_b16 a[126:127], v224 offset:14080
v_mfma_f32_16x16x32_bf16 v[44:47], a[40:43], a[20:23], v[44:47]
v_mfma_f32_16x16x32_bf16 v[104:107], a[44:47], a[20:23], v[104:107]
ds_read_b64_tr_b16 a[128:129], v225 offset:12544
v_mfma_f32_16x16x32_bf16 v[108:111], a[48:51], a[20:23], v[108:111]
v_mfma_f32_16x16x32_bf16 v[176:179], a[20:23], a[52:55], v[176:179]
ds_read_b128 a[100:103], v233 offset:14336
v_mfma_f32_16x16x32_bf16 v[180:183], a[20:23], a[56:59], v[180:183]
v_mfma_f32_16x16x32_bf16 v[48:51], a[36:39], a[24:27], v[48:51]
ds_read_b64_tr_b16 a[130:131], v225 offset:14080
v_mfma_f32_16x16x32_bf16 v[52:55], a[40:43], a[24:27], v[52:55]
v_mfma_f32_16x16x32_bf16 v[112:115], a[44:47], a[24:27], v[112:115]
ds_read_b128 a[104:107], v227
v_mfma_f32_16x16x32_bf16 v[116:119], a[48:51], a[24:27], v[116:119]
v_add_u32 v233, s45, v233
v_mfma_f32_16x16x32_bf16 v[184:187], a[24:27], a[52:55], v[184:187]
v_add_u32 v227, s45, v227
v_mfma_f32_16x16x32_bf16 v[188:191], a[24:27], a[56:59], v[188:191]
s_add_u32 s46, s46, s45
v_mfma_f32_16x16x32_bf16 v[56:59], a[36:39], a[28:31], v[56:59]
s_cmp_eq_u32 s46, 69632
v_mfma_f32_16x16x32_bf16 v[60:63], a[40:43], a[28:31], v[60:63]
s_cselect_b32 s45, s54, s53
v_mfma_f32_16x16x32_bf16 v[120:123], a[44:47], a[28:31], v[120:123]
v_mfma_f32_16x16x32_bf16 v[124:127], a[48:51], a[28:31], v[124:127]
v_mfma_f32_16x16x32_bf16 v[192:195], a[28:31], a[52:55], v[192:195]
v_mfma_f32_16x16x32_bf16 v[196:199], a[28:31], a[56:59], v[196:199]
v_mfma_f32_16x16x32_bf16 v[128:131], a[44:47], a[32:35], v[128:131]
v_mfma_f32_16x16x32_bf16 v[132:135], a[48:51], a[32:35], v[132:135]
v_mfma_f32_16x16x32_bf16 v[200:203], a[32:35], a[52:55], v[200:203]
v_mfma_f32_16x16x32_bf16 v[204:207], a[32:35], a[56:59], v[204:207]
s_waitcnt vmcnt(14) lgkmcnt(0)
s_barrier
v_mfma_f32_16x16x32_bf16 v[0:3], a[108:111], a[72:75], v[0:3]
ds_read_b64_tr_b16 a[36:37], v224 offset:24576
v_mfma_f32_16x16x32_bf16 v[4:7], a[112:115], a[72:75], v[4:7]
ds_read_b128 a[0:3], v232 offset:0
s_add_u32 s42, s35, 4194304
v_mfma_f32_16x16x32_bf16 v[64:67], a[116:119], a[72:75], v[64:67]
buffer_load_dwordx4 a[252:255], v253, s[16:19], s42 offen
s_add_u32 s42, s35, 5242880
v_mfma_f32_16x16x32_bf16 v[68:71], a[120:123], a[72:75], v[68:71]
ds_read_b64_tr_b16 a[38:39], v224 offset:26112
buffer_load_dwordx4 a[252:255], v253, s[16:19], s42 offen
v_mfma_f32_16x16x32_bf16 v[136:139], a[72:75], a[124:127], v[136:139]
s_add_u32 s42, s35, 6291456
buffer_load_dwordx4 a[252:255], v253, s[16:19], s42 offen
v_mfma_f32_16x16x32_bf16 v[140:143], a[72:75], a[128:131], v[140:143]
ds_read_b64_tr_b16 a[40:41], v225 offset:24576
s_and_b32 s51, s2, 7
v_mfma_f32_16x16x32_bf16 v[8:11], a[108:111], a[76:79], v[8:11]
s_xor_b32 s94, s23, 1
s_lshr_b32 s92, s51, 1
v_mfma_f32_16x16x32_bf16 v[12:15], a[112:115], a[76:79], v[12:15]
ds_read_b128 a[4:7], v232 offset:2048
s_lshl_b32 s92, s92, 2
v_mfma_f32_16x16x32_bf16 v[72:75], a[116:119], a[76:79], v[72:75]
s_and_b32 s53, s21, 3
s_add_u32 s92, s92, s53
v_mfma_f32_16x16x32_bf16 v[76:79], a[120:123], a[76:79], v[76:79]
ds_read_b64_tr_b16 a[42:43], v225 offset:26112
s_and_b32 s93, s51, 1
v_mfma_f32_16x16x32_bf16 v[144:147], a[76:79], a[124:127], v[144:147]
s_lshl_b32 s93, s93, 2
s_and_b32 s53, s22, 3
v_mfma_f32_16x16x32_bf16 v[148:151], a[76:79], a[128:131], v[148:151]
ds_read_b128 a[8:11], v232 offset:4096
s_add_u32 s93, s93, s53
v_mfma_f32_16x16x32_bf16 v[16:19], a[108:111], a[80:83], v[16:19]
s_lshl_b32 s96, s94, 20
s_lshl_b32 s97, s20, 16
v_mfma_f32_16x16x32_bf16 v[20:23], a[112:115], a[80:83], v[20:23]
ds_read_b64_tr_b16 a[44:45], v224 offset:24704
s_lshl_b32 s52, s93, 8
v_mfma_f32_16x16x32_bf16 v[80:83], a[116:119], a[80:83], v[80:83]
s_add_u32 s97, s97, s52
s_add_u32 s96, s96, s97
v_mfma_f32_16x16x32_bf16 v[84:87], a[120:123], a[80:83], v[84:87]
ds_read_b128 a[12:15], v232 offset:6144
s_lshl_b32 s98, s20, 13
v_mfma_f32_16x16x32_bf16 v[152:155], a[80:83], a[124:127], v[152:155]
s_lshr_b32 s48, s92, 1
s_lshl_b32 s48, s48, 7
v_mfma_f32_16x16x32_bf16 v[156:159], a[80:83], a[128:131], v[156:159]
ds_read_b64_tr_b16 a[46:47], v224 offset:26240
s_add_u32 s48, s48, 0x1440800
v_mfma_f32_16x16x32_bf16 v[24:27], a[108:111], a[84:87], v[24:27]
s_add_u32 s34, s55, 0
s_add_u32 s35, s55, 4096
v_mfma_f32_16x16x32_bf16 v[28:31], a[112:115], a[84:87], v[28:31]
ds_read_b64_tr_b16 a[48:49], v225 offset:24704
s_add_u32 s36, s55, 8192
v_mfma_f32_16x16x32_bf16 v[88:91], a[116:119], a[84:87], v[88:91]
ds_read_b128 a[16:19], v232 offset:8192
s_add_u32 s37, s55, 12288
v_mfma_f32_16x16x32_bf16 v[92:95], a[120:123], a[84:87], v[92:95]
s_add_u32 s38, s55, 16384
s_add_u32 s39, s55, 20480
v_mfma_f32_16x16x32_bf16 v[160:163], a[84:87], a[124:127], v[160:163]
ds_read_b64_tr_b16 a[50:51], v225 offset:26240
s_add_u32 s40, s55, 24576
v_mfma_f32_16x16x32_bf16 v[164:167], a[84:87], a[128:131], v[164:167]
s_add_u32 s41, s55, 28672
s_mov_b32 s42, 0x3e3504f3
v_mfma_f32_16x16x32_bf16 v[32:35], a[108:111], a[88:91], v[32:35]
ds_read_b128 a[20:23], v232 offset:10240
s_mov_b32 s43, 0x3e3504f3
v_mfma_f32_16x16x32_bf16 v[36:39], a[112:115], a[88:91], v[36:39]
s_mov_b32 s44, 0x3fb8aa3b
s_mov_b32 s47, 0xffff0000
v_mfma_f32_16x16x32_bf16 v[96:99], a[116:119], a[88:91], v[96:99]
ds_read_b64_tr_b16 a[52:53], v224 offset:24832
v_mov_b32 v252, 0xff800000
v_mfma_f32_16x16x32_bf16 v[100:103], a[120:123], a[88:91], v[100:103]
v_accvgpr_read_b32 v248, a170
v_accvgpr_read_b32 v249, a171
v_mfma_f32_16x16x32_bf16 v[168:171], a[88:91], a[124:127], v[168:171]
ds_read_b128 a[24:27], v232 offset:12288
v_accvgpr_read_b32 v250, a172
v_mfma_f32_16x16x32_bf16 v[172:175], a[88:91], a[128:131], v[172:175]
v_accvgpr_read_b32 v251, a173
v_mfma_f32_16x16x32_bf16 v[40:43], a[108:111], a[92:95], v[40:43]
ds_read_b64_tr_b16 a[54:55], v224 offset:26368
v_mfma_f32_16x16x32_bf16 v[44:47], a[112:115], a[92:95], v[44:47]
v_mfma_f32_16x16x32_bf16 v[104:107], a[116:119], a[92:95], v[104:107]
ds_read_b64_tr_b16 a[56:57], v225 offset:24832
v_mfma_f32_16x16x32_bf16 v[108:111], a[120:123], a[92:95], v[108:111]
v_mfma_f32_16x16x32_bf16 v[176:179], a[92:95], a[124:127], v[176:179]
ds_read_b128 a[28:31], v232 offset:14336
v_mfma_f32_16x16x32_bf16 v[180:183], a[92:95], a[128:131], v[180:183]
v_mfma_f32_16x16x32_bf16 v[48:51], a[108:111], a[96:99], v[48:51]
ds_read_b64_tr_b16 a[58:59], v225 offset:26368
v_mfma_f32_16x16x32_bf16 v[52:55], a[112:115], a[96:99], v[52:55]
v_mfma_f32_16x16x32_bf16 v[112:115], a[116:119], a[96:99], v[112:115]
ds_read_b128 a[32:35], v226
v_mfma_f32_16x16x32_bf16 v[116:119], a[120:123], a[96:99], v[116:119]
v_add_u32 v232, s45, v232
v_mfma_f32_16x16x32_bf16 v[184:187], a[96:99], a[124:127], v[184:187]
v_add_u32 v226, s45, v226
v_mfma_f32_16x16x32_bf16 v[188:191], a[96:99], a[128:131], v[188:191]
v_mfma_f32_16x16x32_bf16 v[56:59], a[108:111], a[100:103], v[56:59]
v_mfma_f32_16x16x32_bf16 v[60:63], a[112:115], a[100:103], v[60:63]
v_mfma_f32_16x16x32_bf16 v[120:123], a[116:119], a[100:103], v[120:123]
v_mfma_f32_16x16x32_bf16 v[124:127], a[120:123], a[100:103], v[124:127]
v_mfma_f32_16x16x32_bf16 v[192:195], a[100:103], a[124:127], v[192:195]
v_mfma_f32_16x16x32_bf16 v[196:199], a[100:103], a[128:131], v[196:199]
v_mfma_f32_16x16x32_bf16 v[128:131], a[116:119], a[104:107], v[128:131]
v_mfma_f32_16x16x32_bf16 v[132:135], a[120:123], a[104:107], v[132:135]
v_mfma_f32_16x16x32_bf16 v[200:203], a[104:107], a[124:127], v[200:203]
v_mfma_f32_16x16x32_bf16 v[204:207], a[104:107], a[128:131], v[204:207]
s_waitcnt vmcnt(9) lgkmcnt(0)
s_barrier
v_mfma_f32_16x16x32_bf16 v[200:203], a[32:35], a[52:55], v[200:203]
ds_read_b64_tr_b16 a[108:109], v224 offset:36864
ds_read_b128 a[72:75], v233 offset:0
v_mfma_f32_16x16x32_bf16 v[204:207], a[32:35], a[56:59], v[204:207]
ds_read_b64_tr_b16 a[110:111], v224 offset:38400
v_mfma_f32_16x16x32_bf16 v[128:131], a[44:47], a[32:35], v[128:131]
ds_read_b64_tr_b16 a[112:113], v225 offset:36864
v_mfma_f32_16x16x32_bf16 v[132:135], a[48:51], a[32:35], v[132:135]
ds_read_b128 a[76:79], v233 offset:2048
v_mfma_f32_16x16x32_bf16 v[136:139], a[0:3], a[52:55], v[136:139]
ds_read_b64_tr_b16 a[114:115], v225 offset:38400
v_mfma_f32_16x16x32_bf16 v[140:143], a[0:3], a[56:59], v[140:143]
ds_read_b128 a[80:83], v233 offset:4096
v_mfma_f32_16x16x32_bf16 v[64:67], a[44:47], a[0:3], v[64:67]
ds_read_b64_tr_b16 a[116:117], v224 offset:36992
v_mfma_f32_16x16x32_bf16 v[68:71], a[48:51], a[0:3], v[68:71]
ds_read_b128 a[84:87], v233 offset:6144
v_mfma_f32_16x16x32_bf16 v[0:3], a[36:39], a[0:3], v[0:3]
ds_read_b64_tr_b16 a[118:119], v224 offset:38528
v_mfma_f32_16x16x32_bf16 v[4:7], a[40:43], a[0:3], v[4:7]
ds_read_b64_tr_b16 a[120:121], v225 offset:36992
v_mfma_f32_16x16x32_bf16 v[144:147], a[4:7], a[52:55], v[144:147]
ds_read_b128 a[88:91], v233 offset:8192
v_mfma_f32_16x16x32_bf16 v[148:151], a[4:7], a[56:59], v[148:151]
ds_read_b64_tr_b16 a[122:123], v225 offset:38528
v_mfma_f32_16x16x32_bf16 v[72:75], a[44:47], a[4:7], v[72:75]
ds_read_b128 a[92:95], v233 offset:10240
v_mfma_f32_16x16x32_bf16 v[76:79], a[48:51], a[4:7], v[76:79]
ds_read_b64_tr_b16 a[124:125], v224 offset:37120
v_mfma_f32_16x16x32_bf16 v[8:11], a[36:39], a[4:7], v[8:11]
ds_read_b128 a[96:99], v233 offset:12288
v_mfma_f32_16x16x32_bf16 v[12:15], a[40:43], a[4:7], v[12:15]
ds_read_b64_tr_b16 a[126:127], v224 offset:38656
v_mfma_f32_16x16x32_bf16 v[152:155], a[8:11], a[52:55], v[152:155]
ds_read_b64_tr_b16 a[128:129], v225 offset:37120
v_mfma_f32_16x16x32_bf16 v[156:159], a[8:11], a[56:59], v[156:159]
ds_read_b128 a[100:103], v233 offset:14336
v_mfma_f32_16x16x32_bf16 v[80:83], a[44:47], a[8:11], v[80:83]
ds_read_b64_tr_b16 a[130:131], v225 offset:38656
v_mfma_f32_16x16x32_bf16 v[84:87], a[48:51], a[8:11], v[84:87]
ds_read_b128 a[104:107], v227
v_mfma_f32_16x16x32_bf16 v[16:19], a[36:39], a[8:11], v[16:19]
v_mfma_f32_16x16x32_bf16 v[20:23], a[40:43], a[8:11], v[20:23]
v_mfma_f32_16x16x32_bf16 v[160:163], a[12:15], a[52:55], v[160:163]
v_mfma_f32_16x16x32_bf16 v[164:167], a[12:15], a[56:59], v[164:167]
v_mfma_f32_16x16x32_bf16 v[88:91], a[44:47], a[12:15], v[88:91]
v_mfma_f32_16x16x32_bf16 v[92:95], a[48:51], a[12:15], v[92:95]
v_mfma_f32_16x16x32_bf16 v[24:27], a[36:39], a[12:15], v[24:27]
v_mfma_f32_16x16x32_bf16 v[28:31], a[40:43], a[12:15], v[28:31]
s_waitcnt lgkmcnt(0)
s_barrier
v_mfma_f32_16x16x32_bf16 v[200:203], a[104:107], a[124:127], v[200:203]
s_add_u32 m0, s98, 0
v_mfma_f32_16x16x32_bf16 v[204:207], a[104:107], a[128:131], v[204:207]
buffer_load_dwordx4 v244, s[8:11], s96 offen offset:0 lds
v_mfma_f32_16x16x32_bf16 v[128:131], a[116:119], a[104:107], v[128:131]
buffer_load_dwordx4 v245, s[8:11], s96 offen offset:1024 lds
v_mfma_f32_16x16x32_bf16 v[132:135], a[120:123], a[104:107], v[132:135]
buffer_load_dwordx4 v246, s[8:11], s96 offen offset:2048 lds
v_mfma_f32_16x16x32_bf16 v[136:139], a[72:75], a[124:127], v[136:139]
buffer_load_dwordx4 v247, s[8:11], s96 offen offset:3072 lds
v_mfma_f32_16x16x32_bf16 v[140:143], a[72:75], a[128:131], v[140:143]
s_add_u32 m0, s98, 4096
v_mfma_f32_16x16x32_bf16 v[64:67], a[116:119], a[72:75], v[64:67]
s_add_u32 s52, s96, 32768
v_mfma_f32_16x16x32_bf16 v[68:71], a[120:123], a[72:75], v[68:71]
buffer_load_dwordx4 v244, s[8:11], s52 offen offset:0 lds
v_mfma_f32_16x16x32_bf16 v[0:3], a[108:111], a[72:75], v[0:3]
buffer_load_dwordx4 v245, s[8:11], s52 offen offset:1024 lds
v_mfma_f32_16x16x32_bf16 v[4:7], a[112:115], a[72:75], v[4:7]
buffer_load_dwordx4 v246, s[8:11], s52 offen offset:2048 lds
v_mfma_f32_16x16x32_bf16 v[144:147], a[76:79], a[124:127], v[144:147]
buffer_load_dwordx4 v247, s[8:11], s52 offen offset:3072 lds
v_cvt_pk_bf16_f32 v208, v200, v201
v_cvt_pk_bf16_f32 v209, v202, v203
v_mfma_f32_16x16x32_bf16 v[148:151], a[76:79], a[128:131], v[148:151]
s_add_u32 s96, s96, 262144
v_cvt_pk_bf16_f32 v228, v204, v205
v_cvt_pk_bf16_f32 v229, v206, v207
v_mfma_f32_16x16x32_bf16 v[72:75], a[116:119], a[76:79], v[72:75]
s_add_u32 m0, s98, 32768
v_cvt_pk_bf16_f32 v218, v200, v201
v_cvt_pk_bf16_f32 v219, v202, v203
v_mfma_f32_16x16x32_bf16 v[76:79], a[120:123], a[76:79], v[76:79]
buffer_load_dwordx4 v244, s[8:11], s96 offen offset:0 lds
v_cvt_pk_bf16_f32 v238, v204, v205
v_cvt_pk_bf16_f32 v239, v206, v207
v_mfma_f32_16x16x32_bf16 v[8:11], a[108:111], a[76:79], v[8:11]
buffer_load_dwordx4 v245, s[8:11], s96 offen offset:1024 lds
v_cvt_pk_bf16_f32 v128, v128, v129
v_cvt_pk_bf16_f32 v129, v130, v131
v_mfma_f32_16x16x32_bf16 v[12:15], a[112:115], a[76:79], v[12:15]
buffer_load_dwordx4 v246, s[8:11], s96 offen offset:2048 lds
v_cvt_pk_bf16_f32 v130, v132, v133
v_cvt_pk_bf16_f32 v131, v134, v135
v_mfma_f32_16x16x32_bf16 v[152:155], a[80:83], a[124:127], v[152:155]
buffer_load_dwordx4 v247, s[8:11], s96 offen offset:3072 lds
v_accvgpr_read_b32 v132, a174
v_accvgpr_read_b32 v133, a175
v_mfma_f32_16x16x32_bf16 v[156:159], a[80:83], a[128:131], v[156:159]
s_add_u32 m0, s98, 36864
v_accvgpr_read_b32 v134, a176
v_accvgpr_read_b32 v135, a177
v_mfma_f32_16x16x32_bf16 v[80:83], a[116:119], a[80:83], v[80:83]
s_add_u32 s52, s96, 32768
v_cvt_pk_bf16_f32 v210, v136, v137
v_cvt_pk_bf16_f32 v211, v138, v139
v_mfma_f32_16x16x32_bf16 v[84:87], a[120:123], a[80:83], v[84:87]
buffer_load_dwordx4 v244, s[8:11], s52 offen offset:0 lds
v_cvt_pk_bf16_f32 v230, v140, v141
v_cvt_pk_bf16_f32 v231, v142, v143
v_mfma_f32_16x16x32_bf16 v[16:19], a[108:111], a[80:83], v[16:19]
buffer_load_dwordx4 v245, s[8:11], s52 offen offset:1024 lds
v_cvt_pk_bf16_f32 v64, v64, v65
v_cvt_pk_bf16_f32 v65, v66, v67
v_mfma_f32_16x16x32_bf16 v[20:23], a[112:115], a[80:83], v[20:23]
buffer_load_dwordx4 v246, s[8:11], s52 offen offset:2048 lds
v_cvt_pk_bf16_f32 v66, v68, v69
v_cvt_pk_bf16_f32 v67, v70, v71
v_mfma_f32_16x16x32_bf16 v[160:163], a[84:87], a[124:127], v[160:163]
buffer_load_dwordx4 v247, s[8:11], s52 offen offset:3072 lds
v_cvt_pk_bf16_f32 v0, v0, v1
v_cvt_pk_bf16_f32 v1, v2, v3
v_mfma_f32_16x16x32_bf16 v[164:167], a[84:87], a[128:131], v[164:167]
s_add_u32 s96, s96, 262144
v_cvt_pk_bf16_f32 v2, v4, v5
v_cvt_pk_bf16_f32 v3, v6, v7
v_mfma_f32_16x16x32_bf16 v[88:91], a[116:119], a[84:87], v[88:91]
v_cvt_pk_bf16_f32 v220, v144, v145
v_cvt_pk_bf16_f32 v221, v146, v147
v_mfma_f32_16x16x32_bf16 v[92:95], a[120:123], a[84:87], v[92:95]
v_cvt_pk_bf16_f32 v240, v148, v149
v_cvt_pk_bf16_f32 v241, v150, v151
v_mfma_f32_16x16x32_bf16 v[24:27], a[108:111], a[84:87], v[24:27]
v_cvt_pk_bf16_f32 v72, v72, v73
v_cvt_pk_bf16_f32 v73, v74, v75
v_mfma_f32_16x16x32_bf16 v[28:31], a[112:115], a[84:87], v[28:31]
v_cvt_pk_bf16_f32 v74, v76, v77
v_cvt_pk_bf16_f32 v75, v78, v79
v_mfma_f32_16x16x32_bf16 v[168:171], a[16:19], a[52:55], v[168:171]
v_cvt_pk_bf16_f32 v8, v8, v9
v_cvt_pk_bf16_f32 v9, v10, v11
v_mfma_f32_16x16x32_bf16 v[172:175], a[16:19], a[56:59], v[172:175]
v_cvt_pk_bf16_f32 v10, v12, v13
v_cvt_pk_bf16_f32 v11, v14, v15
v_mfma_f32_16x16x32_bf16 v[96:99], a[44:47], a[16:19], v[96:99]
v_cvt_pk_bf16_f32 v212, v152, v153
v_cvt_pk_bf16_f32 v213, v154, v155
v_mfma_f32_16x16x32_bf16 v[100:103], a[48:51], a[16:19], v[100:103]
v_cvt_pk_bf16_f32 v232, v156, v157
v_cvt_pk_bf16_f32 v233, v158, v159
v_mfma_f32_16x16x32_bf16 v[32:35], a[36:39], a[16:19], v[32:35]
v_cvt_pk_bf16_f32 v80, v80, v81
v_cvt_pk_bf16_f32 v81, v82, v83
v_mfma_f32_16x16x32_bf16 v[36:39], a[40:43], a[16:19], v[36:39]
v_cvt_pk_bf16_f32 v82, v84, v85
v_cvt_pk_bf16_f32 v83, v86, v87
v_mfma_f32_16x16x32_bf16 v[168:171], a[88:91], a[124:127], v[168:171]
v_cvt_pk_bf16_f32 v16, v16, v17
v_cvt_pk_bf16_f32 v17, v18, v19
v_mfma_f32_16x16x32_bf16 v[172:175], a[88:91], a[128:131], v[172:175]
v_cvt_pk_bf16_f32 v18, v20, v21
v_cvt_pk_bf16_f32 v19, v22, v23
v_mfma_f32_16x16x32_bf16 v[96:99], a[116:119], a[88:91], v[96:99]
v_cvt_pk_bf16_f32 v222, v160, v161
v_cvt_pk_bf16_f32 v223, v162, v163
v_mfma_f32_16x16x32_bf16 v[100:103], a[120:123], a[88:91], v[100:103]
v_cvt_pk_bf16_f32 v242, v164, v165
v_cvt_pk_bf16_f32 v243, v166, v167
v_mfma_f32_16x16x32_bf16 v[32:35], a[108:111], a[88:91], v[32:35]
v_cvt_pk_bf16_f32 v88, v88, v89
v_cvt_pk_bf16_f32 v89, v90, v91
v_mfma_f32_16x16x32_bf16 v[36:39], a[112:115], a[88:91], v[36:39]
v_cvt_pk_bf16_f32 v90, v92, v93
v_cvt_pk_bf16_f32 v91, v94, v95
v_mfma_f32_16x16x32_bf16 v[176:179], a[20:23], a[52:55], v[176:179]
v_cvt_pk_bf16_f32 v24, v24, v25
v_cvt_pk_bf16_f32 v25, v26, v27
v_mfma_f32_16x16x32_bf16 v[180:183], a[20:23], a[56:59], v[180:183]
v_cvt_pk_bf16_f32 v26, v28, v29
v_cvt_pk_bf16_f32 v27, v30, v31
v_mfma_f32_16x16x32_bf16 v[104:107], a[44:47], a[20:23], v[104:107]
v_mfma_f32_16x16x32_bf16 v[136:139], v[128:131], v[0:3], 0
v_mfma_f32_16x16x32_bf16 v[144:147], v[128:131], v[8:11], 0
v_mfma_f32_16x16x32_bf16 v[152:155], v[64:67], v[16:19], 0
v_mfma_f32_16x16x32_bf16 v[108:111], a[48:51], a[20:23], v[108:111]
v_mfma_f32_16x16x32_bf16 v[160:163], v[72:75], v[24:27], 0
v_mfma_f32_16x16x32_bf16 v[140:143], v[64:67], v[0:3], 0
v_mfma_f32_16x16x32_bf16 v[148:151], v[72:75], v[8:11], 0
v_mfma_f32_16x16x32_bf16 v[40:43], a[36:39], a[20:23], v[40:43]
v_mfma_f32_16x16x32_bf16 v[156:159], v[80:83], v[16:19], 0
v_mfma_f32_16x16x32_bf16 v[164:167], v[88:91], v[24:27], 0
v_cndmask_b32 v136, v252, v136, s[76:77]
v_mfma_f32_16x16x32_bf16 v[44:47], a[40:43], a[20:23], v[44:47]
v_cndmask_b32 v144, v252, v144, s[84:85]
v_cndmask_b32 v152, v252, v152, s[68:69]
v_cndmask_b32 v160, v252, v160, s[68:69]
v_mfma_f32_16x16x32_bf16 v[176:179], a[92:95], a[124:127], v[176:179]
v_cndmask_b32 v137, v252, v137, s[78:79]
v_cndmask_b32 v145, v252, v145, s[86:87]
v_cndmask_b32 v153, v252, v153, s[70:71]
v_mfma_f32_16x16x32_bf16 v[180:183], a[92:95], a[128:131], v[180:183]
v_cndmask_b32 v161, v252, v161, s[70:71]
v_cndmask_b32 v138, v252, v138, s[80:81]
v_cndmask_b32 v146, v252, v146, s[88:89]
v_mfma_f32_16x16x32_bf16 v[104:107], a[116:119], a[92:95], v[104:107]
v_cndmask_b32 v154, v252, v154, s[72:73]
v_cndmask_b32 v162, v252, v162, s[72:73]
v_cndmask_b32 v139, v252, v139, s[82:83]
v_mfma_f32_16x16x32_bf16 v[108:111], a[120:123], a[92:95], v[108:111]
v_cndmask_b32 v147, v252, v147, s[90:91]
v_cndmask_b32 v155, v252, v155, s[74:75]
v_cndmask_b32 v163, v252, v163, s[74:75]
v_mfma_f32_16x16x32_bf16 v[40:43], a[108:111], a[92:95], v[40:43]
v_cndmask_b32 v140, v136, v140, s[60:61]
v_cndmask_b32 v148, v144, v148, s[60:61]
v_cndmask_b32 v156, v152, v156, s[60:61]
v_mfma_f32_16x16x32_bf16 v[44:47], a[112:115], a[92:95], v[44:47]
v_cndmask_b32 v164, v160, v164, s[60:61]
v_cndmask_b32 v141, v137, v141, s[62:63]
v_cndmask_b32 v149, v145, v149, s[62:63]
v_mfma_f32_16x16x32_bf16 v[184:187], a[24:27], a[52:55], v[184:187]
v_cndmask_b32 v157, v153, v157, s[62:63]
v_cndmask_b32 v165, v161, v165, s[62:63]
v_cndmask_b32 v142, v138, v142, s[64:65]
v_mfma_f32_16x16x32_bf16 v[188:191], a[24:27], a[56:59], v[188:191]
v_cndmask_b32 v150, v146, v150, s[64:65]
v_cndmask_b32 v158, v154, v158, s[64:65]
v_cndmask_b32 v166, v162, v166, s[64:65]
v_mfma_f32_16x16x32_bf16 v[112:115], a[44:47], a[24:27], v[112:115]
v_cndmask_b32 v143, v139, v143, s[66:67]
v_cndmask_b32 v151, v147, v151, s[66:67]
v_cndmask_b32 v159, v155, v159, s[66:67]
v_mfma_f32_16x16x32_bf16 v[116:119], a[48:51], a[24:27], v[116:119]
v_cndmask_b32 v167, v163, v167, s[66:67]
v_cvt_pk_bf16_f32 v4, v140, v141
v_cvt_pk_bf16_f32 v12, v148, v149
v_mfma_f32_16x16x32_bf16 v[48:51], a[36:39], a[24:27], v[48:51]
v_cvt_pk_bf16_f32 v20, v156, v157
v_cvt_pk_bf16_f32 v28, v164, v165
v_cvt_pk_bf16_f32 v5, v142, v143
v_mfma_f32_16x16x32_bf16 v[52:55], a[40:43], a[24:27], v[52:55]
v_cvt_pk_bf16_f32 v13, v150, v151
v_cvt_pk_bf16_f32 v21, v158, v159
v_cvt_pk_bf16_f32 v29, v166, v167
v_mfma_f32_16x16x32_bf16 v[184:187], a[96:99], a[124:127], v[184:187]
v_lshlrev_b32 v140, 16, v4
v_lshlrev_b32 v148, 16, v12
v_lshlrev_b32 v156, 16, v20
v_mfma_f32_16x16x32_bf16 v[188:191], a[96:99], a[128:131], v[188:191]
v_lshlrev_b32 v164, 16, v28
v_and_b32 v141, s47, v4
v_and_b32 v149, s47, v12
v_mfma_f32_16x16x32_bf16 v[112:115], a[116:119], a[96:99], v[112:115]
v_and_b32 v157, s47, v20
v_and_b32 v165, s47, v28
v_lshlrev_b32 v142, 16, v5
v_mfma_f32_16x16x32_bf16 v[116:119], a[120:123], a[96:99], v[116:119]
v_lshlrev_b32 v150, 16, v13
v_lshlrev_b32 v158, 16, v21
v_lshlrev_b32 v166, 16, v29
v_mfma_f32_16x16x32_bf16 v[48:51], a[108:111], a[96:99], v[48:51]
v_and_b32 v143, s47, v5
v_and_b32 v151, s47, v13
v_and_b32 v159, s47, v21
v_mfma_f32_16x16x32_bf16 v[52:55], a[112:115], a[96:99], v[52:55]
v_and_b32 v167, s47, v29
v_pk_mul_f32 v[140:141], v[140:141], s[42:43]
v_pk_mul_f32 v[148:149], v[148:149], s[42:43]
v_mfma_f32_16x16x32_bf16 v[192:195], a[28:31], a[52:55], v[192:195]
v_pk_mul_f32 v[156:157], v[156:157], s[42:43]
v_pk_mul_f32 v[164:165], v[164:165], s[42:43]
v_pk_mul_f32 v[142:143], v[142:143], s[42:43]
v_mfma_f32_16x16x32_bf16 v[196:199], a[28:31], a[56:59], v[196:199]
v_pk_mul_f32 v[150:151], v[150:151], s[42:43]
v_pk_mul_f32 v[158:159], v[158:159], s[42:43]
v_pk_mul_f32 v[166:167], v[166:167], s[42:43]
v_mfma_f32_16x16x32_bf16 v[120:123], a[44:47], a[28:31], v[120:123]
v_cvt_pk_bf16_f32 v4, v140, v141
v_cvt_pk_bf16_f32 v12, v148, v149
v_cvt_pk_bf16_f32 v20, v156, v157
v_mfma_f32_16x16x32_bf16 v[124:127], a[48:51], a[28:31], v[124:127]
v_cvt_pk_bf16_f32 v28, v164, v165
v_cvt_pk_bf16_f32 v5, v142, v143
v_cvt_pk_bf16_f32 v13, v150, v151
v_mfma_f32_16x16x32_bf16 v[56:59], a[36:39], a[28:31], v[56:59]
v_cvt_pk_bf16_f32 v21, v158, v159
v_cvt_pk_bf16_f32 v29, v166, v167
v_lshlrev_b32 v140, 16, v4
v_mfma_f32_16x16x32_bf16 v[60:63], a[40:43], a[28:31], v[60:63]
v_lshlrev_b32 v148, 16, v12
v_lshlrev_b32 v156, 16, v20
v_lshlrev_b32 v164, 16, v28
v_mfma_f32_16x16x32_bf16 v[192:195], a[100:103], a[124:127], v[192:195]
v_and_b32 v141, s47, v4
v_and_b32 v149, s47, v12
v_and_b32 v157, s47, v20
v_mfma_f32_16x16x32_bf16 v[196:199], a[100:103], a[128:131], v[196:199]
v_and_b32 v165, s47, v28
v_lshlrev_b32 v142, 16, v5
v_lshlrev_b32 v150, 16, v13
v_lshrrev_b32 v246, 2, v253
v_mfma_f32_16x16x32_bf16 v[120:123], a[116:119], a[100:103], v[120:123]
v_lshlrev_b32 v158, 16, v21
v_lshlrev_b32 v166, 16, v29
v_and_b32 v143, s47, v5
v_mfma_f32_16x16x32_bf16 v[124:127], a[120:123], a[100:103], v[124:127]
v_and_b32 v151, s47, v13
v_and_b32 v159, s47, v21
v_and_b32 v167, s47, v29
buffer_load_dword a178, v246, s[12:15], s48 offen sc1
v_mfma_f32_16x16x32_bf16 v[56:59], a[108:111], a[100:103], v[56:59]
v_max3_f32 v68, v140, v141, v142
v_max3_f32 v76, v148, v149, v150
v_max3_f32 v84, v156, v157, v158
v_mfma_f32_16x16x32_bf16 v[60:63], a[112:115], a[100:103], v[60:63]
v_max3_f32 v92, v164, v165, v166
v_cvt_pk_bf16_f32 v214, v168, v169
v_max_f32 v68, v68, v143
v_cvt_pk_bf16_f32 v215, v170, v171
v_max_f32 v76, v76, v151
v_cvt_pk_bf16_f32 v234, v172, v173
v_max_f32 v84, v84, v159
v_cvt_pk_bf16_f32 v235, v174, v175
v_max_f32 v92, v92, v167
v_cvt_pk_bf16_f32 v96, v96, v97
v_mov_b32 v69, v68
v_cvt_pk_bf16_f32 v97, v98, v99
v_mov_b32 v77, v76
v_cvt_pk_bf16_f32 v98, v100, v101
v_mov_b32 v85, v84
v_cvt_pk_bf16_f32 v99, v102, v103
v_mov_b32 v93, v92
v_cvt_pk_bf16_f32 v32, v32, v33
v_permlane32_swap_b32 v68, v69
v_cvt_pk_bf16_f32 v33, v34, v35
v_permlane32_swap_b32 v76, v77
v_cvt_pk_bf16_f32 v34, v36, v37
v_permlane32_swap_b32 v84, v85
v_cvt_pk_bf16_f32 v35, v38, v39
v_permlane32_swap_b32 v92, v93
v_cvt_pk_bf16_f32 v224, v176, v177
v_max_f32 v68, v68, v69
v_cvt_pk_bf16_f32 v225, v178, v179
v_max_f32 v76, v76, v77
v_cvt_pk_bf16_f32 v244, v180, v181
v_max_f32 v84, v84, v85
v_cvt_pk_bf16_f32 v245, v182, v183
v_max_f32 v92, v92, v93
v_cvt_pk_bf16_f32 v104, v104, v105
v_mov_b32 v69, v68
v_cvt_pk_bf16_f32 v105, v106, v107
v_mov_b32 v77, v76
v_cvt_pk_bf16_f32 v106, v108, v109
v_mov_b32 v85, v84
v_cvt_pk_bf16_f32 v107, v110, v111
v_mov_b32 v93, v92
v_cvt_pk_bf16_f32 v40, v40, v41
v_permlane16_swap_b32 v68, v69
v_cvt_pk_bf16_f32 v41, v42, v43
v_permlane16_swap_b32 v76, v77
v_cvt_pk_bf16_f32 v42, v44, v45
v_permlane16_swap_b32 v84, v85
v_cvt_pk_bf16_f32 v43, v46, v47
v_permlane16_swap_b32 v92, v93
v_cvt_pk_bf16_f32 v216, v184, v185
v_max_f32 v68, v68, v69
v_cvt_pk_bf16_f32 v217, v186, v187
v_max_f32 v76, v76, v77
v_cvt_pk_bf16_f32 v236, v188, v189
v_max_f32 v84, v84, v85
v_cvt_pk_bf16_f32 v237, v190, v191
v_max_f32 v92, v92, v93
v_cvt_pk_bf16_f32 v112, v112, v113
v_mul_f32 v68, s44, v68
v_cvt_pk_bf16_f32 v113, v114, v115
v_mul_f32 v76, s44, v76
v_cvt_pk_bf16_f32 v114, v116, v117
v_mul_f32 v84, s44, v84
v_cvt_pk_bf16_f32 v115, v118, v119
v_mul_f32 v92, s44, v92
v_cvt_pk_bf16_f32 v48, v48, v49
v_fma_f32 v140, v140, s44, -v68
v_cvt_pk_bf16_f32 v49, v50, v51
v_fma_f32 v148, v148, s44, -v76
v_cvt_pk_bf16_f32 v50, v52, v53
v_fma_f32 v156, v156, s44, -v84
v_cvt_pk_bf16_f32 v51, v54, v55
v_fma_f32 v164, v164, s44, -v92
v_cvt_pk_bf16_f32 v226, v192, v193
v_fma_f32 v141, v141, s44, -v68
v_cvt_pk_bf16_f32 v227, v194, v195
v_fma_f32 v149, v149, s44, -v76
v_cvt_pk_bf16_f32 v246, v196, v197
v_fma_f32 v157, v157, s44, -v84
v_cvt_pk_bf16_f32 v247, v198, v199
v_fma_f32 v165, v165, s44, -v92
v_cvt_pk_bf16_f32 v120, v120, v121
v_fma_f32 v142, v142, s44, -v68
v_cvt_pk_bf16_f32 v121, v122, v123
v_fma_f32 v150, v150, s44, -v76
v_cvt_pk_bf16_f32 v122, v124, v125
v_fma_f32 v158, v158, s44, -v84
v_cvt_pk_bf16_f32 v123, v126, v127
v_fma_f32 v166, v166, s44, -v92
v_cvt_pk_bf16_f32 v56, v56, v57
v_fma_f32 v143, v143, s44, -v68
v_cvt_pk_bf16_f32 v57, v58, v59
v_fma_f32 v151, v151, s44, -v76
v_cvt_pk_bf16_f32 v58, v60, v61
v_fma_f32 v159, v159, s44, -v84
v_cvt_pk_bf16_f32 v59, v62, v63
v_fma_f32 v167, v167, s44, -v92
v_mfma_f32_16x16x32_bf16 v[168:171], v[80:83], v[32:35], 0
v_exp_f32 v140, v140
v_mfma_f32_16x16x32_bf16 v[176:179], v[88:91], v[40:43], 0
v_exp_f32 v148, v148
v_mfma_f32_16x16x32_bf16 v[184:187], v[96:99], v[48:51], 0
v_exp_f32 v156, v156
v_mfma_f32_16x16x32_bf16 v[192:195], v[104:107], v[56:59], 0
v_exp_f32 v164, v164
v_mfma_f32_16x16x32_bf16 v[172:175], v[96:99], v[32:35], 0
v_exp_f32 v141, v141
v_mfma_f32_16x16x32_bf16 v[180:183], v[104:107], v[40:43], 0
v_exp_f32 v149, v149
v_mfma_f32_16x16x32_bf16 v[188:191], v[112:115], v[48:51], 0
v_exp_f32 v157, v157
v_mfma_f32_16x16x32_bf16 v[196:199], v[120:123], v[56:59], 0
v_exp_f32 v165, v165
v_cndmask_b32 v168, v252, v168, s[68:69]
v_exp_f32 v142, v142
v_cndmask_b32 v176, v252, v176, s[68:69]
v_exp_f32 v150, v150
v_cndmask_b32 v184, v252, v184, s[68:69]
v_exp_f32 v158, v158
v_cndmask_b32 v192, v252, v192, s[68:69]
v_exp_f32 v166, v166
v_cndmask_b32 v169, v252, v169, s[70:71]
v_exp_f32 v143, v143
v_cndmask_b32 v177, v252, v177, s[70:71]
v_exp_f32 v151, v151
v_cndmask_b32 v185, v252, v185, s[70:71]
v_exp_f32 v159, v159
v_cndmask_b32 v193, v252, v193, s[70:71]
v_exp_f32 v167, v167
v_cndmask_b32 v170, v252, v170, s[72:73]
v_pk_add_f32 v[4:5], v[140:141], v[142:143]
v_cndmask_b32 v178, v252, v178, s[72:73]
v_pk_add_f32 v[12:13], v[148:149], v[150:151]
v_cndmask_b32 v186, v252, v186, s[72:73]
v_pk_add_f32 v[20:21], v[156:157], v[158:159]
v_cndmask_b32 v194, v252, v194, s[72:73]
v_pk_add_f32 v[28:29], v[164:165], v[166:167]
v_cndmask_b32 v171, v252, v171, s[74:75]
v_add_f32 v68, v4, v5
v_cndmask_b32 v179, v252, v179, s[74:75]
v_add_f32 v76, v12, v13
v_cndmask_b32 v187, v252, v187, s[74:75]
v_add_f32 v84, v20, v21
v_cndmask_b32 v195, v252, v195, s[74:75]
v_add_f32 v92, v28, v29
v_cndmask_b32 v172, v168, v172, s[60:61]
v_mov_b32 v69, v68
v_cndmask_b32 v180, v176, v180, s[60:61]
v_mov_b32 v77, v76
v_cndmask_b32 v188, v184, v188, s[60:61]
v_mov_b32 v85, v84
v_cndmask_b32 v196, v192, v196, s[60:61]
v_mov_b32 v93, v92
v_cndmask_b32 v173, v169, v173, s[62:63]
v_permlane32_swap_b32 v68, v69
v_cndmask_b32 v181, v177, v181, s[62:63]
v_permlane32_swap_b32 v76, v77
v_cndmask_b32 v189, v185, v189, s[62:63]
v_permlane32_swap_b32 v84, v85
v_cndmask_b32 v197, v193, v197, s[62:63]
v_permlane32_swap_b32 v92, v93
v_cndmask_b32 v174, v170, v174, s[64:65]
v_add_f32 v68, v68, v69
v_cndmask_b32 v182, v178, v182, s[64:65]
v_add_f32 v76, v76, v77
v_cndmask_b32 v190, v186, v190, s[64:65]
v_add_f32 v84, v84, v85
v_cndmask_b32 v198, v194, v198, s[64:65]
v_add_f32 v92, v92, v93
v_cndmask_b32 v175, v171, v175, s[66:67]
v_mov_b32 v69, v68
v_cndmask_b32 v183, v179, v183, s[66:67]
v_mov_b32 v77, v76
v_cndmask_b32 v191, v187, v191, s[66:67]
v_mov_b32 v85, v84
v_cndmask_b32 v199, v195, v199, s[66:67]
v_mov_b32 v93, v92
v_cvt_pk_bf16_f32 v36, v172, v173
v_permlane16_swap_b32 v68, v69
v_cvt_pk_bf16_f32 v44, v180, v181
v_permlane16_swap_b32 v76, v77
v_cvt_pk_bf16_f32 v52, v188, v189
v_permlane16_swap_b32 v84, v85
v_cvt_pk_bf16_f32 v60, v196, v197
v_permlane16_swap_b32 v92, v93
v_cvt_pk_bf16_f32 v37, v174, v175
v_add_f32 v68, v68, v69
v_cvt_pk_bf16_f32 v45, v182, v183
v_add_f32 v76, v76, v77
v_cvt_pk_bf16_f32 v53, v190, v191
v_add_f32 v84, v84, v85
v_cvt_pk_bf16_f32 v61, v198, v199
v_add_f32 v92, v92, v93
v_lshlrev_b32 v172, 16, v36
v_rcp_f32 v68, v68
v_lshlrev_b32 v180, 16, v44
v_rcp_f32 v76, v76
v_lshlrev_b32 v188, 16, v52
v_rcp_f32 v84, v84
v_lshlrev_b32 v196, 16, v60
v_rcp_f32 v92, v92
v_and_b32 v173, s47, v36
v_mul_f32 v140, v140, v68
v_and_b32 v181, s47, v44
v_mul_f32 v148, v148, v76
v_and_b32 v189, s47, v52
v_mul_f32 v156, v156, v84
v_and_b32 v197, s47, v60
v_mul_f32 v164, v164, v92
v_lshlrev_b32 v174, 16, v37
v_mul_f32 v141, v141, v68
v_lshlrev_b32 v182, 16, v45
v_mul_f32 v149, v149, v76
v_lshlrev_b32 v190, 16, v53
v_mul_f32 v157, v157, v84
v_lshlrev_b32 v198, 16, v61
v_mul_f32 v165, v165, v92
v_and_b32 v175, s47, v37
v_mul_f32 v142, v142, v68
v_and_b32 v183, s47, v45
v_mul_f32 v150, v150, v76
v_and_b32 v191, s47, v53
v_mul_f32 v158, v158, v84
v_and_b32 v199, s47, v61
v_mul_f32 v166, v166, v92
v_pk_mul_f32 v[172:173], v[172:173], s[42:43]
v_mul_f32 v143, v143, v68
v_pk_mul_f32 v[180:181], v[180:181], s[42:43]
v_mul_f32 v151, v151, v76
v_pk_mul_f32 v[188:189], v[188:189], s[42:43]
v_mul_f32 v159, v159, v84
v_pk_mul_f32 v[196:197], v[196:197], s[42:43]
v_mul_f32 v167, v167, v92
v_pk_mul_f32 v[174:175], v[174:175], s[42:43]
v_cvt_pk_bf16_f32 v4, v140, v141
v_pk_mul_f32 v[182:183], v[182:183], s[42:43]
v_cvt_pk_bf16_f32 v12, v148, v149
v_pk_mul_f32 v[190:191], v[190:191], s[42:43]
v_cvt_pk_bf16_f32 v20, v156, v157
v_pk_mul_f32 v[198:199], v[198:199], s[42:43]
v_cvt_pk_bf16_f32 v28, v164, v165
v_cvt_pk_bf16_f32 v36, v172, v173
v_cvt_pk_bf16_f32 v5, v142, v143
v_cvt_pk_bf16_f32 v44, v180, v181
v_cvt_pk_bf16_f32 v13, v150, v151
v_cvt_pk_bf16_f32 v52, v188, v189
v_cvt_pk_bf16_f32 v21, v158, v159
v_cvt_pk_bf16_f32 v60, v196, v197
v_cvt_pk_bf16_f32 v29, v166, v167
v_cvt_pk_bf16_f32 v37, v174, v175
v_and_b32 v136, v132, v4
v_cvt_pk_bf16_f32 v45, v182, v183
v_and_b32 v144, v134, v12
v_cvt_pk_bf16_f32 v53, v190, v191
v_and_b32 v152, v250, v20
v_cvt_pk_bf16_f32 v61, v198, v199
v_and_b32 v160, v250, v28
v_lshlrev_b32 v172, 16, v36
v_and_b32 v137, v133, v5
v_lshlrev_b32 v180, 16, v44
v_and_b32 v145, v135, v13
v_lshlrev_b32 v188, 16, v52
v_and_b32 v153, v251, v21
v_lshlrev_b32 v196, 16, v60
v_and_b32 v161, v251, v29
v_and_b32 v173, s47, v36
v_and_b32 v138, v248, v4
v_and_b32 v181, s47, v44
v_and_b32 v146, v248, v12
v_and_b32 v189, s47, v52
v_and_b32 v154, v248, v20
v_and_b32 v197, s47, v60
v_and_b32 v162, v248, v28
v_lshlrev_b32 v174, 16, v37
v_and_b32 v139, v249, v5
v_lshlrev_b32 v182, 16, v45
v_and_b32 v147, v249, v13
v_lshlrev_b32 v190, 16, v53
v_and_b32 v155, v249, v21
v_lshlrev_b32 v198, 16, v61
v_and_b32 v163, v249, v29
v_and_b32 v175, s47, v37
v_mfma_f32_16x16x32_bf16 v[4:7], v[208:211], v[136:139], 0
v_and_b32 v183, s47, v45
v_mfma_f32_16x16x32_bf16 v[12:15], v[218:221], v[144:147], 0
v_and_b32 v191, s47, v53
v_mfma_f32_16x16x32_bf16 v[20:23], v[210:213], v[152:155], 0
v_and_b32 v199, s47, v61
v_mfma_f32_16x16x32_bf16 v[28:31], v[220:223], v[160:163], 0
v_max3_f32 v100, v172, v173, v174
v_mfma_f32_16x16x32_bf16 v[68:71], v[228:231], v[136:139], 0
v_max3_f32 v108, v180, v181, v182
v_mfma_f32_16x16x32_bf16 v[76:79], v[238:241], v[144:147], 0
v_max3_f32 v116, v188, v189, v190
v_mfma_f32_16x16x32_bf16 v[84:87], v[230:233], v[152:155], 0
v_max3_f32 v124, v196, v197, v198
v_mfma_f32_16x16x32_bf16 v[92:95], v[240:243], v[160:163], 0
v_max_f32 v100, v100, v175
v_cvt_pk_bf16_f32 v0, v4, v5
v_max_f32 v108, v108, v183
v_cvt_pk_bf16_f32 v8, v12, v13
v_max_f32 v116, v116, v191
v_cvt_pk_bf16_f32 v16, v20, v21
v_max_f32 v124, v124, v199
v_cvt_pk_bf16_f32 v24, v28, v29
v_mov_b32 v101, v100
v_cvt_pk_bf16_f32 v1, v6, v7
v_mov_b32 v109, v108
v_cvt_pk_bf16_f32 v9, v14, v15
v_mov_b32 v117, v116
v_cvt_pk_bf16_f32 v17, v22, v23
v_mov_b32 v125, v124
v_cvt_pk_bf16_f32 v25, v30, v31
v_permlane32_swap_b32 v100, v101
v_cvt_pk_bf16_f32 v2, v68, v69
v_permlane32_swap_b32 v108, v109
v_cvt_pk_bf16_f32 v10, v76, v77
v_permlane32_swap_b32 v116, v117
v_cvt_pk_bf16_f32 v18, v84, v85
v_permlane32_swap_b32 v124, v125
v_cvt_pk_bf16_f32 v26, v92, v93
v_max_f32 v100, v100, v101
v_cvt_pk_bf16_f32 v3, v70, v71
v_max_f32 v108, v108, v109
v_cvt_pk_bf16_f32 v11, v78, v79
v_max_f32 v116, v116, v117
v_cvt_pk_bf16_f32 v19, v86, v87
v_max_f32 v124, v124, v125
v_cvt_pk_bf16_f32 v27, v94, v95
v_mov_b32 v101, v100
buffer_store_dwordx4 v[0:3], v253, s[12:15], s34 offen sc1
v_mov_b32 v109, v108
buffer_store_dwordx4 v[8:11], v253, s[12:15], s35 offen sc1
v_mov_b32 v117, v116
buffer_store_dwordx4 v[16:19], v253, s[12:15], s36 offen sc1
v_mov_b32 v125, v124
buffer_store_dwordx4 v[24:27], v253, s[12:15], s37 offen sc1
v_permlane16_swap_b32 v100, v101
v_permlane16_swap_b32 v108, v109
v_permlane16_swap_b32 v116, v117
v_permlane16_swap_b32 v124, v125
v_max_f32 v100, v100, v101
v_max_f32 v108, v108, v109
v_max_f32 v116, v116, v117
v_max_f32 v124, v124, v125
v_mul_f32 v100, s44, v100
v_mul_f32 v108, s44, v108
v_mul_f32 v116, s44, v116
v_mul_f32 v124, s44, v124
v_fma_f32 v172, v172, s44, -v100
v_fma_f32 v180, v180, s44, -v108
v_fma_f32 v188, v188, s44, -v116
v_fma_f32 v196, v196, s44, -v124
v_fma_f32 v173, v173, s44, -v100
v_fma_f32 v181, v181, s44, -v108
v_fma_f32 v189, v189, s44, -v116
v_fma_f32 v197, v197, s44, -v124
v_fma_f32 v174, v174, s44, -v100
v_fma_f32 v182, v182, s44, -v108
v_fma_f32 v190, v190, s44, -v116
v_fma_f32 v198, v198, s44, -v124
v_fma_f32 v175, v175, s44, -v100
v_fma_f32 v183, v183, s44, -v108
v_fma_f32 v191, v191, s44, -v116
v_fma_f32 v199, v199, s44, -v124
v_exp_f32 v172, v172
v_exp_f32 v180, v180
v_exp_f32 v188, v188
v_exp_f32 v196, v196
v_exp_f32 v173, v173
v_exp_f32 v181, v181
v_exp_f32 v189, v189
v_exp_f32 v197, v197
v_exp_f32 v174, v174
v_exp_f32 v182, v182
v_exp_f32 v190, v190
v_exp_f32 v198, v198
v_exp_f32 v175, v175
v_exp_f32 v183, v183
v_exp_f32 v191, v191
v_exp_f32 v199, v199
v_pk_add_f32 v[36:37], v[172:173], v[174:175]
v_pk_add_f32 v[44:45], v[180:181], v[182:183]
v_pk_add_f32 v[52:53], v[188:189], v[190:191]
v_pk_add_f32 v[60:61], v[196:197], v[198:199]
v_add_f32 v100, v36, v37
v_add_f32 v108, v44, v45
v_add_f32 v116, v52, v53
v_add_f32 v124, v60, v61
v_mov_b32 v101, v100
v_mov_b32 v109, v108
v_mov_b32 v117, v116
v_mov_b32 v125, v124
v_permlane32_swap_b32 v100, v101
v_permlane32_swap_b32 v108, v109
v_permlane32_swap_b32 v116, v117
v_permlane32_swap_b32 v124, v125
v_add_f32 v100, v100, v101
v_add_f32 v108, v108, v109
v_add_f32 v116, v116, v117
v_add_f32 v124, v124, v125
v_mov_b32 v101, v100
v_mov_b32 v109, v108
v_mov_b32 v117, v116
v_mov_b32 v125, v124
v_permlane16_swap_b32 v100, v101
v_permlane16_swap_b32 v108, v109
v_permlane16_swap_b32 v116, v117
v_permlane16_swap_b32 v124, v125
v_add_f32 v100, v100, v101
v_add_f32 v108, v108, v109
v_add_f32 v116, v116, v117
v_add_f32 v124, v124, v125
v_rcp_f32 v100, v100
v_rcp_f32 v108, v108
v_rcp_f32 v116, v116
v_rcp_f32 v124, v124
v_mul_f32 v172, v172, v100
v_mul_f32 v180, v180, v108
v_mul_f32 v188, v188, v116
v_mul_f32 v196, v196, v124
v_mul_f32 v173, v173, v100
v_mul_f32 v181, v181, v108
v_mul_f32 v189, v189, v116
v_mul_f32 v197, v197, v124
v_mul_f32 v174, v174, v100
v_mul_f32 v182, v182, v108
v_mul_f32 v190, v190, v116
v_mul_f32 v198, v198, v124
v_mul_f32 v175, v175, v100
v_mul_f32 v183, v183, v108
v_mul_f32 v191, v191, v116
v_mul_f32 v199, v199, v124
v_cvt_pk_bf16_f32 v36, v172, v173
v_cvt_pk_bf16_f32 v44, v180, v181
v_cvt_pk_bf16_f32 v52, v188, v189
v_cvt_pk_bf16_f32 v60, v196, v197
v_cvt_pk_bf16_f32 v37, v174, v175
v_cvt_pk_bf16_f32 v45, v182, v183
v_cvt_pk_bf16_f32 v53, v190, v191
v_cvt_pk_bf16_f32 v61, v198, v199
v_and_b32 v168, v250, v36
v_and_b32 v176, v250, v44
v_and_b32 v184, v250, v52
v_and_b32 v192, v250, v60
v_and_b32 v169, v251, v37
v_and_b32 v177, v251, v45
v_and_b32 v185, v251, v53
v_and_b32 v193, v251, v61
v_and_b32 v170, v248, v36
v_and_b32 v178, v248, v44
v_and_b32 v186, v248, v52
v_and_b32 v194, v248, v60
v_and_b32 v171, v249, v37
v_and_b32 v179, v249, v45
v_and_b32 v187, v249, v53
v_and_b32 v195, v249, v61
v_mfma_f32_16x16x32_bf16 v[36:39], v[212:215], v[168:171], 0
v_mfma_f32_16x16x32_bf16 v[44:47], v[222:225], v[176:179], 0
v_mfma_f32_16x16x32_bf16 v[52:55], v[214:217], v[184:187], 0
v_mfma_f32_16x16x32_bf16 v[60:63], v[224:227], v[192:195], 0
v_mfma_f32_16x16x32_bf16 v[100:103], v[232:235], v[168:171], 0
v_mfma_f32_16x16x32_bf16 v[108:111], v[242:245], v[176:179], 0
v_mfma_f32_16x16x32_bf16 v[116:119], v[234:237], v[184:187], 0
v_mfma_f32_16x16x32_bf16 v[124:127], v[244:247], v[192:195], 0
s_nop 0
v_cvt_pk_bf16_f32 v32, v36, v37
v_cvt_pk_bf16_f32 v40, v44, v45
v_cvt_pk_bf16_f32 v48, v52, v53
v_cvt_pk_bf16_f32 v56, v60, v61
v_cvt_pk_bf16_f32 v33, v38, v39
v_cvt_pk_bf16_f32 v41, v46, v47
v_cvt_pk_bf16_f32 v49, v54, v55
v_cvt_pk_bf16_f32 v57, v62, v63
v_cvt_pk_bf16_f32 v34, v100, v101
v_cvt_pk_bf16_f32 v42, v108, v109
v_cvt_pk_bf16_f32 v50, v116, v117
v_cvt_pk_bf16_f32 v58, v124, v125
v_cvt_pk_bf16_f32 v35, v102, v103
v_cvt_pk_bf16_f32 v43, v110, v111
v_cvt_pk_bf16_f32 v51, v118, v119
v_cvt_pk_bf16_f32 v59, v126, v127
buffer_store_dwordx4 v[32:35], v253, s[12:15], s38 offen sc1
buffer_store_dwordx4 v[40:43], v253, s[12:15], s39 offen sc1
buffer_store_dwordx4 v[48:51], v253, s[12:15], s40 offen sc1
buffer_store_dwordx4 v[56:59], v253, s[12:15], s41 offen sc1
s_waitcnt vmcnt(8)
L2_start:
v_accvgpr_read_b32 v230, a168
v_accvgpr_read_b32 v231, a169
v_and_b32 v219, 1, v254
v_cmp_eq_u32 vcc, 1, v219
v_lshlrev_b32 v212, 4, v254
v_lshlrev_b32 v236, 2, v254
v_cndmask_b32 v219, v230, v231, vcc
s_lshl_b32 s77, s94, 4
s_lshl_b32 s77, 0xffff, s77
s_cmp_eq_u32 s94, 0
s_mov_b32 s70, 18354176
s_cselect_b32 s70, 10489856, s70
s_lshl_b32 s86, s94, 21
s_add_u32 s87, s86, 524288
s_add_u32 s88, s86, 1048576
s_add_u32 s89, s86, 1572864
s_lshl_b32 s39, s92, 3
s_lshl_b32 s51, s20, 1
s_add_u32 s39, s39, s51
s_lshl_b32 s51, s39, 12
s_add_u32 s68, s32, s51
s_addc_u32 s69, s33, 0
s_and_b32 s69, s69, 0xffff
s_mov_b32 s71, 0x20000
s_add_u32 s51, s51, 4096
s_add_u32 s72, s32, s51
s_addc_u32 s73, s33, 0
s_and_b32 s73, s73, 0xffff
s_mov_b32 s74, s70
s_mov_b32 s75, 0x20000
s_mov_b32 s67, 0
v_accvgpr_read_b32 v221, a178
L2_mk:
v_cmp_ne_u32 vcc, v219, v221
s_add_u32 s67, s67, 1
s_and_b32 s78, vcc_lo, s77
s_cbranch_scc0 L2_mk_ok
s_cmp_gt_u32 s67, 0x80000
s_cbranch_scc1 L2_mk_ok
buffer_load_dword v221, v236, s[12:15], s48 offen sc1
s_waitcnt vmcnt(0)
s_branch L2_mk
L2_mk_ok:
buffer_load_dwordx4 v[64:67], v212, s[68:71], s86 offen offset:0 sc1
buffer_load_dwordx4 v[68:71], v212, s[72:75], s86 offen offset:0 sc1
buffer_load_dwordx4 v[72:75], v212, s[68:71], s86 offen offset:1024 sc1
buffer_load_dwordx4 v[76:79], v212, s[72:75], s86 offen offset:1024 sc1
buffer_load_dwordx4 v[80:83], v212, s[68:71], s86 offen offset:2048 sc1
buffer_load_dwordx4 v[84:87], v212, s[72:75], s86 offen offset:2048 sc1
buffer_load_dwordx4 v[88:91], v212, s[68:71], s86 offen offset:3072 sc1
buffer_load_dwordx4 v[92:95], v212, s[72:75], s86 offen offset:3072 sc1
v_lshrrev_b32 v250, 4, v254
v_and_b32 v251, 15, v254
v_lshlrev_b32 v252, 1, v250
v_xor_b32 v251, v252, v251
v_lshlrev_b32 v250, 11, v250
v_lshl_add_u32 v208, v251, 4, v250
v_xor_b32 v251, 8, v251
v_lshl_add_u32 v251, v251, 4, v250
v_add_u32 v209, 7168, v251
v_add_u32 v210, 14336, v208
v_add_u32 v211, 21504, v251
buffer_load_dwordx4 v[96:99], v212, s[68:71], s87 offen offset:0 sc1
buffer_load_dwordx4 v[100:103], v212, s[72:75], s87 offen offset:0 sc1
buffer_load_dwordx4 v[104:107], v212, s[68:71], s87 offen offset:1024 sc1
buffer_load_dwordx4 v[108:111], v212, s[72:75], s87 offen offset:1024 sc1
buffer_load_dwordx4 v[112:115], v212, s[68:71], s87 offen offset:2048 sc1
buffer_load_dwordx4 v[116:119], v212, s[72:75], s87 offen offset:2048 sc1
buffer_load_dwordx4 v[120:123], v212, s[68:71], s87 offen offset:3072 sc1
buffer_load_dwordx4 v[124:127], v212, s[72:75], s87 offen offset:3072 sc1
s_mov_b32 s38, s96
s_add_u32 s59, s38, 32768
s_add_u32 m0, s98, 65536
s_nop 0
buffer_load_dwordx4 v208, s[8:11], s38 offen offset:0 lds
buffer_load_dwordx4 v209, s[8:11], s38 offen offset:1024 lds
buffer_load_dwordx4 v210, s[8:11], s38 offen offset:2048 lds
buffer_load_dwordx4 v211, s[8:11], s38 offen offset:3072 lds
s_add_u32 m0, s98, 69632
s_nop 0
buffer_load_dwordx4 v208, s[8:11], s59 offen offset:0 lds
buffer_load_dwordx4 v209, s[8:11], s59 offen offset:1024 lds
buffer_load_dwordx4 v210, s[8:11], s59 offen offset:2048 lds
buffer_load_dwordx4 v211, s[8:11], s59 offen offset:3072 lds
s_add_u32 s38, s38, 262144
s_add_u32 m0, s98, 98304
s_nop 0
buffer_load_dwordx4 v208, s[8:11], s38 offen offset:0 lds
buffer_load_dwordx4 v209, s[8:11], s38 offen offset:1024 lds
s_lshr_b32 s61, s92, 1
s_lshl_b32 s61, s61, 8
s_add_u32 s61, s61, 0x1440000
s_cmp_eq_u32 s94, 0
s_cselect_b32 s34, 17, 19
s_cselect_b32 s50, -5, 16
s_mov_b32 s40, 11010048
s_cselect_b32 s40, 4194304, s40
s_mov_b32 s36, 7340032
s_cselect_b32 s36, 3407872, s36
s_cselect_b32 s37, 0, 3407872
s_add_u32 s37, s37, s97
s_mov_b32 s46, 4
s_mov_b32 s16, s28
s_and_b32 s17, s29, 0xffff
s_mov_b32 s18, 0x400000
s_mov_b32 s19, 0x20000
v_lshrrev_b32 v1, 4, v254
v_bfe_u32 v3, v254, 2, 2
v_and_b32 v4, 3, v254
v_lshlrev_b32 v4, 3, v4
v_lshl_add_u32 v5, v1, 2, v3
v_lshl_add_u32 v4, v5, 8, v4
v_and_b32 v6, 7, v5
v_xor_b32 v7, 0, v6
v_lshl_add_u32 v192, v7, 5, v4
v_add_u32 v200, 0x10000, v192
v_xor_b32 v7, 1, v6
v_lshl_add_u32 v193, v7, 5, v4
v_add_u32 v201, 0x10000, v193
v_xor_b32 v7, 2, v6
v_lshl_add_u32 v194, v7, 5, v4
v_add_u32 v202, 0x10000, v194
v_xor_b32 v7, 3, v6
v_lshl_add_u32 v195, v7, 5, v4
v_add_u32 v203, 0x10000, v195
v_xor_b32 v7, 4, v6
v_lshl_add_u32 v196, v7, 5, v4
v_add_u32 v204, 0x10000, v196
v_xor_b32 v7, 5, v6
v_lshl_add_u32 v197, v7, 5, v4
v_add_u32 v205, 0x10000, v197
v_xor_b32 v7, 6, v6
v_lshl_add_u32 v198, v7, 5, v4
v_add_u32 v206, 0x10000, v198
v_xor_b32 v7, 7, v6
v_lshl_add_u32 v199, v7, 5, v4
v_add_u32 v207, 0x10000, v199
v_and_b32 v217, 15, v254
v_lshlrev_b32 v217, 7, v217
v_mov_b32 v220, 0
v_and_b32 v232, 4, v236
v_lshlrev_b32 v239, 3, v254
s_lshl_b32 s60, s21, 1
s_add_u32 s60, s60, s23
s_lshl_b32 s60, s60, 4
s_add_u32 s60, s60, s22
s_lshl_b32 s60, s60, 3
s_add_u32 s60, s60, 0x1440000
s_cmp_eq_u32 s20, 0
s_cselect_b32 s60, s60, 0x40000000
s_lshl_b32 s51, s92, 3
s_add_u32 s51, s51, s93
s_lshl_b32 s62, s51, 7
s_add_u32 s62, s62, 0x1441000
s_lshl_b32 s63, s51, 16
s_lshl_b32 s53, s20, 14
s_add_u32 s63, s63, s53
s_add_u32 s63, s63, 0x1500000
s_add_u32 s80, s63, 0
s_add_u32 s81, s63, 4096
s_add_u32 s82, s63, 8192
s_add_u32 s83, s63, 12288
s_lshl_b32 s64, s39, 10
s_add_u32 s64, s64, 0x1400000
s_mov_b32 s66, 0
s_lshl_b32 s54, s92, 18
s_lshl_b32 s55, s20, 16
s_add_u32 s54, s54, s55
s_lshl_b32 s55, s93, 8
s_add_u32 s54, s54, s55
s_add_u32 s55, s98, 0x20000
s_mov_b32 s84, 254
s_mov_b32 s85, 268
s_waitcnt vmcnt(18)
s_barrier
buffer_store_dwordx2 v[230:231], v220, s[12:15], s60 offen sc1
ds_read_b64_tr_b16 a[0:1], v192 offset:0
ds_read_b64_tr_b16 a[2:3], v192 offset:4096
ds_read_b64_tr_b16 a[4:5], v193 offset:0
ds_read_b64_tr_b16 a[6:7], v193 offset:4096
ds_read_b64_tr_b16 a[8:9], v194 offset:0
ds_read_b64_tr_b16 a[10:11], v194 offset:4096
ds_read_b64_tr_b16 a[12:13], v195 offset:0
ds_read_b64_tr_b16 a[14:15], v195 offset:4096
ds_read_b64_tr_b16 a[16:17], v196 offset:0
ds_read_b64_tr_b16 a[18:19], v196 offset:4096
ds_read_b64_tr_b16 a[20:21], v197 offset:0
ds_read_b64_tr_b16 a[22:23], v197 offset:4096
ds_read_b64_tr_b16 a[24:25], v198 offset:0
ds_read_b64_tr_b16 a[26:27], v198 offset:4096
ds_read_b64_tr_b16 a[28:29], v199 offset:0
ds_read_b64_tr_b16 a[30:31], v199 offset:4096
v_max3_u32 v233, v64, v65, v66
v_max3_u32 v234, v72, v73, v74
v_max3_u32 v235, v80, v81, v82
v_max3_u32 v237, v88, v89, v90
v_max3_u32 v233, v233, v67, v68
v_max3_u32 v234, v234, v75, v76
v_max3_u32 v235, v235, v83, v84
v_max3_u32 v237, v237, v91, v92
v_max3_u32 v233, v233, v69, v70
v_max3_u32 v234, v234, v77, v78
v_max3_u32 v235, v235, v85, v86
v_max3_u32 v237, v237, v93, v94
v_max3_u32 v233, v233, v71, v79
v_max3_u32 v235, v235, v87, v95
v_max3_u32 v233, v233, v234, v235
v_max_u32 v233, v233, v237
L2_v0:
v_cmp_eq_u32 vcc, -1, v233
s_add_u32 s67, s67, 1
s_cbranch_vccz L2_v0_ok
s_cmp_gt_u32 s67, 0x80000
s_cbranch_scc1 L2_v0_ok
buffer_load_dwordx4 v[64:67], v212, s[68:71], s86 offen offset:0 sc1
buffer_load_dwordx4 v[68:71], v212, s[72:75], s86 offen offset:0 sc1
buffer_load_dwordx4 v[72:75], v212, s[68:71], s86 offen offset:1024 sc1
buffer_load_dwordx4 v[76:79], v212, s[72:75], s86 offen offset:1024 sc1
buffer_load_dwordx4 v[80:83], v212, s[68:71], s86 offen offset:2048 sc1
buffer_load_dwordx4 v[84:87], v212, s[72:75], s86 offen offset:2048 sc1
buffer_load_dwordx4 v[88:91], v212, s[68:71], s86 offen offset:3072 sc1
buffer_load_dwordx4 v[92:95], v212, s[72:75], s86 offen offset:3072 sc1
s_waitcnt vmcnt(0)
v_max3_u32 v233, v64, v65, v66
v_max3_u32 v234, v72, v73, v74
v_max3_u32 v235, v80, v81, v82
v_max3_u32 v237, v88, v89, v90
v_max3_u32 v233, v233, v67, v68
v_max3_u32 v234, v234, v75, v76
v_max3_u32 v235, v235, v83, v84
v_max3_u32 v237, v237, v91, v92
v_max3_u32 v233, v233, v69, v70
v_max3_u32 v234, v234, v77, v78
v_max3_u32 v235, v235, v85, v86
v_max3_u32 v237, v237, v93, v94
v_max3_u32 v233, v233, v71, v79
v_max3_u32 v235, v235, v87, v95
v_max3_u32 v233, v233, v234, v235
v_max_u32 v233, v233, v237
s_branch L2_v0
L2_v0_ok:
s_waitcnt vmcnt(25) lgkmcnt(0)
v_mfma_f32_16x16x32_bf16 v[0:3], a[0:3], v[64:67], 0
ds_read_b64_tr_b16 a[32:33], v192 offset:8192
ds_read_b64_tr_b16 a[34:35], v192 offset:12288
s_add_u32 s59, s38, 32768
v_mfma_f32_16x16x32_bf16 v[32:35], a[0:3], v[68:71], 0
ds_read_b64_tr_b16 a[36:37], v193 offset:8192
buffer_load_dwordx4 v210, s[8:11], s38 offen offset:2048 lds
v_mfma_f32_16x16x32_bf16 v[4:7], a[4:7], v[64:67], 0
ds_read_b64_tr_b16 a[38:39], v193 offset:12288
v_mfma_f32_16x16x32_bf16 v[36:39], a[4:7], v[68:71], 0
ds_read_b64_tr_b16 a[40:41], v194 offset:8192
v_mfma_f32_16x16x32_bf16 v[8:11], a[8:11], v[64:67], 0
ds_read_b64_tr_b16 a[42:43], v194 offset:12288
ds_read_b64_tr_b16 a[44:45], v195 offset:8192
buffer_load_dwordx4 v211, s[8:11], s38 offen offset:3072 lds
v_mfma_f32_16x16x32_bf16 v[40:43], a[8:11], v[68:71], 0
ds_read_b64_tr_b16 a[46:47], v195 offset:12288
v_mfma_f32_16x16x32_bf16 v[12:15], a[12:15], v[64:67], 0
ds_read_b64_tr_b16 a[48:49], v196 offset:8192
v_mfma_f32_16x16x32_bf16 v[44:47], a[12:15], v[68:71], 0
ds_read_b64_tr_b16 a[50:51], v196 offset:12288
buffer_load_dwordx4 v[128:131], v212, s[68:71], s88 offen offset:0 sc1
v_mfma_f32_16x16x32_bf16 v[16:19], a[16:19], v[64:67], 0
ds_read_b64_tr_b16 a[52:53], v197 offset:8192
ds_read_b64_tr_b16 a[54:55], v197 offset:12288
v_mfma_f32_16x16x32_bf16 v[48:51], a[16:19], v[68:71], 0
ds_read_b64_tr_b16 a[56:57], v198 offset:8192
buffer_load_dwordx4 v[132:135], v212, s[72:75], s88 offen offset:0 sc1
v_mfma_f32_16x16x32_bf16 v[20:23], a[20:23], v[64:67], 0
ds_read_b64_tr_b16 a[58:59], v198 offset:12288
v_mfma_f32_16x16x32_bf16 v[52:55], a[20:23], v[68:71], 0
ds_read_b64_tr_b16 a[60:61], v199 offset:8192
v_mfma_f32_16x16x32_bf16 v[24:27], a[24:27], v[64:67], 0
ds_read_b64_tr_b16 a[62:63], v199 offset:12288
buffer_load_dwordx4 v[136:139], v212, s[68:71], s88 offen offset:1024 sc1
v_mfma_f32_16x16x32_bf16 v[56:59], a[24:27], v[68:71], 0
v_mfma_f32_16x16x32_bf16 v[28:31], a[28:31], v[64:67], 0
buffer_load_dwordx4 v[140:143], v212, s[72:75], s88 offen offset:1024 sc1
v_mfma_f32_16x16x32_bf16 v[60:63], a[28:31], v[68:71], 0
s_waitcnt vmcnt(29) lgkmcnt(0)
v_mfma_f32_16x16x32_bf16 v[0:3], a[32:35], v[72:75], v[0:3]
ds_read_b64_tr_b16 a[0:1], v192 offset:16384
ds_read_b64_tr_b16 a[2:3], v192 offset:20480
s_add_u32 m0, s98, 102400
v_mfma_f32_16x16x32_bf16 v[32:35], a[32:35], v[76:79], v[32:35]
ds_read_b64_tr_b16 a[4:5], v193 offset:16384
buffer_load_dwordx4 v208, s[8:11], s59 offen offset:0 lds
v_mfma_f32_16x16x32_bf16 v[4:7], a[36:39], v[72:75], v[4:7]
ds_read_b64_tr_b16 a[6:7], v193 offset:20480
v_mfma_f32_16x16x32_bf16 v[36:39], a[36:39], v[76:79], v[36:39]
ds_read_b64_tr_b16 a[8:9], v194 offset:16384
v_mfma_f32_16x16x32_bf16 v[8:11], a[40:43], v[72:75], v[8:11]
ds_read_b64_tr_b16 a[10:11], v194 offset:20480
ds_read_b64_tr_b16 a[12:13], v195 offset:16384
buffer_load_dwordx4 v209, s[8:11], s59 offen offset:1024 lds
v_mfma_f32_16x16x32_bf16 v[40:43], a[40:43], v[76:79], v[40:43]
ds_read_b64_tr_b16 a[14:15], v195 offset:20480
v_mfma_f32_16x16x32_bf16 v[12:15], a[44:47], v[72:75], v[12:15]
ds_read_b64_tr_b16 a[16:17], v196 offset:16384
v_mfma_f32_16x16x32_bf16 v[44:47], a[44:47], v[76:79], v[44:47]
ds_read_b64_tr_b16 a[18:19], v196 offset:20480
buffer_load_dwordx4 v[144:147], v212, s[68:71], s88 offen offset:2048 sc1
v_mfma_f32_16x16x32_bf16 v[16:19], a[48:51], v[72:75], v[16:19]
ds_read_b64_tr_b16 a[20:21], v197 offset:16384
ds_read_b64_tr_b16 a[22:23], v197 offset:20480
v_mfma_f32_16x16x32_bf16 v[48:51], a[48:51], v[76:79], v[48:51]
ds_read_b64_tr_b16 a[24:25], v198 offset:16384
buffer_load_dwordx4 v[148:151], v212, s[72:75], s88 offen offset:2048 sc1
v_mfma_f32_16x16x32_bf16 v[20:23], a[52:55], v[72:75], v[20:23]
ds_read_b64_tr_b16 a[26:27], v198 offset:20480
v_mfma_f32_16x16x32_bf16 v[52:55], a[52:55], v[76:79], v[52:55]
ds_read_b64_tr_b16 a[28:29], v199 offset:16384
v_mfma_f32_16x16x32_bf16 v[24:27], a[56:59], v[72:75], v[24:27]
ds_read_b64_tr_b16 a[30:31], v199 offset:20480
buffer_load_dwordx4 v[152:155], v212, s[68:71], s88 offen offset:3072 sc1
v_mfma_f32_16x16x32_bf16 v[56:59], a[56:59], v[76:79], v[56:59]
v_mfma_f32_16x16x32_bf16 v[28:31], a[60:63], v[72:75], v[28:31]
buffer_load_dwordx4 v[156:159], v212, s[72:75], s88 offen offset:3072 sc1
v_mfma_f32_16x16x32_bf16 v[60:63], a[60:63], v[76:79], v[60:63]
s_waitcnt vmcnt(33) lgkmcnt(0)
v_mfma_f32_16x16x32_bf16 v[0:3], a[0:3], v[80:83], v[0:3]
ds_read_b64_tr_b16 a[32:33], v192 offset:24576
ds_read_b64_tr_b16 a[34:35], v192 offset:28672
v_mfma_f32_16x16x32_bf16 v[32:35], a[0:3], v[84:87], v[32:35]
ds_read_b64_tr_b16 a[36:37], v193 offset:24576
buffer_load_dwordx4 v210, s[8:11], s59 offen offset:2048 lds
v_mfma_f32_16x16x32_bf16 v[4:7], a[4:7], v[80:83], v[4:7]
ds_read_b64_tr_b16 a[38:39], v193 offset:28672
v_mfma_f32_16x16x32_bf16 v[36:39], a[4:7], v[84:87], v[36:39]
ds_read_b64_tr_b16 a[40:41], v194 offset:24576
v_mfma_f32_16x16x32_bf16 v[8:11], a[8:11], v[80:83], v[8:11]
ds_read_b64_tr_b16 a[42:43], v194 offset:28672
ds_read_b64_tr_b16 a[44:45], v195 offset:24576
buffer_load_dwordx4 v211, s[8:11], s59 offen offset:3072 lds
v_mfma_f32_16x16x32_bf16 v[40:43], a[8:11], v[84:87], v[40:43]
ds_read_b64_tr_b16 a[46:47], v195 offset:28672
v_mfma_f32_16x16x32_bf16 v[12:15], a[12:15], v[80:83], v[12:15]
ds_read_b64_tr_b16 a[48:49], v196 offset:24576
v_mfma_f32_16x16x32_bf16 v[44:47], a[12:15], v[84:87], v[44:47]
ds_read_b64_tr_b16 a[50:51], v196 offset:28672
buffer_load_dwordx4 v[160:163], v212, s[68:71], s89 offen offset:0 sc1
v_mfma_f32_16x16x32_bf16 v[16:19], a[16:19], v[80:83], v[16:19]
ds_read_b64_tr_b16 a[52:53], v197 offset:24576
ds_read_b64_tr_b16 a[54:55], v197 offset:28672
v_mfma_f32_16x16x32_bf16 v[48:51], a[16:19], v[84:87], v[48:51]
ds_read_b64_tr_b16 a[56:57], v198 offset:24576
buffer_load_dwordx4 v[164:167], v212, s[72:75], s89 offen offset:0 sc1
v_mfma_f32_16x16x32_bf16 v[20:23], a[20:23], v[80:83], v[20:23]
ds_read_b64_tr_b16 a[58:59], v198 offset:28672
v_mfma_f32_16x16x32_bf16 v[52:55], a[20:23], v[84:87], v[52:55]
ds_read_b64_tr_b16 a[60:61], v199 offset:24576
v_mfma_f32_16x16x32_bf16 v[24:27], a[24:27], v[80:83], v[24:27]
ds_read_b64_tr_b16 a[62:63], v199 offset:28672
buffer_load_dwordx4 v[168:171], v212, s[68:71], s89 offen offset:1024 sc1
v_mfma_f32_16x16x32_bf16 v[56:59], a[24:27], v[84:87], v[56:59]
v_mfma_f32_16x16x32_bf16 v[28:31], a[28:31], v[80:83], v[28:31]
buffer_load_dwordx4 v[172:175], v212, s[72:75], s89 offen offset:1024 sc1
v_mfma_f32_16x16x32_bf16 v[60:63], a[28:31], v[84:87], v[60:63]
s_waitcnt vmcnt(29) lgkmcnt(0)
s_barrier
v_mfma_f32_16x16x32_bf16 v[0:3], a[32:35], v[88:91], v[0:3]
ds_read_b64_tr_b16 a[0:1], v192 offset:32768
ds_read_b64_tr_b16 a[2:3], v192 offset:36864
s_mov_b32 s8, s26
s_and_b32 s9, s27, 0xffff
s_mov_b32 s10, s36
s_mov_b32 s38, s37
s_add_u32 m0, s98, 0
v_max3_u32 v233, v96, v97, v98
v_mfma_f32_16x16x32_bf16 v[32:35], a[32:35], v[92:95], v[32:35]
ds_read_b64_tr_b16 a[4:5], v193 offset:32768
buffer_load_dwordx4 v208, s[8:11], s38 offen offset:0 lds
v_max3_u32 v234, v104, v105, v106
v_mfma_f32_16x16x32_bf16 v[4:7], a[36:39], v[88:91], v[4:7]
ds_read_b64_tr_b16 a[6:7], v193 offset:36864
v_max3_u32 v235, v112, v113, v114
v_mfma_f32_16x16x32_bf16 v[36:39], a[36:39], v[92:95], v[36:39]
ds_read_b64_tr_b16 a[8:9], v194 offset:32768
v_max3_u32 v237, v120, v121, v122
v_mfma_f32_16x16x32_bf16 v[8:11], a[40:43], v[88:91], v[8:11]
ds_read_b64_tr_b16 a[10:11], v194 offset:36864
ds_read_b64_tr_b16 a[12:13], v195 offset:32768
buffer_load_dwordx4 v209, s[8:11], s38 offen offset:1024 lds
v_max3_u32 v233, v233, v99, v100
v_mfma_f32_16x16x32_bf16 v[40:43], a[40:43], v[92:95], v[40:43]
ds_read_b64_tr_b16 a[14:15], v195 offset:36864
v_max3_u32 v234, v234, v107, v108
v_mfma_f32_16x16x32_bf16 v[12:15], a[44:47], v[88:91], v[12:15]
ds_read_b64_tr_b16 a[16:17], v196 offset:32768
v_max3_u32 v235, v235, v115, v116
v_mfma_f32_16x16x32_bf16 v[44:47], a[44:47], v[92:95], v[44:47]
ds_read_b64_tr_b16 a[18:19], v196 offset:36864
buffer_load_dwordx4 v[176:179], v212, s[68:71], s89 offen offset:2048 sc1
v_max3_u32 v237, v237, v123, v124
v_mfma_f32_16x16x32_bf16 v[16:19], a[48:51], v[88:91], v[16:19]
ds_read_b64_tr_b16 a[20:21], v197 offset:32768
ds_read_b64_tr_b16 a[22:23], v197 offset:36864
v_max3_u32 v233, v233, v101, v102
v_mfma_f32_16x16x32_bf16 v[48:51], a[48:51], v[92:95], v[48:51]
ds_read_b64_tr_b16 a[24:25], v198 offset:32768
buffer_load_dwordx4 v[180:183], v212, s[72:75], s89 offen offset:2048 sc1
v_max3_u32 v234, v234, v109, v110
v_mfma_f32_16x16x32_bf16 v[20:23], a[52:55], v[88:91], v[20:23]
ds_read_b64_tr_b16 a[26:27], v198 offset:36864
v_max3_u32 v235, v235, v117, v118
v_mfma_f32_16x16x32_bf16 v[52:55], a[52:55], v[92:95], v[52:55]
ds_read_b64_tr_b16 a[28:29], v199 offset:32768
v_max3_u32 v237, v237, v125, v126
v_mfma_f32_16x16x32_bf16 v[24:27], a[56:59], v[88:91], v[24:27]
ds_read_b64_tr_b16 a[30:31], v199 offset:36864
buffer_load_dwordx4 v[184:187], v212, s[68:71], s89 offen offset:3072 sc1
v_max3_u32 v233, v233, v103, v111
v_mfma_f32_16x16x32_bf16 v[56:59], a[56:59], v[92:95], v[56:59]
v_max3_u32 v235, v235, v119, v127
v_mfma_f32_16x16x32_bf16 v[28:31], a[60:63], v[88:91], v[28:31]
buffer_load_dwordx4 v[188:191], v212, s[72:75], s89 offen offset:3072 sc1
v_max3_u32 v233, v233, v234, v235
v_mfma_f32_16x16x32_bf16 v[60:63], a[60:63], v[92:95], v[60:63]
v_max_u32 v233, v233, v237
L2_v1:
v_cmp_eq_u32 vcc, -1, v233
s_add_u32 s67, s67, 1
s_cbranch_vccz L2_v1_ok
s_cmp_gt_u32 s67, 0x80000
s_cbranch_scc1 L2_v1_ok
buffer_load_dwordx4 v[96:99], v212, s[68:71], s87 offen offset:0 sc1
buffer_load_dwordx4 v[100:103], v212, s[72:75], s87 offen offset:0 sc1
buffer_load_dwordx4 v[104:107], v212, s[68:71], s87 offen offset:1024 sc1
buffer_load_dwordx4 v[108:111], v212, s[72:75], s87 offen offset:1024 sc1
buffer_load_dwordx4 v[112:115], v212, s[68:71], s87 offen offset:2048 sc1
buffer_load_dwordx4 v[116:119], v212, s[72:75], s87 offen offset:2048 sc1
buffer_load_dwordx4 v[120:123], v212, s[68:71], s87 offen offset:3072 sc1
buffer_load_dwordx4 v[124:127], v212, s[72:75], s87 offen offset:3072 sc1
s_waitcnt vmcnt(0)
v_max3_u32 v233, v96, v97, v98
v_max3_u32 v234, v104, v105, v106
v_max3_u32 v235, v112, v113, v114
v_max3_u32 v237, v120, v121, v122
v_max3_u32 v233, v233, v99, v100
v_max3_u32 v234, v234, v107, v108
v_max3_u32 v235, v235, v115, v116
v_max3_u32 v237, v237, v123, v124
v_max3_u32 v233, v233, v101, v102
v_max3_u32 v234, v234, v109, v110
v_max3_u32 v235, v235, v117, v118
v_max3_u32 v237, v237, v125, v126
v_max3_u32 v233, v233, v103, v111
v_max3_u32 v235, v235, v119, v127
v_max3_u32 v233, v233, v234, v235
v_max_u32 v233, v233, v237
s_branch L2_v1
L2_v1_ok:
s_waitcnt vmcnt(41) lgkmcnt(0)
v_mfma_f32_16x16x32_bf16 v[0:3], a[0:3], v[96:99], v[0:3]
ds_read_b64_tr_b16 a[32:33], v192 offset:40960
ds_read_b64_tr_b16 a[34:35], v192 offset:45056
v_mfma_f32_16x16x32_bf16 v[32:35], a[0:3], v[100:103], v[32:35]
ds_read_b64_tr_b16 a[36:37], v193 offset:40960
s_add_u32 s59, s38, 32768
v_mfma_f32_16x16x32_bf16 v[4:7], a[4:7], v[96:99], v[4:7]
ds_read_b64_tr_b16 a[38:39], v193 offset:45056
buffer_load_dwordx4 v210, s[8:11], s38 offen offset:2048 lds
v_mfma_f32_16x16x32_bf16 v[36:39], a[4:7], v[100:103], v[36:39]
ds_read_b64_tr_b16 a[40:41], v194 offset:40960
v_mfma_f32_16x16x32_bf16 v[8:11], a[8:11], v[96:99], v[8:11]
ds_read_b64_tr_b16 a[42:43], v194 offset:45056
ds_read_b64_tr_b16 a[44:45], v195 offset:40960
v_mfma_f32_16x16x32_bf16 v[40:43], a[8:11], v[100:103], v[40:43]
ds_read_b64_tr_b16 a[46:47], v195 offset:45056
v_mfma_f32_16x16x32_bf16 v[12:15], a[12:15], v[96:99], v[12:15]
ds_read_b64_tr_b16 a[48:49], v196 offset:40960
buffer_load_dwordx4 v211, s[8:11], s38 offen offset:3072 lds
v_mfma_f32_16x16x32_bf16 v[44:47], a[12:15], v[100:103], v[44:47]
ds_read_b64_tr_b16 a[50:51], v196 offset:45056
v_mfma_f32_16x16x32_bf16 v[16:19], a[16:19], v[96:99], v[16:19]
ds_read_b64_tr_b16 a[52:53], v197 offset:40960
ds_read_b64_tr_b16 a[54:55], v197 offset:45056
v_mfma_f32_16x16x32_bf16 v[48:51], a[16:19], v[100:103], v[48:51]
ds_read_b64_tr_b16 a[56:57], v198 offset:40960
v_mfma_f32_16x16x32_bf16 v[20:23], a[20:23], v[96:99], v[20:23]
ds_read_b64_tr_b16 a[58:59], v198 offset:45056
v_mfma_f32_16x16x32_bf16 v[52:55], a[20:23], v[100:103], v[52:55]
ds_read_b64_tr_b16 a[60:61], v199 offset:40960
v_mfma_f32_16x16x32_bf16 v[24:27], a[24:27], v[96:99], v[24:27]
ds_read_b64_tr_b16 a[62:63], v199 offset:45056
v_mfma_f32_16x16x32_bf16 v[56:59], a[24:27], v[100:103], v[56:59]
v_mfma_f32_16x16x32_bf16 v[28:31], a[28:31], v[96:99], v[28:31]
v_mfma_f32_16x16x32_bf16 v[60:63], a[28:31], v[100:103], v[60:63]
s_waitcnt vmcnt(41) lgkmcnt(0)
v_mfma_f32_16x16x32_bf16 v[0:3], a[32:35], v[104:107], v[0:3]
ds_read_b64_tr_b16 a[0:1], v192 offset:49152
ds_read_b64_tr_b16 a[2:3], v192 offset:53248
v_mfma_f32_16x16x32_bf16 v[32:35], a[32:35], v[108:111], v[32:35]
ds_read_b64_tr_b16 a[4:5], v193 offset:49152
s_add_u32 m0, s98, 4096
v_mfma_f32_16x16x32_bf16 v[4:7], a[36:39], v[104:107], v[4:7]
ds_read_b64_tr_b16 a[6:7], v193 offset:53248
buffer_load_dwordx4 v208, s[8:11], s59 offen offset:0 lds
v_mfma_f32_16x16x32_bf16 v[36:39], a[36:39], v[108:111], v[36:39]
ds_read_b64_tr_b16 a[8:9], v194 offset:49152
v_mfma_f32_16x16x32_bf16 v[8:11], a[40:43], v[104:107], v[8:11]
ds_read_b64_tr_b16 a[10:11], v194 offset:53248
ds_read_b64_tr_b16 a[12:13], v195 offset:49152
v_mfma_f32_16x16x32_bf16 v[40:43], a[40:43], v[108:111], v[40:43]
ds_read_b64_tr_b16 a[14:15], v195 offset:53248
v_mfma_f32_16x16x32_bf16 v[12:15], a[44:47], v[104:107], v[12:15]
ds_read_b64_tr_b16 a[16:17], v196 offset:49152
buffer_load_dwordx4 v209, s[8:11], s59 offen offset:1024 lds
v_mfma_f32_16x16x32_bf16 v[44:47], a[44:47], v[108:111], v[44:47]
ds_read_b64_tr_b16 a[18:19], v196 offset:53248
v_mfma_f32_16x16x32_bf16 v[16:19], a[48:51], v[104:107], v[16:19]
ds_read_b64_tr_b16 a[20:21], v197 offset:49152
ds_read_b64_tr_b16 a[22:23], v197 offset:53248
v_mfma_f32_16x16x32_bf16 v[48:51], a[48:51], v[108:111], v[48:51]
ds_read_b64_tr_b16 a[24:25], v198 offset:49152
v_mfma_f32_16x16x32_bf16 v[20:23], a[52:55], v[104:107], v[20:23]
ds_read_b64_tr_b16 a[26:27], v198 offset:53248
v_mfma_f32_16x16x32_bf16 v[52:55], a[52:55], v[108:111], v[52:55]
ds_read_b64_tr_b16 a[28:29], v199 offset:49152
v_mfma_f32_16x16x32_bf16 v[24:27], a[56:59], v[104:107], v[24:27]
ds_read_b64_tr_b16 a[30:31], v199 offset:53248
v_mfma_f32_16x16x32_bf16 v[56:59], a[56:59], v[108:111], v[56:59]
v_mfma_f32_16x16x32_bf16 v[28:31], a[60:63], v[104:107], v[28:31]
v_mfma_f32_16x16x32_bf16 v[60:63], a[60:63], v[108:111], v[60:63]
s_waitcnt vmcnt(41) lgkmcnt(0)
buffer_load_dword v221, v236, s[12:15], s61 offen sc1
v_mfma_f32_16x16x32_bf16 v[0:3], a[0:3], v[112:115], v[0:3]
ds_read_b64_tr_b16 a[32:33], v192 offset:57344
ds_read_b64_tr_b16 a[34:35], v192 offset:61440
v_mfma_f32_16x16x32_bf16 v[32:35], a[0:3], v[116:119], v[32:35]
ds_read_b64_tr_b16 a[36:37], v193 offset:57344
v_mfma_f32_16x16x32_bf16 v[4:7], a[4:7], v[112:115], v[4:7]
ds_read_b64_tr_b16 a[38:39], v193 offset:61440
buffer_load_dwordx4 v210, s[8:11], s59 offen offset:2048 lds
v_mfma_f32_16x16x32_bf16 v[36:39], a[4:7], v[116:119], v[36:39]
ds_read_b64_tr_b16 a[40:41], v194 offset:57344
v_mfma_f32_16x16x32_bf16 v[8:11], a[8:11], v[112:115], v[8:11]
ds_read_b64_tr_b16 a[42:43], v194 offset:61440
ds_read_b64_tr_b16 a[44:45], v195 offset:57344
v_mfma_f32_16x16x32_bf16 v[40:43], a[8:11], v[116:119], v[40:43]
ds_read_b64_tr_b16 a[46:47], v195 offset:61440
v_mfma_f32_16x16x32_bf16 v[12:15], a[12:15], v[112:115], v[12:15]
ds_read_b64_tr_b16 a[48:49], v196 offset:57344
buffer_load_dwordx4 v211, s[8:11], s59 offen offset:3072 lds
v_mfma_f32_16x16x32_bf16 v[44:47], a[12:15], v[116:119], v[44:47]
ds_read_b64_tr_b16 a[50:51], v196 offset:61440
v_mfma_f32_16x16x32_bf16 v[16:19], a[16:19], v[112:115], v[16:19]
ds_read_b64_tr_b16 a[52:53], v197 offset:57344
ds_read_b64_tr_b16 a[54:55], v197 offset:61440
v_mfma_f32_16x16x32_bf16 v[48:51], a[16:19], v[116:119], v[48:51]
ds_read_b64_tr_b16 a[56:57], v198 offset:57344
v_mfma_f32_16x16x32_bf16 v[20:23], a[20:23], v[112:115], v[20:23]
ds_read_b64_tr_b16 a[58:59], v198 offset:61440
v_mfma_f32_16x16x32_bf16 v[52:55], a[20:23], v[116:119], v[52:55]
ds_read_b64_tr_b16 a[60:61], v199 offset:57344
v_mfma_f32_16x16x32_bf16 v[24:27], a[24:27], v[112:115], v[24:27]
ds_read_b64_tr_b16 a[62:63], v199 offset:61440
v_mfma_f32_16x16x32_bf16 v[56:59], a[24:27], v[116:119], v[56:59]
v_mfma_f32_16x16x32_bf16 v[28:31], a[28:31], v[112:115], v[28:31]
v_mfma_f32_16x16x32_bf16 v[60:63], a[28:31], v[116:119], v[60:63]
s_waitcnt vmcnt(19) lgkmcnt(0)
s_barrier
v_mfma_f32_16x16x32_bf16 v[0:3], a[32:35], v[120:123], v[0:3]
ds_read_b64_tr_b16 a[0:1], v200 offset:0
ds_read_b64_tr_b16 a[2:3], v200 offset:4096
s_add_u32 s38, s38, 262144
v_max3_u32 v233, v128, v129, v130
v_mfma_f32_16x16x32_bf16 v[32:35], a[32:35], v[124:127], v[32:35]
ds_read_b64_tr_b16 a[4:5], v201 offset:0
s_add_u32 m0, s98, 32768
v_max3_u32 v234, v136, v137, v138
v_mfma_f32_16x16x32_bf16 v[4:7], a[36:39], v[120:123], v[4:7]
ds_read_b64_tr_b16 a[6:7], v201 offset:4096
buffer_load_dwordx4 v208, s[8:11], s38 offen offset:0 lds
v_max3_u32 v235, v144, v145, v146
v_mfma_f32_16x16x32_bf16 v[36:39], a[36:39], v[124:127], v[36:39]
ds_read_b64_tr_b16 a[8:9], v202 offset:0
v_max3_u32 v237, v152, v153, v154
v_mfma_f32_16x16x32_bf16 v[8:11], a[40:43], v[120:123], v[8:11]
ds_read_b64_tr_b16 a[10:11], v202 offset:4096
ds_read_b64_tr_b16 a[12:13], v203 offset:0
v_max3_u32 v233, v233, v131, v132
v_mfma_f32_16x16x32_bf16 v[40:43], a[40:43], v[124:127], v[40:43]
ds_read_b64_tr_b16 a[14:15], v203 offset:4096
v_max3_u32 v234, v234, v139, v140
v_mfma_f32_16x16x32_bf16 v[12:15], a[44:47], v[120:123], v[12:15]
ds_read_b64_tr_b16 a[16:17], v204 offset:0
buffer_load_dwordx4 v209, s[8:11], s38 offen offset:1024 lds
v_max3_u32 v235, v235, v147, v148
v_mfma_f32_16x16x32_bf16 v[44:47], a[44:47], v[124:127], v[44:47]
ds_read_b64_tr_b16 a[18:19], v204 offset:4096
v_max3_u32 v237, v237, v155, v156
v_mfma_f32_16x16x32_bf16 v[16:19], a[48:51], v[120:123], v[16:19]
ds_read_b64_tr_b16 a[20:21], v205 offset:0
ds_read_b64_tr_b16 a[22:23], v205 offset:4096
v_max3_u32 v233, v233, v133, v134
v_mfma_f32_16x16x32_bf16 v[48:51], a[48:51], v[124:127], v[48:51]
ds_read_b64_tr_b16 a[24:25], v206 offset:0
v_max3_u32 v234, v234, v141, v142
v_mfma_f32_16x16x32_bf16 v[20:23], a[52:55], v[120:123], v[20:23]
ds_read_b64_tr_b16 a[26:27], v206 offset:4096
v_max3_u32 v235, v235, v149, v150
v_mfma_f32_16x16x32_bf16 v[52:55], a[52:55], v[124:127], v[52:55]
ds_read_b64_tr_b16 a[28:29], v207 offset:0
v_max3_u32 v237, v237, v157, v158
v_mfma_f32_16x16x32_bf16 v[24:27], a[56:59], v[120:123], v[24:27]
ds_read_b64_tr_b16 a[30:31], v207 offset:4096
v_max3_u32 v233, v233, v135, v143
v_mfma_f32_16x16x32_bf16 v[56:59], a[56:59], v[124:127], v[56:59]
v_max3_u32 v235, v235, v151, v159
v_mfma_f32_16x16x32_bf16 v[28:31], a[60:63], v[120:123], v[28:31]
v_max3_u32 v233, v233, v234, v235
v_mfma_f32_16x16x32_bf16 v[60:63], a[60:63], v[124:127], v[60:63]
v_max_u32 v233, v233, v237
L2_v2:
v_cmp_eq_u32 vcc, -1, v233
s_add_u32 s67, s67, 1
s_cbranch_vccz L2_v2_ok
s_cmp_gt_u32 s67, 0x80000
s_cbranch_scc1 L2_v2_ok
buffer_load_dwordx4 v[128:131], v212, s[68:71], s88 offen offset:0 sc1
buffer_load_dwordx4 v[132:135], v212, s[72:75], s88 offen offset:0 sc1
buffer_load_dwordx4 v[136:139], v212, s[68:71], s88 offen offset:1024 sc1
buffer_load_dwordx4 v[140:143], v212, s[72:75], s88 offen offset:1024 sc1
buffer_load_dwordx4 v[144:147], v212, s[68:71], s88 offen offset:2048 sc1
buffer_load_dwordx4 v[148:151], v212, s[72:75], s88 offen offset:2048 sc1
buffer_load_dwordx4 v[152:155], v212, s[68:71], s88 offen offset:3072 sc1
buffer_load_dwordx4 v[156:159], v212, s[72:75], s88 offen offset:3072 sc1
s_waitcnt vmcnt(0)
v_max3_u32 v233, v128, v129, v130
v_max3_u32 v234, v136, v137, v138
v_max3_u32 v235, v144, v145, v146
v_max3_u32 v237, v152, v153, v154
v_max3_u32 v233, v233, v131, v132
v_max3_u32 v234, v234, v139, v140
v_max3_u32 v235, v235, v147, v148
v_max3_u32 v237, v237, v155, v156
v_max3_u32 v233, v233, v133, v134
v_max3_u32 v234, v234, v141, v142
v_max3_u32 v235, v235, v149, v150
v_max3_u32 v237, v237, v157, v158
v_max3_u32 v233, v233, v135, v143
v_max3_u32 v235, v235, v151, v159
v_max3_u32 v233, v233, v234, v235
v_max_u32 v233, v233, v237
s_branch L2_v2
L2_v2_ok:
s_waitcnt vmcnt(4) lgkmcnt(0)
L2_chk2:
v_cmp_ne_u32 vcc, v219, v221
s_add_u32 s67, s67, 1
s_cbranch_vccz L2_chk2_ok
s_cmp_gt_u32 s67, 0x80000
s_cbranch_scc1 L2_chk2_ok
s_sleep 2
buffer_load_dword v221, v236, s[12:15], s61 offen sc1
s_waitcnt vmcnt(0)
s_branch L2_chk2
L2_chk2_ok:
buffer_load_dwordx4 v[224:227], v217, s[12:15], s64 offen sc1
v_mfma_f32_16x16x32_bf16 v[0:3], a[0:3], v[128:131], v[0:3]
ds_read_b64_tr_b16 a[32:33], v200 offset:8192
ds_read_b64_tr_b16 a[34:35], v200 offset:12288
s_add_u32 s59, s38, 32768
v_mfma_f32_16x16x32_bf16 v[32:35], a[0:3], v[132:135], v[32:35]
ds_read_b64_tr_b16 a[36:37], v201 offset:8192
buffer_load_dwordx4 v210, s[8:11], s38 offen offset:2048 lds
v_mfma_f32_16x16x32_bf16 v[4:7], a[4:7], v[128:131], v[4:7]
ds_read_b64_tr_b16 a[38:39], v201 offset:12288
v_mfma_f32_16x16x32_bf16 v[36:39], a[4:7], v[132:135], v[36:39]
ds_read_b64_tr_b16 a[40:41], v202 offset:8192
v_mfma_f32_16x16x32_bf16 v[8:11], a[8:11], v[128:131], v[8:11]
ds_read_b64_tr_b16 a[42:43], v202 offset:12288
ds_read_b64_tr_b16 a[44:45], v203 offset:8192
buffer_load_dwordx4 v211, s[8:11], s38 offen offset:3072 lds
v_mfma_f32_16x16x32_bf16 v[40:43], a[8:11], v[132:135], v[40:43]
ds_read_b64_tr_b16 a[46:47], v203 offset:12288
v_mfma_f32_16x16x32_bf16 v[12:15], a[12:15], v[128:131], v[12:15]
ds_read_b64_tr_b16 a[48:49], v204 offset:8192
v_mfma_f32_16x16x32_bf16 v[44:47], a[12:15], v[132:135], v[44:47]
ds_read_b64_tr_b16 a[50:51], v204 offset:12288
buffer_load_dwordx4 a[64:67], v212, s[68:71], s40 offen offset:0 sc1
v_mfma_f32_16x16x32_bf16 v[16:19], a[16:19], v[128:131], v[16:19]
ds_read_b64_tr_b16 a[52:53], v205 offset:8192
ds_read_b64_tr_b16 a[54:55], v205 offset:12288
v_mfma_f32_16x16x32_bf16 v[48:51], a[16:19], v[132:135], v[48:51]
ds_read_b64_tr_b16 a[56:57], v206 offset:8192
buffer_load_dwordx4 a[68:71], v212, s[72:75], s40 offen offset:0 sc1
v_mfma_f32_16x16x32_bf16 v[20:23], a[20:23], v[128:131], v[20:23]
ds_read_b64_tr_b16 a[58:59], v206 offset:12288
v_mfma_f32_16x16x32_bf16 v[52:55], a[20:23], v[132:135], v[52:55]
ds_read_b64_tr_b16 a[60:61], v207 offset:8192
v_mfma_f32_16x16x32_bf16 v[24:27], a[24:27], v[128:131], v[24:27]
ds_read_b64_tr_b16 a[62:63], v207 offset:12288
buffer_load_dwordx4 a[72:75], v212, s[68:71], s40 offen offset:1024 sc1
v_mfma_f32_16x16x32_bf16 v[56:59], a[24:27], v[132:135], v[56:59]
v_mfma_f32_16x16x32_bf16 v[28:31], a[28:31], v[128:131], v[28:31]
buffer_load_dwordx4 a[76:79], v212, s[72:75], s40 offen offset:1024 sc1
v_mfma_f32_16x16x32_bf16 v[60:63], a[28:31], v[132:135], v[60:63]
s_waitcnt vmcnt(34) lgkmcnt(0)
v_mfma_f32_16x16x32_bf16 v[0:3], a[32:35], v[136:139], v[0:3]
ds_read_b64_tr_b16 a[0:1], v200 offset:16384
ds_read_b64_tr_b16 a[2:3], v200 offset:20480
s_add_u32 m0, s98, 36864
v_mfma_f32_16x16x32_bf16 v[32:35], a[32:35], v[140:143], v[32:35]
ds_read_b64_tr_b16 a[4:5], v201 offset:16384
buffer_load_dwordx4 v208, s[8:11], s59 offen offset:0 lds
v_mfma_f32_16x16x32_bf16 v[4:7], a[36:39], v[136:139], v[4:7]
ds_read_b64_tr_b16 a[6:7], v201 offset:20480
v_mfma_f32_16x16x32_bf16 v[36:39], a[36:39], v[140:143], v[36:39]
ds_read_b64_tr_b16 a[8:9], v202 offset:16384
v_mfma_f32_16x16x32_bf16 v[8:11], a[40:43], v[136:139], v[8:11]
ds_read_b64_tr_b16 a[10:11], v202 offset:20480
ds_read_b64_tr_b16 a[12:13], v203 offset:16384
buffer_load_dwordx4 v209, s[8:11], s59 offen offset:1024 lds
v_mfma_f32_16x16x32_bf16 v[40:43], a[40:43], v[140:143], v[40:43]
ds_read_b64_tr_b16 a[14:15], v203 offset:20480
v_mfma_f32_16x16x32_bf16 v[12:15], a[44:47], v[136:139], v[12:15]
ds_read_b64_tr_b16 a[16:17], v204 offset:16384
v_mfma_f32_16x16x32_bf16 v[44:47], a[44:47], v[140:143], v[44:47]
ds_read_b64_tr_b16 a[18:19], v204 offset:20480
buffer_load_dwordx4 a[80:83], v212, s[68:71], s40 offen offset:2048 sc1
v_mfma_f32_16x16x32_bf16 v[16:19], a[48:51], v[136:139], v[16:19]
ds_read_b64_tr_b16 a[20:21], v205 offset:16384
ds_read_b64_tr_b16 a[22:23], v205 offset:20480
v_mfma_f32_16x16x32_bf16 v[48:51], a[48:51], v[140:143], v[48:51]
ds_read_b64_tr_b16 a[24:25], v206 offset:16384
buffer_load_dwordx4 a[84:87], v212, s[72:75], s40 offen offset:2048 sc1
v_mfma_f32_16x16x32_bf16 v[20:23], a[52:55], v[136:139], v[20:23]
ds_read_b64_tr_b16 a[26:27], v206 offset:20480
v_mfma_f32_16x16x32_bf16 v[52:55], a[52:55], v[140:143], v[52:55]
ds_read_b64_tr_b16 a[28:29], v207 offset:16384
v_mfma_f32_16x16x32_bf16 v[24:27], a[56:59], v[136:139], v[24:27]
ds_read_b64_tr_b16 a[30:31], v207 offset:20480
buffer_load_dwordx4 a[88:91], v212, s[68:71], s40 offen offset:3072 sc1
v_mfma_f32_16x16x32_bf16 v[56:59], a[56:59], v[140:143], v[56:59]
v_mfma_f32_16x16x32_bf16 v[28:31], a[60:63], v[136:139], v[28:31]
buffer_load_dwordx4 a[92:95], v212, s[72:75], s40 offen offset:3072 sc1
v_mfma_f32_16x16x32_bf16 v[60:63], a[60:63], v[140:143], v[60:63]
s_add_u32 s40, s40, 0x80000
s_waitcnt vmcnt(36) lgkmcnt(0)
v_mfma_f32_16x16x32_bf16 v[0:3], a[0:3], v[144:147], v[0:3]
ds_read_b64_tr_b16 a[32:33], v200 offset:24576
ds_read_b64_tr_b16 a[34:35], v200 offset:28672
v_mfma_f32_16x16x32_bf16 v[32:35], a[0:3], v[148:151], v[32:35]
ds_read_b64_tr_b16 a[36:37], v201 offset:24576
buffer_load_dwordx4 v210, s[8:11], s59 offen offset:2048 lds
v_mfma_f32_16x16x32_bf16 v[4:7], a[4:7], v[144:147], v[4:7]
ds_read_b64_tr_b16 a[38:39], v201 offset:28672
v_mfma_f32_16x16x32_bf16 v[36:39], a[4:7], v[148:151], v[36:39]
ds_read_b64_tr_b16 a[40:41], v202 offset:24576
v_mfma_f32_16x16x32_bf16 v[8:11], a[8:11], v[144:147], v[8:11]
ds_read_b64_tr_b16 a[42:43], v202 offset:28672
ds_read_b64_tr_b16 a[44:45], v203 offset:24576
buffer_load_dwordx4 v211, s[8:11], s59 offen offset:3072 lds
v_mfma_f32_16x16x32_bf16 v[40:43], a[8:11], v[148:151], v[40:43]
ds_read_b64_tr_b16 a[46:47], v203 offset:28672
v_mfma_f32_16x16x32_bf16 v[12:15], a[12:15], v[144:147], v[12:15]
ds_read_b64_tr_b16 a[48:49], v204 offset:24576
v_mfma_f32_16x16x32_bf16 v[44:47], a[12:15], v[148:151], v[44:47]
ds_read_b64_tr_b16 a[50:51], v204 offset:28672
buffer_load_dwordx4 a[96:99], v212, s[68:71], s40 offen offset:0 sc1
v_mfma_f32_16x16x32_bf16 v[16:19], a[16:19], v[144:147], v[16:19]
ds_read_b64_tr_b16 a[52:53], v205 offset:24576
ds_read_b64_tr_b16 a[54:55], v205 offset:28672
v_mfma_f32_16x16x32_bf16 v[48:51], a[16:19], v[148:151], v[48:51]
ds_read_b64_tr_b16 a[56:57], v206 offset:24576
buffer_load_dwordx4 a[100:103], v212, s[72:75], s40 offen offset:0 sc1
v_mfma_f32_16x16x32_bf16 v[20:23], a[20:23], v[144:147], v[20:23]
ds_read_b64_tr_b16 a[58:59], v206 offset:28672
v_mfma_f32_16x16x32_bf16 v[52:55], a[20:23], v[148:151], v[52:55]
ds_read_b64_tr_b16 a[60:61], v207 offset:24576
v_mfma_f32_16x16x32_bf16 v[24:27], a[24:27], v[144:147], v[24:27]
ds_read_b64_tr_b16 a[62:63], v207 offset:28672
buffer_load_dwordx4 a[104:107], v212, s[68:71], s40 offen offset:1024 sc1
v_mfma_f32_16x16x32_bf16 v[56:59], a[24:27], v[148:151], v[56:59]
v_mfma_f32_16x16x32_bf16 v[28:31], a[28:31], v[144:147], v[28:31]
buffer_load_dwordx4 a[108:111], v212, s[72:75], s40 offen offset:1024 sc1
v_mfma_f32_16x16x32_bf16 v[60:63], a[28:31], v[148:151], v[60:63]
s_waitcnt vmcnt(28) lgkmcnt(0)
s_barrier
v_mfma_f32_16x16x32_bf16 v[0:3], a[32:35], v[152:155], v[0:3]
ds_read_b64_tr_b16 a[0:1], v200 offset:32768
ds_read_b64_tr_b16 a[2:3], v200 offset:36864
s_add_u32 s38, s38, 262144
s_add_u32 m0, s98, 65536
v_max3_u32 v233, v160, v161, v162
v_mfma_f32_16x16x32_bf16 v[32:35], a[32:35], v[156:159], v[32:35]
ds_read_b64_tr_b16 a[4:5], v201 offset:32768
buffer_load_dwordx4 v208, s[8:11], s38 offen offset:0 lds
v_max3_u32 v234, v168, v169, v170
v_mfma_f32_16x16x32_bf16 v[4:7], a[36:39], v[152:155], v[4:7]
ds_read_b64_tr_b16 a[6:7], v201 offset:36864
v_max3_u32 v235, v176, v177, v178
v_mfma_f32_16x16x32_bf16 v[36:39], a[36:39], v[156:159], v[36:39]
ds_read_b64_tr_b16 a[8:9], v202 offset:32768
v_max3_u32 v237, v184, v185, v186
v_mfma_f32_16x16x32_bf16 v[8:11], a[40:43], v[152:155], v[8:11]
ds_read_b64_tr_b16 a[10:11], v202 offset:36864
ds_read_b64_tr_b16 a[12:13], v203 offset:32768
buffer_load_dwordx4 v209, s[8:11], s38 offen offset:1024 lds
v_max3_u32 v233, v233, v163, v164
v_mfma_f32_16x16x32_bf16 v[40:43], a[40:43], v[156:159], v[40:43]
ds_read_b64_tr_b16 a[14:15], v203 offset:36864
v_max3_u32 v234, v234, v171, v172
v_mfma_f32_16x16x32_bf16 v[12:15], a[44:47], v[152:155], v[12:15]
ds_read_b64_tr_b16 a[16:17], v204 offset:32768
v_max3_u32 v235, v235, v179, v180
v_mfma_f32_16x16x32_bf16 v[44:47], a[44:47], v[156:159], v[44:47]
ds_read_b64_tr_b16 a[18:19], v204 offset:36864
buffer_load_dwordx4 a[112:115], v212, s[68:71], s40 offen offset:2048 sc1
v_max3_u32 v237, v237, v187, v188
v_mfma_f32_16x16x32_bf16 v[16:19], a[48:51], v[152:155], v[16:19]
ds_read_b64_tr_b16 a[20:21], v205 offset:32768
ds_read_b64_tr_b16 a[22:23], v205 offset:36864
v_max3_u32 v233, v233, v165, v166
v_mfma_f32_16x16x32_bf16 v[48:51], a[48:51], v[156:159], v[48:51]
ds_read_b64_tr_b16 a[24:25], v206 offset:32768
buffer_load_dwordx4 a[116:119], v212, s[72:75], s40 offen offset:2048 sc1
v_max3_u32 v234, v234, v173, v174
v_mfma_f32_16x16x32_bf16 v[20:23], a[52:55], v[152:155], v[20:23]
ds_read_b64_tr_b16 a[26:27], v206 offset:36864
v_max3_u32 v235, v235, v181, v182
v_mfma_f32_16x16x32_bf16 v[52:55], a[52:55], v[156:159], v[52:55]
ds_read_b64_tr_b16 a[28:29], v207 offset:32768
v_max3_u32 v237, v237, v189, v190
v_mfma_f32_16x16x32_bf16 v[24:27], a[56:59], v[152:155], v[24:27]
ds_read_b64_tr_b16 a[30:31], v207 offset:36864
buffer_load_dwordx4 a[120:123], v212, s[68:71], s40 offen offset:3072 sc1
v_max3_u32 v233, v233, v167, v175
v_mfma_f32_16x16x32_bf16 v[56:59], a[56:59], v[156:159], v[56:59]
v_max3_u32 v235, v235, v183, v191
v_mfma_f32_16x16x32_bf16 v[28:31], a[60:63], v[152:155], v[28:31]
buffer_load_dwordx4 a[124:127], v212, s[72:75], s40 offen offset:3072 sc1
v_max3_u32 v233, v233, v234, v235
v_mfma_f32_16x16x32_bf16 v[60:63], a[60:63], v[156:159], v[60:63]
s_add_u32 s40, s40, 0x80000
v_max_u32 v233, v233, v237
L2_v3:
v_cmp_eq_u32 vcc, -1, v233
s_add_u32 s67, s67, 1
s_cbranch_vccz L2_v3_ok
s_cmp_gt_u32 s67, 0x80000
s_cbranch_scc1 L2_v3_ok
buffer_load_dwordx4 v[160:163], v212, s[68:71], s89 offen offset:0 sc1
buffer_load_dwordx4 v[164:167], v212, s[72:75], s89 offen offset:0 sc1
buffer_load_dwordx4 v[168:171], v212, s[68:71], s89 offen offset:1024 sc1
buffer_load_dwordx4 v[172:175], v212, s[72:75], s89 offen offset:1024 sc1
buffer_load_dwordx4 v[176:179], v212, s[68:71], s89 offen offset:2048 sc1
buffer_load_dwordx4 v[180:183], v212, s[72:75], s89 offen offset:2048 sc1
buffer_load_dwordx4 v[184:187], v212, s[68:71], s89 offen offset:3072 sc1
buffer_load_dwordx4 v[188:191], v212, s[72:75], s89 offen offset:3072 sc1
s_waitcnt vmcnt(0)
v_max3_u32 v233, v160, v161, v162
v_max3_u32 v234, v168, v169, v170
v_max3_u32 v235, v176, v177, v178
v_max3_u32 v237, v184, v185, v186
v_max3_u32 v233, v233, v163, v164
v_max3_u32 v234, v234, v171, v172
v_max3_u32 v235, v235, v179, v180
v_max3_u32 v237, v237, v187, v188
v_max3_u32 v233, v233, v165, v166
v_max3_u32 v234, v234, v173, v174
v_max3_u32 v235, v235, v181, v182
v_max3_u32 v237, v237, v189, v190
v_max3_u32 v233, v233, v167, v175
v_max3_u32 v235, v235, v183, v191
v_max3_u32 v233, v233, v234, v235
v_max_u32 v233, v233, v237
s_branch L2_v3
L2_v3_ok:
s_waitcnt vmcnt(24) lgkmcnt(0)
v_mfma_f32_16x16x32_bf16 v[0:3], a[0:3], v[160:163], v[0:3]
ds_read_b64_tr_b16 a[32:33], v200 offset:40960
ds_read_b64_tr_b16 a[34:35], v200 offset:45056
v_mfma_f32_16x16x32_bf16 v[32:35], a[0:3], v[164:167], v[32:35]
ds_read_b64_tr_b16 a[36:37], v201 offset:40960
s_add_u32 s59, s38, 32768
v_mfma_f32_16x16x32_bf16 v[4:7], a[4:7], v[160:163], v[4:7]
ds_read_b64_tr_b16 a[38:39], v201 offset:45056
buffer_load_dwordx4 v210, s[8:11], s38 offen offset:2048 lds
v_mfma_f32_16x16x32_bf16 v[36:39], a[4:7], v[164:167], v[36:39]
ds_read_b64_tr_b16 a[40:41], v202 offset:40960
v_mfma_f32_16x16x32_bf16 v[8:11], a[8:11], v[160:163], v[8:11]
ds_read_b64_tr_b16 a[42:43], v202 offset:45056
ds_read_b64_tr_b16 a[44:45], v203 offset:40960
v_mfma_f32_16x16x32_bf16 v[40:43], a[8:11], v[164:167], v[40:43]
ds_read_b64_tr_b16 a[46:47], v203 offset:45056
v_mfma_f32_16x16x32_bf16 v[12:15], a[12:15], v[160:163], v[12:15]
ds_read_b64_tr_b16 a[48:49], v204 offset:40960
buffer_load_dwordx4 v211, s[8:11], s38 offen offset:3072 lds
v_mfma_f32_16x16x32_bf16 v[44:47], a[12:15], v[164:167], v[44:47]
ds_read_b64_tr_b16 a[50:51], v204 offset:45056
v_mfma_f32_16x16x32_bf16 v[16:19], a[16:19], v[160:163], v[16:19]
ds_read_b64_tr_b16 a[52:53], v205 offset:40960
ds_read_b64_tr_b16 a[54:55], v205 offset:45056
v_mfma_f32_16x16x32_bf16 v[48:51], a[16:19], v[164:167], v[48:51]
ds_read_b64_tr_b16 a[56:57], v206 offset:40960
v_mfma_f32_16x16x32_bf16 v[20:23], a[20:23], v[160:163], v[20:23]
ds_read_b64_tr_b16 a[58:59], v206 offset:45056
buffer_load_dwordx4 a[128:131], v212, s[68:71], s40 offen offset:0 sc1
v_mfma_f32_16x16x32_bf16 v[52:55], a[20:23], v[164:167], v[52:55]
ds_read_b64_tr_b16 a[60:61], v207 offset:40960
v_mfma_f32_16x16x32_bf16 v[24:27], a[24:27], v[160:163], v[24:27]
ds_read_b64_tr_b16 a[62:63], v207 offset:45056
v_max_f32 v226, 0x2b800000, v226
v_max_f32 v227, 0x2b800000, v227
v_mfma_f32_16x16x32_bf16 v[56:59], a[24:27], v[164:167], v[56:59]
v_rcp_f32 v228, v226
v_rcp_f32 v229, v227
v_mfma_f32_16x16x32_bf16 v[28:31], a[28:31], v[160:163], v[28:31]
buffer_load_dwordx4 a[132:135], v212, s[72:75], s40 offen offset:0 sc1
v_mul_f32 v228, v228, v224
v_mul_f32 v229, v229, v225
v_mfma_f32_16x16x32_bf16 v[60:63], a[28:31], v[164:167], v[60:63]
s_waitcnt vmcnt(44) lgkmcnt(0)
v_mfma_f32_16x16x32_bf16 v[0:3], a[32:35], v[168:171], v[0:3]
ds_read_b64_tr_b16 a[0:1], v200 offset:49152
ds_read_b64_tr_b16 a[2:3], v200 offset:53248
v_and_b32 v128, 15, v254
v_mfma_f32_16x16x32_bf16 v[32:35], a[32:35], v[172:175], v[32:35]
ds_read_b64_tr_b16 a[4:5], v201 offset:49152
s_add_u32 m0, s98, 69632
v_lshrrev_b32 v129, 5, v254
v_mfma_f32_16x16x32_bf16 v[4:7], a[36:39], v[168:171], v[4:7]
ds_read_b64_tr_b16 a[6:7], v201 offset:53248
buffer_load_dwordx4 v208, s[8:11], s59 offen offset:0 lds
v_xor_b32 v129, v129, v128
v_mfma_f32_16x16x32_bf16 v[36:39], a[36:39], v[172:175], v[36:39]
ds_read_b64_tr_b16 a[8:9], v202 offset:49152
v_bfe_u32 v130, v254, 4, 1
v_mfma_f32_16x16x32_bf16 v[8:11], a[40:43], v[168:171], v[8:11]
ds_read_b64_tr_b16 a[10:11], v202 offset:53248
ds_read_b64_tr_b16 a[12:13], v203 offset:49152
v_lshlrev_b32 v130, 3, v130
v_mfma_f32_16x16x32_bf16 v[40:43], a[40:43], v[172:175], v[40:43]
ds_read_b64_tr_b16 a[14:15], v203 offset:53248
v_lshl_add_u32 v130, v128, 9, v130
v_mfma_f32_16x16x32_bf16 v[12:15], a[44:47], v[168:171], v[12:15]
ds_read_b64_tr_b16 a[16:17], v204 offset:49152
buffer_load_dwordx4 v209, s[8:11], s59 offen offset:1024 lds
v_add_u32 v130, s55, v130
v_mfma_f32_16x16x32_bf16 v[44:47], a[44:47], v[172:175], v[44:47]
ds_read_b64_tr_b16 a[18:19], v204 offset:53248
v_xor_b32 v131, 0, v129
v_mfma_f32_16x16x32_bf16 v[16:19], a[48:51], v[168:171], v[16:19]
ds_read_b64_tr_b16 a[20:21], v205 offset:49152
ds_read_b64_tr_b16 a[22:23], v205 offset:53248
v_lshl_add_u32 v132, v131, 4, v130
v_mfma_f32_16x16x32_bf16 v[48:51], a[48:51], v[172:175], v[48:51]
ds_read_b64_tr_b16 a[24:25], v206 offset:49152
v_xor_b32 v131, 2, v129
v_mfma_f32_16x16x32_bf16 v[20:23], a[52:55], v[168:171], v[20:23]
ds_read_b64_tr_b16 a[26:27], v206 offset:53248
buffer_load_dwordx4 a[136:139], v212, s[68:71], s40 offen offset:1024 sc1
v_lshl_add_u32 v133, v131, 4, v130
v_mfma_f32_16x16x32_bf16 v[52:55], a[52:55], v[172:175], v[52:55]
ds_read_b64_tr_b16 a[28:29], v207 offset:49152
v_xor_b32 v131, 4, v129
v_mfma_f32_16x16x32_bf16 v[24:27], a[56:59], v[168:171], v[24:27]
ds_read_b64_tr_b16 a[30:31], v207 offset:53248
v_lshl_add_u32 v134, v131, 4, v130
v_mfma_f32_16x16x32_bf16 v[56:59], a[56:59], v[172:175], v[56:59]
v_xor_b32 v131, 6, v129
v_mfma_f32_16x16x32_bf16 v[28:31], a[60:63], v[168:171], v[28:31]
buffer_load_dwordx4 a[140:143], v212, s[72:75], s40 offen offset:1024 sc1
v_lshl_add_u32 v135, v131, 4, v130
v_mfma_f32_16x16x32_bf16 v[60:63], a[60:63], v[172:175], v[60:63]
s_waitcnt vmcnt(44) lgkmcnt(0)
v_mfma_f32_16x16x32_bf16 v[0:3], a[0:3], v[176:179], v[0:3]
ds_read_b64_tr_b16 a[32:33], v200 offset:57344
ds_read_b64_tr_b16 a[34:35], v200 offset:61440
v_xor_b32 v131, 8, v129
v_mfma_f32_16x16x32_bf16 v[32:35], a[0:3], v[180:183], v[32:35]
ds_read_b64_tr_b16 a[36:37], v201 offset:57344
v_lshl_add_u32 v136, v131, 4, v130
v_mfma_f32_16x16x32_bf16 v[4:7], a[4:7], v[176:179], v[4:7]
ds_read_b64_tr_b16 a[38:39], v201 offset:61440
buffer_load_dwordx4 v210, s[8:11], s59 offen offset:2048 lds
v_xor_b32 v131, 10, v129
v_mfma_f32_16x16x32_bf16 v[36:39], a[4:7], v[180:183], v[36:39]
ds_read_b64_tr_b16 a[40:41], v202 offset:57344
v_lshl_add_u32 v137, v131, 4, v130
v_mfma_f32_16x16x32_bf16 v[8:11], a[8:11], v[176:179], v[8:11]
ds_read_b64_tr_b16 a[42:43], v202 offset:61440
ds_read_b64_tr_b16 a[44:45], v203 offset:57344
v_xor_b32 v131, 12, v129
v_mfma_f32_16x16x32_bf16 v[40:43], a[8:11], v[180:183], v[40:43]
ds_read_b64_tr_b16 a[46:47], v203 offset:61440
v_lshl_add_u32 v138, v131, 4, v130
v_mfma_f32_16x16x32_bf16 v[12:15], a[12:15], v[176:179], v[12:15]
ds_read_b64_tr_b16 a[48:49], v204 offset:57344
buffer_load_dwordx4 v211, s[8:11], s59 offen offset:3072 lds
v_xor_b32 v131, 14, v129
v_mfma_f32_16x16x32_bf16 v[44:47], a[12:15], v[180:183], v[44:47]
ds_read_b64_tr_b16 a[50:51], v204 offset:61440
v_lshl_add_u32 v139, v131, 4, v130
v_mfma_f32_16x16x32_bf16 v[16:19], a[16:19], v[176:179], v[16:19]
ds_read_b64_tr_b16 a[52:53], v205 offset:57344
ds_read_b64_tr_b16 a[54:55], v205 offset:61440
v_lshrrev_b32 v131, 4, v254
v_mfma_f32_16x16x32_bf16 v[48:51], a[16:19], v[180:183], v[48:51]
ds_read_b64_tr_b16 a[56:57], v206 offset:57344
v_lshlrev_b32 v130, 8, v131
v_mfma_f32_16x16x32_bf16 v[20:23], a[20:23], v[176:179], v[20:23]
ds_read_b64_tr_b16 a[58:59], v206 offset:61440
buffer_load_dwordx4 a[144:147], v212, s[68:71], s40 offen offset:2048 sc1
v_add_u32 v130, s55, v130
v_mfma_f32_16x16x32_bf16 v[52:55], a[20:23], v[180:183], v[52:55]
ds_read_b64_tr_b16 a[60:61], v207 offset:57344
v_xor_b32 v140, 0, v129
v_mfma_f32_16x16x32_bf16 v[24:27], a[24:27], v[176:179], v[24:27]
ds_read_b64_tr_b16 a[62:63], v207 offset:61440
v_lshl_add_u32 v141, v140, 4, v130
v_mfma_f32_16x16x32_bf16 v[56:59], a[24:27], v[180:183], v[56:59]
v_xor_b32 v140, 2, v129
v_mfma_f32_16x16x32_bf16 v[28:31], a[28:31], v[176:179], v[28:31]
buffer_load_dwordx4 a[148:151], v212, s[72:75], s40 offen offset:2048 sc1
v_lshl_add_u32 v142, v140, 4, v130
v_mfma_f32_16x16x32_bf16 v[60:63], a[28:31], v[180:183], v[60:63]
s_waitcnt vmcnt(39) lgkmcnt(0)
s_barrier
v_mfma_f32_16x16x32_bf16 v[0:3], a[32:35], v[184:187], v[0:3]
ds_read_b64_tr_b16 a[0:1], v192 offset:0
ds_read_b64_tr_b16 a[2:3], v192 offset:4096
s_add_u32 s38, s38, 262144
v_xor_b32 v140, 4, v129
v_lshl_add_u32 v143, v140, 4, v130
v_mfma_f32_16x16x32_bf16 v[32:35], a[32:35], v[188:191], v[32:35]
ds_read_b64_tr_b16 a[4:5], v193 offset:0
s_add_u32 m0, s98, 98304
v_xor_b32 v140, 6, v129
v_mfma_f32_16x16x32_bf16 v[4:7], a[36:39], v[184:187], v[4:7]
ds_read_b64_tr_b16 a[6:7], v193 offset:4096
buffer_load_dwordx4 v208, s[8:11], s38 offen offset:0 lds
v_lshl_add_u32 v144, v140, 4, v130
v_mfma_f32_16x16x32_bf16 v[36:39], a[36:39], v[188:191], v[36:39]
ds_read_b64_tr_b16 a[8:9], v194 offset:0
v_xor_b32 v140, 8, v129
v_mfma_f32_16x16x32_bf16 v[8:11], a[40:43], v[184:187], v[8:11]
ds_read_b64_tr_b16 a[10:11], v194 offset:4096
ds_read_b64_tr_b16 a[12:13], v195 offset:0
v_lshl_add_u32 v145, v140, 4, v130
v_mfma_f32_16x16x32_bf16 v[40:43], a[40:43], v[188:191], v[40:43]
ds_read_b64_tr_b16 a[14:15], v195 offset:4096
v_xor_b32 v140, 10, v129
v_lshl_add_u32 v146, v140, 4, v130
v_mfma_f32_16x16x32_bf16 v[12:15], a[44:47], v[184:187], v[12:15]
ds_read_b64_tr_b16 a[16:17], v196 offset:0
buffer_load_dwordx4 v209, s[8:11], s38 offen offset:1024 lds
v_xor_b32 v140, 12, v129
v_mfma_f32_16x16x32_bf16 v[44:47], a[44:47], v[188:191], v[44:47]
ds_read_b64_tr_b16 a[18:19], v196 offset:4096
v_lshl_add_u32 v147, v140, 4, v130
v_mfma_f32_16x16x32_bf16 v[16:19], a[48:51], v[184:187], v[16:19]
ds_read_b64_tr_b16 a[20:21], v197 offset:0
ds_read_b64_tr_b16 a[22:23], v197 offset:4096
v_xor_b32 v140, 14, v129
v_mfma_f32_16x16x32_bf16 v[48:51], a[48:51], v[188:191], v[48:51]
ds_read_b64_tr_b16 a[24:25], v198 offset:0
v_lshl_add_u32 v148, v140, 4, v130
v_mfma_f32_16x16x32_bf16 v[20:23], a[52:55], v[184:187], v[20:23]
ds_read_b64_tr_b16 a[26:27], v198 offset:4096
buffer_load_dwordx4 a[152:155], v212, s[68:71], s40 offen offset:3072 sc1
v_lshlrev_b32 v222, 11, v131
v_lshl_add_u32 v222, v128, 4, v222
v_mfma_f32_16x16x32_bf16 v[52:55], a[52:55], v[188:191], v[52:55]
ds_read_b64_tr_b16 a[28:29], v199 offset:0
v_mov_b32 v240, v226
v_mfma_f32_16x16x32_bf16 v[24:27], a[56:59], v[184:187], v[24:27]
ds_read_b64_tr_b16 a[30:31], v199 offset:4096
v_mov_b32 v241, v226
v_mfma_f32_16x16x32_bf16 v[56:59], a[56:59], v[188:191], v[56:59]
v_mov_b32 v242, v227
v_mfma_f32_16x16x32_bf16 v[28:31], a[60:63], v[184:187], v[28:31]
buffer_load_dwordx4 a[156:159], v212, s[72:75], s40 offen offset:3072 sc1
v_mov_b32 v243, v227
v_mfma_f32_16x16x32_bf16 v[60:63], a[60:63], v[188:191], v[60:63]
s_add_u32 s40, s40, 0x80000
v_mul_f32 v0, v0, v228
v_mul_f32 v1, v1, v228
v_mul_f32 v2, v2, v228
v_mul_f32 v3, v3, v228
v_mul_f32 v4, v4, v228
v_mul_f32 v5, v5, v228
v_mul_f32 v6, v6, v228
v_mul_f32 v7, v7, v228
v_mul_f32 v8, v8, v228
v_mul_f32 v9, v9, v228
v_mul_f32 v10, v10, v228
v_mul_f32 v11, v11, v228
v_mul_f32 v12, v12, v228
v_mul_f32 v13, v13, v228
v_mul_f32 v14, v14, v228
v_mul_f32 v15, v15, v228
v_mul_f32 v16, v16, v228
v_mul_f32 v17, v17, v228
v_mul_f32 v18, v18, v228
v_mul_f32 v19, v19, v228
v_mul_f32 v20, v20, v228
v_mul_f32 v21, v21, v228
v_mul_f32 v22, v22, v228
v_mul_f32 v23, v23, v228
v_mul_f32 v24, v24, v228
v_mul_f32 v25, v25, v228
v_mul_f32 v26, v26, v228
v_mul_f32 v27, v27, v228
v_mul_f32 v28, v28, v228
v_mul_f32 v29, v29, v228
v_mul_f32 v30, v30, v228
v_mul_f32 v31, v31, v228
v_mul_f32 v32, v32, v229
v_mul_f32 v33, v33, v229
v_mul_f32 v34, v34, v229
v_mul_f32 v35, v35, v229
v_mul_f32 v36, v36, v229
v_mul_f32 v37, v37, v229
v_mul_f32 v38, v38, v229
v_mul_f32 v39, v39, v229
v_mul_f32 v40, v40, v229
v_mul_f32 v41, v41, v229
v_mul_f32 v42, v42, v229
v_mul_f32 v43, v43, v229
v_mul_f32 v44, v44, v229
v_mul_f32 v45, v45, v229
v_mul_f32 v46, v46, v229
v_mul_f32 v47, v47, v229
v_mul_f32 v48, v48, v229
v_mul_f32 v49, v49, v229
v_mul_f32 v50, v50, v229
v_mul_f32 v51, v51, v229
v_mul_f32 v52, v52, v229
v_mul_f32 v53, v53, v229
v_mul_f32 v54, v54, v229
v_mul_f32 v55, v55, v229
v_mul_f32 v56, v56, v229
v_mul_f32 v57, v57, v229
v_mul_f32 v58, v58, v229
v_mul_f32 v59, v59, v229
v_mul_f32 v60, v60, v229
v_mul_f32 v61, v61, v229
v_mul_f32 v62, v62, v229
v_mul_f32 v63, v63, v229
.p2align 6
L2_loop:
s_waitcnt vmcnt(36) lgkmcnt(0)
v_mfma_f32_16x16x32_bf16 v[0:3], a[0:3], a[64:67], v[0:3]
ds_read_b64_tr_b16 a[32:33], v192 offset:8192
ds_read_b64_tr_b16 a[34:35], v192 offset:12288
v_mfma_f32_16x16x32_bf16 v[32:35], a[0:3], a[68:71], v[32:35]
ds_read_b64_tr_b16 a[36:37], v193 offset:8192
s_add_u32 s59, s38, 32768
v_mfma_f32_16x16x32_bf16 v[4:7], a[4:7], a[64:67], v[4:7]
ds_read_b64_tr_b16 a[38:39], v193 offset:12288
buffer_load_dwordx4 v210, s[8:11], s38 offen offset:2048 lds
v_mfma_f32_16x16x32_bf16 v[36:39], a[4:7], a[68:71], v[36:39]
ds_read_b64_tr_b16 a[40:41], v194 offset:8192
v_mfma_f32_16x16x32_bf16 v[8:11], a[8:11], a[64:67], v[8:11]
ds_read_b64_tr_b16 a[42:43], v194 offset:12288
ds_read_b64_tr_b16 a[44:45], v195 offset:8192
v_mfma_f32_16x16x32_bf16 v[40:43], a[8:11], a[68:71], v[40:43]
ds_read_b64_tr_b16 a[46:47], v195 offset:12288
v_mfma_f32_16x16x32_bf16 v[12:15], a[12:15], a[64:67], v[12:15]
ds_read_b64_tr_b16 a[48:49], v196 offset:8192
buffer_load_dwordx4 v211, s[8:11], s38 offen offset:3072 lds
v_mfma_f32_16x16x32_bf16 v[44:47], a[12:15], a[68:71], v[44:47]
ds_read_b64_tr_b16 a[50:51], v196 offset:12288
v_mfma_f32_16x16x32_bf16 v[16:19], a[16:19], a[64:67], v[16:19]
ds_read_b64_tr_b16 a[52:53], v197 offset:8192
ds_read_b64_tr_b16 a[54:55], v197 offset:12288
v_mfma_f32_16x16x32_bf16 v[48:51], a[16:19], a[68:71], v[48:51]
ds_read_b64_tr_b16 a[56:57], v198 offset:8192
v_mfma_f32_16x16x32_bf16 v[20:23], a[20:23], a[64:67], v[20:23]
ds_read_b64_tr_b16 a[58:59], v198 offset:12288
buffer_load_dwordx4 a[160:163], v212, s[68:71], s40 offen offset:0 sc1
v_mfma_f32_16x16x32_bf16 v[52:55], a[20:23], a[68:71], v[52:55]
ds_read_b64_tr_b16 a[60:61], v199 offset:8192
v_mfma_f32_16x16x32_bf16 v[24:27], a[24:27], a[64:67], v[24:27]
ds_read_b64_tr_b16 a[62:63], v199 offset:12288
v_mfma_f32_16x16x32_bf16 v[56:59], a[24:27], a[68:71], v[56:59]
v_mfma_f32_16x16x32_bf16 v[28:31], a[28:31], a[64:67], v[28:31]
buffer_load_dwordx4 a[164:167], v212, s[72:75], s40 offen offset:0 sc1
v_mfma_f32_16x16x32_bf16 v[60:63], a[28:31], a[68:71], v[60:63]
s_waitcnt vmcnt(38) lgkmcnt(0)
v_mfma_f32_16x16x32_bf16 v[0:3], a[32:35], a[72:75], v[0:3]
ds_read_b64_tr_b16 a[0:1], v192 offset:16384
ds_read_b64_tr_b16 a[2:3], v192 offset:20480
v_mfma_f32_16x16x32_bf16 v[32:35], a[32:35], a[76:79], v[32:35]
ds_read_b64_tr_b16 a[4:5], v193 offset:16384
s_add_u32 m0, s98, 102400
v_mfma_f32_16x16x32_bf16 v[4:7], a[36:39], a[72:75], v[4:7]
ds_read_b64_tr_b16 a[6:7], v193 offset:20480
buffer_load_dwordx4 v208, s[8:11], s59 offen offset:0 lds
v_mfma_f32_16x16x32_bf16 v[36:39], a[36:39], a[76:79], v[36:39]
ds_read_b64_tr_b16 a[8:9], v194 offset:16384
v_mfma_f32_16x16x32_bf16 v[8:11], a[40:43], a[72:75], v[8:11]
ds_read_b64_tr_b16 a[10:11], v194 offset:20480
ds_read_b64_tr_b16 a[12:13], v195 offset:16384
v_mfma_f32_16x16x32_bf16 v[40:43], a[40:43], a[76:79], v[40:43]
ds_read_b64_tr_b16 a[14:15], v195 offset:20480
v_mfma_f32_16x16x32_bf16 v[12:15], a[44:47], a[72:75], v[12:15]
ds_read_b64_tr_b16 a[16:17], v196 offset:16384
buffer_load_dwordx4 v209, s[8:11], s59 offen offset:1024 lds
v_mfma_f32_16x16x32_bf16 v[44:47], a[44:47], a[76:79], v[44:47]
ds_read_b64_tr_b16 a[18:19], v196 offset:20480
v_mfma_f32_16x16x32_bf16 v[16:19], a[48:51], a[72:75], v[16:19]
ds_read_b64_tr_b16 a[20:21], v197 offset:16384
ds_read_b64_tr_b16 a[22:23], v197 offset:20480
v_mfma_f32_16x16x32_bf16 v[48:51], a[48:51], a[76:79], v[48:51]
ds_read_b64_tr_b16 a[24:25], v198 offset:16384
v_mfma_f32_16x16x32_bf16 v[20:23], a[52:55], a[72:75], v[20:23]
ds_read_b64_tr_b16 a[26:27], v198 offset:20480
buffer_load_dwordx4 a[168:171], v212, s[68:71], s40 offen offset:1024 sc1
v_mfma_f32_16x16x32_bf16 v[52:55], a[52:55], a[76:79], v[52:55]
ds_read_b64_tr_b16 a[28:29], v199 offset:16384
v_mfma_f32_16x16x32_bf16 v[24:27], a[56:59], a[72:75], v[24:27]
ds_read_b64_tr_b16 a[30:31], v199 offset:20480
v_mfma_f32_16x16x32_bf16 v[56:59], a[56:59], a[76:79], v[56:59]
v_mfma_f32_16x16x32_bf16 v[28:31], a[60:63], a[72:75], v[28:31]
buffer_load_dwordx4 a[172:175], v212, s[72:75], s40 offen offset:1024 sc1
v_mfma_f32_16x16x32_bf16 v[60:63], a[60:63], a[76:79], v[60:63]
s_waitcnt vmcnt(38) lgkmcnt(0)
v_mfma_f32_16x16x32_bf16 v[0:3], a[0:3], a[80:83], v[0:3]
ds_read_b64_tr_b16 a[32:33], v192 offset:24576
ds_read_b64_tr_b16 a[34:35], v192 offset:28672
v_mfma_f32_16x16x32_bf16 v[32:35], a[0:3], a[84:87], v[32:35]
ds_read_b64_tr_b16 a[36:37], v193 offset:24576
v_mfma_f32_16x16x32_bf16 v[4:7], a[4:7], a[80:83], v[4:7]
ds_read_b64_tr_b16 a[38:39], v193 offset:28672
buffer_load_dwordx4 v210, s[8:11], s59 offen offset:2048 lds
v_mfma_f32_16x16x32_bf16 v[36:39], a[4:7], a[84:87], v[36:39]
ds_read_b64_tr_b16 a[40:41], v194 offset:24576
v_mfma_f32_16x16x32_bf16 v[8:11], a[8:11], a[80:83], v[8:11]
ds_read_b64_tr_b16 a[42:43], v194 offset:28672
ds_read_b64_tr_b16 a[44:45], v195 offset:24576
v_mfma_f32_16x16x32_bf16 v[40:43], a[8:11], a[84:87], v[40:43]
ds_read_b64_tr_b16 a[46:47], v195 offset:28672
v_mfma_f32_16x16x32_bf16 v[12:15], a[12:15], a[80:83], v[12:15]
ds_read_b64_tr_b16 a[48:49], v196 offset:24576
buffer_load_dwordx4 v211, s[8:11], s59 offen offset:3072 lds
v_mfma_f32_16x16x32_bf16 v[44:47], a[12:15], a[84:87], v[44:47]
ds_read_b64_tr_b16 a[50:51], v196 offset:28672
v_mfma_f32_16x16x32_bf16 v[16:19], a[16:19], a[80:83], v[16:19]
ds_read_b64_tr_b16 a[52:53], v197 offset:24576
ds_read_b64_tr_b16 a[54:55], v197 offset:28672
v_mfma_f32_16x16x32_bf16 v[48:51], a[16:19], a[84:87], v[48:51]
ds_read_b64_tr_b16 a[56:57], v198 offset:24576
v_mfma_f32_16x16x32_bf16 v[20:23], a[20:23], a[80:83], v[20:23]
ds_read_b64_tr_b16 a[58:59], v198 offset:28672
buffer_load_dwordx4 a[176:179], v212, s[68:71], s40 offen offset:2048 sc1
v_mfma_f32_16x16x32_bf16 v[52:55], a[20:23], a[84:87], v[52:55]
ds_read_b64_tr_b16 a[60:61], v199 offset:24576
v_mfma_f32_16x16x32_bf16 v[24:27], a[24:27], a[80:83], v[24:27]
ds_read_b64_tr_b16 a[62:63], v199 offset:28672
v_mfma_f32_16x16x32_bf16 v[56:59], a[24:27], a[84:87], v[56:59]
v_mfma_f32_16x16x32_bf16 v[28:31], a[28:31], a[80:83], v[28:31]
buffer_load_dwordx4 a[180:183], v212, s[72:75], s40 offen offset:2048 sc1
v_mfma_f32_16x16x32_bf16 v[60:63], a[28:31], a[84:87], v[60:63]
s_waitcnt vmcnt(34) lgkmcnt(0)
s_barrier
v_mfma_f32_16x16x32_bf16 v[0:3], a[32:35], a[88:91], v[0:3]
ds_read_b64_tr_b16 a[0:1], v192 offset:32768
ds_read_b64_tr_b16 a[2:3], v192 offset:36864
s_add_u32 s38, s38, 262144
v_mfma_f32_16x16x32_bf16 v[32:35], a[32:35], a[92:95], v[32:35]
ds_read_b64_tr_b16 a[4:5], v193 offset:32768
s_add_u32 m0, s98, 0
v_mfma_f32_16x16x32_bf16 v[4:7], a[36:39], a[88:91], v[4:7]
ds_read_b64_tr_b16 a[6:7], v193 offset:36864
buffer_load_dwordx4 v208, s[8:11], s38 offen offset:0 lds
v_mfma_f32_16x16x32_bf16 v[36:39], a[36:39], a[92:95], v[36:39]
ds_read_b64_tr_b16 a[8:9], v194 offset:32768
v_mfma_f32_16x16x32_bf16 v[8:11], a[40:43], a[88:91], v[8:11]
ds_read_b64_tr_b16 a[10:11], v194 offset:36864
ds_read_b64_tr_b16 a[12:13], v195 offset:32768
v_mfma_f32_16x16x32_bf16 v[40:43], a[40:43], a[92:95], v[40:43]
ds_read_b64_tr_b16 a[14:15], v195 offset:36864
v_mfma_f32_16x16x32_bf16 v[12:15], a[44:47], a[88:91], v[12:15]
ds_read_b64_tr_b16 a[16:17], v196 offset:32768
buffer_load_dwordx4 v209, s[8:11], s38 offen offset:1024 lds
v_mfma_f32_16x16x32_bf16 v[44:47], a[44:47], a[92:95], v[44:47]
ds_read_b64_tr_b16 a[18:19], v196 offset:36864
v_mfma_f32_16x16x32_bf16 v[16:19], a[48:51], a[88:91], v[16:19]
ds_read_b64_tr_b16 a[20:21], v197 offset:32768
ds_read_b64_tr_b16 a[22:23], v197 offset:36864
v_mfma_f32_16x16x32_bf16 v[48:51], a[48:51], a[92:95], v[48:51]
ds_read_b64_tr_b16 a[24:25], v198 offset:32768
v_mfma_f32_16x16x32_bf16 v[20:23], a[52:55], a[88:91], v[20:23]
ds_read_b64_tr_b16 a[26:27], v198 offset:36864
buffer_load_dwordx4 a[184:187], v212, s[68:71], s40 offen offset:3072 sc1
v_mfma_f32_16x16x32_bf16 v[52:55], a[52:55], a[92:95], v[52:55]
ds_read_b64_tr_b16 a[28:29], v199 offset:32768
v_mfma_f32_16x16x32_bf16 v[24:27], a[56:59], a[88:91], v[24:27]
ds_read_b64_tr_b16 a[30:31], v199 offset:36864
v_mfma_f32_16x16x32_bf16 v[56:59], a[56:59], a[92:95], v[56:59]
v_mfma_f32_16x16x32_bf16 v[28:31], a[60:63], a[88:91], v[28:31]
buffer_load_dwordx4 a[188:191], v212, s[72:75], s40 offen offset:3072 sc1
v_mfma_f32_16x16x32_bf16 v[60:63], a[60:63], a[92:95], v[60:63]
s_add_u32 s40, s40, 0x80000
s_cmp_eq_u32 s46, s50
s_cbranch_scc0 L2_e1_ret
buffer_load_dword v221, v232, s[12:15], s62 offen sc1
L2_e1_ret:
s_add_u32 s46, s46, 1
s_cmp_ge_u32 s46, s34
s_cbranch_scc1 L2_done
s_waitcnt vmcnt(36) lgkmcnt(0)
v_mfma_f32_16x16x32_bf16 v[0:3], a[0:3], a[96:99], v[0:3]
ds_read_b64_tr_b16 a[32:33], v192 offset:40960
ds_read_b64_tr_b16 a[34:35], v192 offset:45056
v_mfma_f32_16x16x32_bf16 v[32:35], a[0:3], a[100:103], v[32:35]
ds_read_b64_tr_b16 a[36:37], v193 offset:40960
s_add_u32 s59, s38, 32768
v_mfma_f32_16x16x32_bf16 v[4:7], a[4:7], a[96:99], v[4:7]
ds_read_b64_tr_b16 a[38:39], v193 offset:45056
buffer_load_dwordx4 v210, s[8:11], s38 offen offset:2048 lds
v_mfma_f32_16x16x32_bf16 v[36:39], a[4:7], a[100:103], v[36:39]
ds_read_b64_tr_b16 a[40:41], v194 offset:40960
v_mfma_f32_16x16x32_bf16 v[8:11], a[8:11], a[96:99], v[8:11]
ds_read_b64_tr_b16 a[42:43], v194 offset:45056
ds_read_b64_tr_b16 a[44:45], v195 offset:40960
v_mfma_f32_16x16x32_bf16 v[40:43], a[8:11], a[100:103], v[40:43]
ds_read_b64_tr_b16 a[46:47], v195 offset:45056
v_mfma_f32_16x16x32_bf16 v[12:15], a[12:15], a[96:99], v[12:15]
ds_read_b64_tr_b16 a[48:49], v196 offset:40960
buffer_load_dwordx4 v211, s[8:11], s38 offen offset:3072 lds
v_mfma_f32_16x16x32_bf16 v[44:47], a[12:15], a[100:103], v[44:47]
ds_read_b64_tr_b16 a[50:51], v196 offset:45056
v_mfma_f32_16x16x32_bf16 v[16:19], a[16:19], a[96:99], v[16:19]
ds_read_b64_tr_b16 a[52:53], v197 offset:40960
ds_read_b64_tr_b16 a[54:55], v197 offset:45056
v_mfma_f32_16x16x32_bf16 v[48:51], a[16:19], a[100:103], v[48:51]
ds_read_b64_tr_b16 a[56:57], v198 offset:40960
v_mfma_f32_16x16x32_bf16 v[20:23], a[20:23], a[96:99], v[20:23]
ds_read_b64_tr_b16 a[58:59], v198 offset:45056
buffer_load_dwordx4 a[64:67], v212, s[68:71], s40 offen offset:0 sc1
v_mfma_f32_16x16x32_bf16 v[52:55], a[20:23], a[100:103], v[52:55]
ds_read_b64_tr_b16 a[60:61], v199 offset:40960
v_mfma_f32_16x16x32_bf16 v[24:27], a[24:27], a[96:99], v[24:27]
ds_read_b64_tr_b16 a[62:63], v199 offset:45056
v_mfma_f32_16x16x32_bf16 v[56:59], a[24:27], a[100:103], v[56:59]
v_mfma_f32_16x16x32_bf16 v[28:31], a[28:31], a[96:99], v[28:31]
buffer_load_dwordx4 a[68:71], v212, s[72:75], s40 offen offset:0 sc1
v_mfma_f32_16x16x32_bf16 v[60:63], a[28:31], a[100:103], v[60:63]
s_waitcnt vmcnt(38) lgkmcnt(0)
v_mfma_f32_16x16x32_bf16 v[0:3], a[32:35], a[104:107], v[0:3]
ds_read_b64_tr_b16 a[0:1], v192 offset:49152
ds_read_b64_tr_b16 a[2:3], v192 offset:53248
v_mfma_f32_16x16x32_bf16 v[32:35], a[32:35], a[108:111], v[32:35]
ds_read_b64_tr_b16 a[4:5], v193 offset:49152
s_add_u32 m0, s98, 4096
v_mfma_f32_16x16x32_bf16 v[4:7], a[36:39], a[104:107], v[4:7]
ds_read_b64_tr_b16 a[6:7], v193 offset:53248
buffer_load_dwordx4 v208, s[8:11], s59 offen offset:0 lds
v_mfma_f32_16x16x32_bf16 v[36:39], a[36:39], a[108:111], v[36:39]
ds_read_b64_tr_b16 a[8:9], v194 offset:49152
v_mfma_f32_16x16x32_bf16 v[8:11], a[40:43], a[104:107], v[8:11]
ds_read_b64_tr_b16 a[10:11], v194 offset:53248
ds_read_b64_tr_b16 a[12:13], v195 offset:49152
v_mfma_f32_16x16x32_bf16 v[40:43], a[40:43], a[108:111], v[40:43]
ds_read_b64_tr_b16 a[14:15], v195 offset:53248
v_mfma_f32_16x16x32_bf16 v[12:15], a[44:47], a[104:107], v[12:15]
ds_read_b64_tr_b16 a[16:17], v196 offset:49152
buffer_load_dwordx4 v209, s[8:11], s59 offen offset:1024 lds
v_mfma_f32_16x16x32_bf16 v[44:47], a[44:47], a[108:111], v[44:47]
ds_read_b64_tr_b16 a[18:19], v196 offset:53248
v_mfma_f32_16x16x32_bf16 v[16:19], a[48:51], a[104:107], v[16:19]
ds_read_b64_tr_b16 a[20:21], v197 offset:49152
ds_read_b64_tr_b16 a[22:23], v197 offset:53248
v_mfma_f32_16x16x32_bf16 v[48:51], a[48:51], a[108:111], v[48:51]
ds_read_b64_tr_b16 a[24:25], v198 offset:49152
v_mfma_f32_16x16x32_bf16 v[20:23], a[52:55], a[104:107], v[20:23]
ds_read_b64_tr_b16 a[26:27], v198 offset:53248
buffer_load_dwordx4 a[72:75], v212, s[68:71], s40 offen offset:1024 sc1
v_mfma_f32_16x16x32_bf16 v[52:55], a[52:55], a[108:111], v[52:55]
ds_read_b64_tr_b16 a[28:29], v199 offset:49152
v_mfma_f32_16x16x32_bf16 v[24:27], a[56:59], a[104:107], v[24:27]
ds_read_b64_tr_b16 a[30:31], v199 offset:53248
v_mfma_f32_16x16x32_bf16 v[56:59], a[56:59], a[108:111], v[56:59]
v_mfma_f32_16x16x32_bf16 v[28:31], a[60:63], a[104:107], v[28:31]
buffer_load_dwordx4 a[76:79], v212, s[72:75], s40 offen offset:1024 sc1
v_mfma_f32_16x16x32_bf16 v[60:63], a[60:63], a[108:111], v[60:63]
s_waitcnt vmcnt(38) lgkmcnt(0)
v_mfma_f32_16x16x32_bf16 v[0:3], a[0:3], a[112:115], v[0:3]
ds_read_b64_tr_b16 a[32:33], v192 offset:57344
ds_read_b64_tr_b16 a[34:35], v192 offset:61440
v_mfma_f32_16x16x32_bf16 v[32:35], a[0:3], a[116:119], v[32:35]
ds_read_b64_tr_b16 a[36:37], v193 offset:57344
v_mfma_f32_16x16x32_bf16 v[4:7], a[4:7], a[112:115], v[4:7]
ds_read_b64_tr_b16 a[38:39], v193 offset:61440
buffer_load_dwordx4 v210, s[8:11], s59 offen offset:2048 lds
v_mfma_f32_16x16x32_bf16 v[36:39], a[4:7], a[116:119], v[36:39]
ds_read_b64_tr_b16 a[40:41], v194 offset:57344
v_mfma_f32_16x16x32_bf16 v[8:11], a[8:11], a[112:115], v[8:11]
ds_read_b64_tr_b16 a[42:43], v194 offset:61440
ds_read_b64_tr_b16 a[44:45], v195 offset:57344
v_mfma_f32_16x16x32_bf16 v[40:43], a[8:11], a[116:119], v[40:43]
ds_read_b64_tr_b16 a[46:47], v195 offset:61440
v_mfma_f32_16x16x32_bf16 v[12:15], a[12:15], a[112:115], v[12:15]
ds_read_b64_tr_b16 a[48:49], v196 offset:57344
buffer_load_dwordx4 v211, s[8:11], s59 offen offset:3072 lds
v_mfma_f32_16x16x32_bf16 v[44:47], a[12:15], a[116:119], v[44:47]
ds_read_b64_tr_b16 a[50:51], v196 offset:61440
v_mfma_f32_16x16x32_bf16 v[16:19], a[16:19], a[112:115], v[16:19]
ds_read_b64_tr_b16 a[52:53], v197 offset:57344
ds_read_b64_tr_b16 a[54:55], v197 offset:61440
v_mfma_f32_16x16x32_bf16 v[48:51], a[16:19], a[116:119], v[48:51]
ds_read_b64_tr_b16 a[56:57], v198 offset:57344
v_mfma_f32_16x16x32_bf16 v[20:23], a[20:23], a[112:115], v[20:23]
ds_read_b64_tr_b16 a[58:59], v198 offset:61440
buffer_load_dwordx4 a[80:83], v212, s[68:71], s40 offen offset:2048 sc1
v_mfma_f32_16x16x32_bf16 v[52:55], a[20:23], a[116:119], v[52:55]
ds_read_b64_tr_b16 a[60:61], v199 offset:57344
v_mfma_f32_16x16x32_bf16 v[24:27], a[24:27], a[112:115], v[24:27]
ds_read_b64_tr_b16 a[62:63], v199 offset:61440
v_mfma_f32_16x16x32_bf16 v[56:59], a[24:27], a[116:119], v[56:59]
v_mfma_f32_16x16x32_bf16 v[28:31], a[28:31], a[112:115], v[28:31]
buffer_load_dwordx4 a[84:87], v212, s[72:75], s40 offen offset:2048 sc1
v_mfma_f32_16x16x32_bf16 v[60:63], a[28:31], a[116:119], v[60:63]
s_waitcnt vmcnt(34) lgkmcnt(0)
s_barrier
v_mfma_f32_16x16x32_bf16 v[0:3], a[32:35], a[120:123], v[0:3]
ds_read_b64_tr_b16 a[0:1], v200 offset:0
ds_read_b64_tr_b16 a[2:3], v200 offset:4096
s_add_u32 s38, s38, 262144
v_mfma_f32_16x16x32_bf16 v[32:35], a[32:35], a[124:127], v[32:35]
ds_read_b64_tr_b16 a[4:5], v201 offset:0
s_add_u32 m0, s98, 32768
v_mfma_f32_16x16x32_bf16 v[4:7], a[36:39], a[120:123], v[4:7]
ds_read_b64_tr_b16 a[6:7], v201 offset:4096
buffer_load_dwordx4 v208, s[8:11], s38 offen offset:0 lds
v_mfma_f32_16x16x32_bf16 v[36:39], a[36:39], a[124:127], v[36:39]
ds_read_b64_tr_b16 a[8:9], v202 offset:0
v_mfma_f32_16x16x32_bf16 v[8:11], a[40:43], a[120:123], v[8:11]
ds_read_b64_tr_b16 a[10:11], v202 offset:4096
ds_read_b64_tr_b16 a[12:13], v203 offset:0
v_mfma_f32_16x16x32_bf16 v[40:43], a[40:43], a[124:127], v[40:43]
ds_read_b64_tr_b16 a[14:15], v203 offset:4096
v_mfma_f32_16x16x32_bf16 v[12:15], a[44:47], a[120:123], v[12:15]
ds_read_b64_tr_b16 a[16:17], v204 offset:0
buffer_load_dwordx4 v209, s[8:11], s38 offen offset:1024 lds
v_mfma_f32_16x16x32_bf16 v[44:47], a[44:47], a[124:127], v[44:47]
ds_read_b64_tr_b16 a[18:19], v204 offset:4096
v_mfma_f32_16x16x32_bf16 v[16:19], a[48:51], a[120:123], v[16:19]
ds_read_b64_tr_b16 a[20:21], v205 offset:0
ds_read_b64_tr_b16 a[22:23], v205 offset:4096
v_mfma_f32_16x16x32_bf16 v[48:51], a[48:51], a[124:127], v[48:51]
ds_read_b64_tr_b16 a[24:25], v206 offset:0
v_mfma_f32_16x16x32_bf16 v[20:23], a[52:55], a[120:123], v[20:23]
ds_read_b64_tr_b16 a[26:27], v206 offset:4096
buffer_load_dwordx4 a[88:91], v212, s[68:71], s40 offen offset:3072 sc1
v_mfma_f32_16x16x32_bf16 v[52:55], a[52:55], a[124:127], v[52:55]
ds_read_b64_tr_b16 a[28:29], v207 offset:0
v_mfma_f32_16x16x32_bf16 v[24:27], a[56:59], a[120:123], v[24:27]
ds_read_b64_tr_b16 a[30:31], v207 offset:4096
v_mfma_f32_16x16x32_bf16 v[56:59], a[56:59], a[124:127], v[56:59]
v_mfma_f32_16x16x32_bf16 v[28:31], a[60:63], a[120:123], v[28:31]
buffer_load_dwordx4 a[92:95], v212, s[72:75], s40 offen offset:3072 sc1
v_mfma_f32_16x16x32_bf16 v[60:63], a[60:63], a[124:127], v[60:63]
s_add_u32 s40, s40, 0x80000
s_sub_u32 s51, s46, 1
s_cmp_eq_u32 s51, s50
s_cbranch_scc1 L2_e2
L2_e2_ret:
s_add_u32 s46, s46, 1
s_cmp_ge_u32 s46, s34
s_cbranch_scc1 L2_done
s_waitcnt vmcnt(36) lgkmcnt(0)
v_mfma_f32_16x16x32_bf16 v[0:3], a[0:3], a[128:131], v[0:3]
ds_read_b64_tr_b16 a[32:33], v200 offset:8192
ds_read_b64_tr_b16 a[34:35], v200 offset:12288
v_mfma_f32_16x16x32_bf16 v[32:35], a[0:3], a[132:135], v[32:35]
ds_read_b64_tr_b16 a[36:37], v201 offset:8192
s_add_u32 s59, s38, 32768
v_mfma_f32_16x16x32_bf16 v[4:7], a[4:7], a[128:131], v[4:7]
ds_read_b64_tr_b16 a[38:39], v201 offset:12288
buffer_load_dwordx4 v210, s[8:11], s38 offen offset:2048 lds
v_mfma_f32_16x16x32_bf16 v[36:39], a[4:7], a[132:135], v[36:39]
ds_read_b64_tr_b16 a[40:41], v202 offset:8192
v_mfma_f32_16x16x32_bf16 v[8:11], a[8:11], a[128:131], v[8:11]
ds_read_b64_tr_b16 a[42:43], v202 offset:12288
ds_read_b64_tr_b16 a[44:45], v203 offset:8192
v_mfma_f32_16x16x32_bf16 v[40:43], a[8:11], a[132:135], v[40:43]
ds_read_b64_tr_b16 a[46:47], v203 offset:12288
v_mfma_f32_16x16x32_bf16 v[12:15], a[12:15], a[128:131], v[12:15]
ds_read_b64_tr_b16 a[48:49], v204 offset:8192
buffer_load_dwordx4 v211, s[8:11], s38 offen offset:3072 lds
v_mfma_f32_16x16x32_bf16 v[44:47], a[12:15], a[132:135], v[44:47]
ds_read_b64_tr_b16 a[50:51], v204 offset:12288
v_mfma_f32_16x16x32_bf16 v[16:19], a[16:19], a[128:131], v[16:19]
ds_read_b64_tr_b16 a[52:53], v205 offset:8192
ds_read_b64_tr_b16 a[54:55], v205 offset:12288
v_mfma_f32_16x16x32_bf16 v[48:51], a[16:19], a[132:135], v[48:51]
ds_read_b64_tr_b16 a[56:57], v206 offset:8192
v_mfma_f32_16x16x32_bf16 v[20:23], a[20:23], a[128:131], v[20:23]
ds_read_b64_tr_b16 a[58:59], v206 offset:12288
buffer_load_dwordx4 a[96:99], v212, s[68:71], s40 offen offset:0 sc1
v_mfma_f32_16x16x32_bf16 v[52:55], a[20:23], a[132:135], v[52:55]
ds_read_b64_tr_b16 a[60:61], v207 offset:8192
v_mfma_f32_16x16x32_bf16 v[24:27], a[24:27], a[128:131], v[24:27]
ds_read_b64_tr_b16 a[62:63], v207 offset:12288
v_mfma_f32_16x16x32_bf16 v[56:59], a[24:27], a[132:135], v[56:59]
v_mfma_f32_16x16x32_bf16 v[28:31], a[28:31], a[128:131], v[28:31]
buffer_load_dwordx4 a[100:103], v212, s[72:75], s40 offen offset:0 sc1
v_mfma_f32_16x16x32_bf16 v[60:63], a[28:31], a[132:135], v[60:63]
s_waitcnt vmcnt(38) lgkmcnt(0)
v_mfma_f32_16x16x32_bf16 v[0:3], a[32:35], a[136:139], v[0:3]
ds_read_b64_tr_b16 a[0:1], v200 offset:16384
ds_read_b64_tr_b16 a[2:3], v200 offset:20480
v_mfma_f32_16x16x32_bf16 v[32:35], a[32:35], a[140:143], v[32:35]
ds_read_b64_tr_b16 a[4:5], v201 offset:16384
s_add_u32 m0, s98, 36864
v_mfma_f32_16x16x32_bf16 v[4:7], a[36:39], a[136:139], v[4:7]
ds_read_b64_tr_b16 a[6:7], v201 offset:20480
buffer_load_dwordx4 v208, s[8:11], s59 offen offset:0 lds
v_mfma_f32_16x16x32_bf16 v[36:39], a[36:39], a[140:143], v[36:39]
ds_read_b64_tr_b16 a[8:9], v202 offset:16384
v_mfma_f32_16x16x32_bf16 v[8:11], a[40:43], a[136:139], v[8:11]
ds_read_b64_tr_b16 a[10:11], v202 offset:20480
ds_read_b64_tr_b16 a[12:13], v203 offset:16384
v_mfma_f32_16x16x32_bf16 v[40:43], a[40:43], a[140:143], v[40:43]
ds_read_b64_tr_b16 a[14:15], v203 offset:20480
v_mfma_f32_16x16x32_bf16 v[12:15], a[44:47], a[136:139], v[12:15]
ds_read_b64_tr_b16 a[16:17], v204 offset:16384
buffer_load_dwordx4 v209, s[8:11], s59 offen offset:1024 lds
v_mfma_f32_16x16x32_bf16 v[44:47], a[44:47], a[140:143], v[44:47]
ds_read_b64_tr_b16 a[18:19], v204 offset:20480
v_mfma_f32_16x16x32_bf16 v[16:19], a[48:51], a[136:139], v[16:19]
ds_read_b64_tr_b16 a[20:21], v205 offset:16384
ds_read_b64_tr_b16 a[22:23], v205 offset:20480
v_mfma_f32_16x16x32_bf16 v[48:51], a[48:51], a[140:143], v[48:51]
ds_read_b64_tr_b16 a[24:25], v206 offset:16384
v_mfma_f32_16x16x32_bf16 v[20:23], a[52:55], a[136:139], v[20:23]
ds_read_b64_tr_b16 a[26:27], v206 offset:20480
buffer_load_dwordx4 a[104:107], v212, s[68:71], s40 offen offset:1024 sc1
v_mfma_f32_16x16x32_bf16 v[52:55], a[52:55], a[140:143], v[52:55]
ds_read_b64_tr_b16 a[28:29], v207 offset:16384
v_mfma_f32_16x16x32_bf16 v[24:27], a[56:59], a[136:139], v[24:27]
ds_read_b64_tr_b16 a[30:31], v207 offset:20480
v_mfma_f32_16x16x32_bf16 v[56:59], a[56:59], a[140:143], v[56:59]
v_mfma_f32_16x16x32_bf16 v[28:31], a[60:63], a[136:139], v[28:31]
buffer_load_dwordx4 a[108:111], v212, s[72:75], s40 offen offset:1024 sc1
v_mfma_f32_16x16x32_bf16 v[60:63], a[60:63], a[140:143], v[60:63]
s_waitcnt vmcnt(38) lgkmcnt(0)
v_mfma_f32_16x16x32_bf16 v[0:3], a[0:3], a[144:147], v[0:3]
ds_read_b64_tr_b16 a[32:33], v200 offset:24576
ds_read_b64_tr_b16 a[34:35], v200 offset:28672
v_mfma_f32_16x16x32_bf16 v[32:35], a[0:3], a[148:151], v[32:35]
ds_read_b64_tr_b16 a[36:37], v201 offset:24576
v_mfma_f32_16x16x32_bf16 v[4:7], a[4:7], a[144:147], v[4:7]
ds_read_b64_tr_b16 a[38:39], v201 offset:28672
buffer_load_dwordx4 v210, s[8:11], s59 offen offset:2048 lds
v_mfma_f32_16x16x32_bf16 v[36:39], a[4:7], a[148:151], v[36:39]
ds_read_b64_tr_b16 a[40:41], v202 offset:24576
v_mfma_f32_16x16x32_bf16 v[8:11], a[8:11], a[144:147], v[8:11]
ds_read_b64_tr_b16 a[42:43], v202 offset:28672
ds_read_b64_tr_b16 a[44:45], v203 offset:24576
v_mfma_f32_16x16x32_bf16 v[40:43], a[8:11], a[148:151], v[40:43]
ds_read_b64_tr_b16 a[46:47], v203 offset:28672
v_mfma_f32_16x16x32_bf16 v[12:15], a[12:15], a[144:147], v[12:15]
ds_read_b64_tr_b16 a[48:49], v204 offset:24576
buffer_load_dwordx4 v211, s[8:11], s59 offen offset:3072 lds
v_mfma_f32_16x16x32_bf16 v[44:47], a[12:15], a[148:151], v[44:47]
ds_read_b64_tr_b16 a[50:51], v204 offset:28672
v_mfma_f32_16x16x32_bf16 v[16:19], a[16:19], a[144:147], v[16:19]
ds_read_b64_tr_b16 a[52:53], v205 offset:24576
ds_read_b64_tr_b16 a[54:55], v205 offset:28672
v_mfma_f32_16x16x32_bf16 v[48:51], a[16:19], a[148:151], v[48:51]
ds_read_b64_tr_b16 a[56:57], v206 offset:24576
v_mfma_f32_16x16x32_bf16 v[20:23], a[20:23], a[144:147], v[20:23]
ds_read_b64_tr_b16 a[58:59], v206 offset:28672
buffer_load_dwordx4 a[112:115], v212, s[68:71], s40 offen offset:2048 sc1
v_mfma_f32_16x16x32_bf16 v[52:55], a[20:23], a[148:151], v[52:55]
ds_read_b64_tr_b16 a[60:61], v207 offset:24576
v_mfma_f32_16x16x32_bf16 v[24:27], a[24:27], a[144:147], v[24:27]
ds_read_b64_tr_b16 a[62:63], v207 offset:28672
v_mfma_f32_16x16x32_bf16 v[56:59], a[24:27], a[148:151], v[56:59]
v_mfma_f32_16x16x32_bf16 v[28:31], a[28:31], a[144:147], v[28:31]
buffer_load_dwordx4 a[116:119], v212, s[72:75], s40 offen offset:2048 sc1
v_mfma_f32_16x16x32_bf16 v[60:63], a[28:31], a[148:151], v[60:63]
s_waitcnt vmcnt(34) lgkmcnt(0)
s_barrier
v_mfma_f32_16x16x32_bf16 v[0:3], a[32:35], a[152:155], v[0:3]
ds_read_b64_tr_b16 a[0:1], v200 offset:32768
ds_read_b64_tr_b16 a[2:3], v200 offset:36864
s_add_u32 s38, s38, 262144
v_mfma_f32_16x16x32_bf16 v[32:35], a[32:35], a[156:159], v[32:35]
ds_read_b64_tr_b16 a[4:5], v201 offset:32768
s_add_u32 m0, s98, 65536
v_mfma_f32_16x16x32_bf16 v[4:7], a[36:39], a[152:155], v[4:7]
ds_read_b64_tr_b16 a[6:7], v201 offset:36864
buffer_load_dwordx4 v208, s[8:11], s38 offen offset:0 lds
v_mfma_f32_16x16x32_bf16 v[36:39], a[36:39], a[156:159], v[36:39]
ds_read_b64_tr_b16 a[8:9], v202 offset:32768
v_mfma_f32_16x16x32_bf16 v[8:11], a[40:43], a[152:155], v[8:11]
ds_read_b64_tr_b16 a[10:11], v202 offset:36864
ds_read_b64_tr_b16 a[12:13], v203 offset:32768
v_mfma_f32_16x16x32_bf16 v[40:43], a[40:43], a[156:159], v[40:43]
ds_read_b64_tr_b16 a[14:15], v203 offset:36864
v_mfma_f32_16x16x32_bf16 v[12:15], a[44:47], a[152:155], v[12:15]
ds_read_b64_tr_b16 a[16:17], v204 offset:32768
buffer_load_dwordx4 v209, s[8:11], s38 offen offset:1024 lds
v_mfma_f32_16x16x32_bf16 v[44:47], a[44:47], a[156:159], v[44:47]
ds_read_b64_tr_b16 a[18:19], v204 offset:36864
v_mfma_f32_16x16x32_bf16 v[16:19], a[48:51], a[152:155], v[16:19]
ds_read_b64_tr_b16 a[20:21], v205 offset:32768
ds_read_b64_tr_b16 a[22:23], v205 offset:36864
v_mfma_f32_16x16x32_bf16 v[48:51], a[48:51], a[156:159], v[48:51]
ds_read_b64_tr_b16 a[24:25], v206 offset:32768
v_mfma_f32_16x16x32_bf16 v[20:23], a[52:55], a[152:155], v[20:23]
ds_read_b64_tr_b16 a[26:27], v206 offset:36864
buffer_load_dwordx4 a[120:123], v212, s[68:71], s40 offen offset:3072 sc1
v_mfma_f32_16x16x32_bf16 v[52:55], a[52:55], a[156:159], v[52:55]
ds_read_b64_tr_b16 a[28:29], v207 offset:32768
v_mfma_f32_16x16x32_bf16 v[24:27], a[56:59], a[152:155], v[24:27]
ds_read_b64_tr_b16 a[30:31], v207 offset:36864
v_mfma_f32_16x16x32_bf16 v[56:59], a[56:59], a[156:159], v[56:59]
v_mfma_f32_16x16x32_bf16 v[28:31], a[60:63], a[152:155], v[28:31]
buffer_load_dwordx4 a[124:127], v212, s[72:75], s40 offen offset:3072 sc1
v_mfma_f32_16x16x32_bf16 v[60:63], a[60:63], a[156:159], v[60:63]
s_add_u32 s40, s40, 0x80000
s_add_u32 s46, s46, 1
s_cmp_ge_u32 s46, s34
s_cbranch_scc1 L2_done
s_waitcnt vmcnt(36) lgkmcnt(0)
v_mfma_f32_16x16x32_bf16 v[0:3], a[0:3], a[160:163], v[0:3]
ds_read_b64_tr_b16 a[32:33], v200 offset:40960
ds_read_b64_tr_b16 a[34:35], v200 offset:45056
v_mfma_f32_16x16x32_bf16 v[32:35], a[0:3], a[164:167], v[32:35]
ds_read_b64_tr_b16 a[36:37], v201 offset:40960
s_add_u32 s59, s38, 32768
v_mfma_f32_16x16x32_bf16 v[4:7], a[4:7], a[160:163], v[4:7]
ds_read_b64_tr_b16 a[38:39], v201 offset:45056
buffer_load_dwordx4 v210, s[8:11], s38 offen offset:2048 lds
v_mfma_f32_16x16x32_bf16 v[36:39], a[4:7], a[164:167], v[36:39]
ds_read_b64_tr_b16 a[40:41], v202 offset:40960
v_mfma_f32_16x16x32_bf16 v[8:11], a[8:11], a[160:163], v[8:11]
ds_read_b64_tr_b16 a[42:43], v202 offset:45056
ds_read_b64_tr_b16 a[44:45], v203 offset:40960
v_mfma_f32_16x16x32_bf16 v[40:43], a[8:11], a[164:167], v[40:43]
ds_read_b64_tr_b16 a[46:47], v203 offset:45056
v_mfma_f32_16x16x32_bf16 v[12:15], a[12:15], a[160:163], v[12:15]
ds_read_b64_tr_b16 a[48:49], v204 offset:40960
buffer_load_dwordx4 v211, s[8:11], s38 offen offset:3072 lds
v_mfma_f32_16x16x32_bf16 v[44:47], a[12:15], a[164:167], v[44:47]
ds_read_b64_tr_b16 a[50:51], v204 offset:45056
v_mfma_f32_16x16x32_bf16 v[16:19], a[16:19], a[160:163], v[16:19]
ds_read_b64_tr_b16 a[52:53], v205 offset:40960
ds_read_b64_tr_b16 a[54:55], v205 offset:45056
v_mfma_f32_16x16x32_bf16 v[48:51], a[16:19], a[164:167], v[48:51]
ds_read_b64_tr_b16 a[56:57], v206 offset:40960
v_mfma_f32_16x16x32_bf16 v[20:23], a[20:23], a[160:163], v[20:23]
ds_read_b64_tr_b16 a[58:59], v206 offset:45056
buffer_load_dwordx4 a[128:131], v212, s[68:71], s40 offen offset:0 sc1
v_mfma_f32_16x16x32_bf16 v[52:55], a[20:23], a[164:167], v[52:55]
ds_read_b64_tr_b16 a[60:61], v207 offset:40960
v_mfma_f32_16x16x32_bf16 v[24:27], a[24:27], a[160:163], v[24:27]
ds_read_b64_tr_b16 a[62:63], v207 offset:45056
v_mfma_f32_16x16x32_bf16 v[56:59], a[24:27], a[164:167], v[56:59]
v_mfma_f32_16x16x32_bf16 v[28:31], a[28:31], a[160:163], v[28:31]
buffer_load_dwordx4 a[132:135], v212, s[72:75], s40 offen offset:0 sc1
v_mfma_f32_16x16x32_bf16 v[60:63], a[28:31], a[164:167], v[60:63]
s_waitcnt vmcnt(38) lgkmcnt(0)
v_mfma_f32_16x16x32_bf16 v[0:3], a[32:35], a[168:171], v[0:3]
ds_read_b64_tr_b16 a[0:1], v200 offset:49152
ds_read_b64_tr_b16 a[2:3], v200 offset:53248
v_mfma_f32_16x16x32_bf16 v[32:35], a[32:35], a[172:175], v[32:35]
ds_read_b64_tr_b16 a[4:5], v201 offset:49152
s_add_u32 m0, s98, 69632
v_mfma_f32_16x16x32_bf16 v[4:7], a[36:39], a[168:171], v[4:7]
ds_read_b64_tr_b16 a[6:7], v201 offset:53248
buffer_load_dwordx4 v208, s[8:11], s59 offen offset:0 lds
v_mfma_f32_16x16x32_bf16 v[36:39], a[36:39], a[172:175], v[36:39]
ds_read_b64_tr_b16 a[8:9], v202 offset:49152
v_mfma_f32_16x16x32_bf16 v[8:11], a[40:43], a[168:171], v[8:11]
ds_read_b64_tr_b16 a[10:11], v202 offset:53248
ds_read_b64_tr_b16 a[12:13], v203 offset:49152
v_mfma_f32_16x16x32_bf16 v[40:43], a[40:43], a[172:175], v[40:43]
ds_read_b64_tr_b16 a[14:15], v203 offset:53248
v_mfma_f32_16x16x32_bf16 v[12:15], a[44:47], a[168:171], v[12:15]
ds_read_b64_tr_b16 a[16:17], v204 offset:49152
buffer_load_dwordx4 v209, s[8:11], s59 offen offset:1024 lds
v_mfma_f32_16x16x32_bf16 v[44:47], a[44:47], a[172:175], v[44:47]
ds_read_b64_tr_b16 a[18:19], v204 offset:53248
v_mfma_f32_16x16x32_bf16 v[16:19], a[48:51], a[168:171], v[16:19]
ds_read_b64_tr_b16 a[20:21], v205 offset:49152
ds_read_b64_tr_b16 a[22:23], v205 offset:53248
v_mfma_f32_16x16x32_bf16 v[48:51], a[48:51], a[172:175], v[48:51]
ds_read_b64_tr_b16 a[24:25], v206 offset:49152
v_mfma_f32_16x16x32_bf16 v[20:23], a[52:55], a[168:171], v[20:23]
ds_read_b64_tr_b16 a[26:27], v206 offset:53248
buffer_load_dwordx4 a[136:139], v212, s[68:71], s40 offen offset:1024 sc1
v_mfma_f32_16x16x32_bf16 v[52:55], a[52:55], a[172:175], v[52:55]
ds_read_b64_tr_b16 a[28:29], v207 offset:49152
v_mfma_f32_16x16x32_bf16 v[24:27], a[56:59], a[168:171], v[24:27]
ds_read_b64_tr_b16 a[30:31], v207 offset:53248
v_mfma_f32_16x16x32_bf16 v[56:59], a[56:59], a[172:175], v[56:59]
v_mfma_f32_16x16x32_bf16 v[28:31], a[60:63], a[168:171], v[28:31]
buffer_load_dwordx4 a[140:143], v212, s[72:75], s40 offen offset:1024 sc1
v_mfma_f32_16x16x32_bf16 v[60:63], a[60:63], a[172:175], v[60:63]
s_waitcnt vmcnt(38) lgkmcnt(0)
v_mfma_f32_16x16x32_bf16 v[0:3], a[0:3], a[176:179], v[0:3]
ds_read_b64_tr_b16 a[32:33], v200 offset:57344
ds_read_b64_tr_b16 a[34:35], v200 offset:61440
v_mfma_f32_16x16x32_bf16 v[32:35], a[0:3], a[180:183], v[32:35]
ds_read_b64_tr_b16 a[36:37], v201 offset:57344
v_mfma_f32_16x16x32_bf16 v[4:7], a[4:7], a[176:179], v[4:7]
ds_read_b64_tr_b16 a[38:39], v201 offset:61440
buffer_load_dwordx4 v210, s[8:11], s59 offen offset:2048 lds
v_mfma_f32_16x16x32_bf16 v[36:39], a[4:7], a[180:183], v[36:39]
ds_read_b64_tr_b16 a[40:41], v202 offset:57344
v_mfma_f32_16x16x32_bf16 v[8:11], a[8:11], a[176:179], v[8:11]
ds_read_b64_tr_b16 a[42:43], v202 offset:61440
ds_read_b64_tr_b16 a[44:45], v203 offset:57344
v_mfma_f32_16x16x32_bf16 v[40:43], a[8:11], a[180:183], v[40:43]
ds_read_b64_tr_b16 a[46:47], v203 offset:61440
v_mfma_f32_16x16x32_bf16 v[12:15], a[12:15], a[176:179], v[12:15]
ds_read_b64_tr_b16 a[48:49], v204 offset:57344
buffer_load_dwordx4 v211, s[8:11], s59 offen offset:3072 lds
v_mfma_f32_16x16x32_bf16 v[44:47], a[12:15], a[180:183], v[44:47]
ds_read_b64_tr_b16 a[50:51], v204 offset:61440
v_mfma_f32_16x16x32_bf16 v[16:19], a[16:19], a[176:179], v[16:19]
ds_read_b64_tr_b16 a[52:53], v205 offset:57344
ds_read_b64_tr_b16 a[54:55], v205 offset:61440
v_mfma_f32_16x16x32_bf16 v[48:51], a[16:19], a[180:183], v[48:51]
ds_read_b64_tr_b16 a[56:57], v206 offset:57344
v_mfma_f32_16x16x32_bf16 v[20:23], a[20:23], a[176:179], v[20:23]
ds_read_b64_tr_b16 a[58:59], v206 offset:61440
buffer_load_dwordx4 a[144:147], v212, s[68:71], s40 offen offset:2048 sc1
v_mfma_f32_16x16x32_bf16 v[52:55], a[20:23], a[180:183], v[52:55]
ds_read_b64_tr_b16 a[60:61], v207 offset:57344
v_mfma_f32_16x16x32_bf16 v[24:27], a[24:27], a[176:179], v[24:27]
ds_read_b64_tr_b16 a[62:63], v207 offset:61440
v_mfma_f32_16x16x32_bf16 v[56:59], a[24:27], a[180:183], v[56:59]
v_mfma_f32_16x16x32_bf16 v[28:31], a[28:31], a[176:179], v[28:31]
buffer_load_dwordx4 a[148:151], v212, s[72:75], s40 offen offset:2048 sc1
v_mfma_f32_16x16x32_bf16 v[60:63], a[28:31], a[180:183], v[60:63]
s_waitcnt vmcnt(34) lgkmcnt(0)
s_barrier
v_mfma_f32_16x16x32_bf16 v[0:3], a[32:35], a[184:187], v[0:3]
ds_read_b64_tr_b16 a[0:1], v192 offset:0
ds_read_b64_tr_b16 a[2:3], v192 offset:4096
s_add_u32 s38, s38, 262144
v_mfma_f32_16x16x32_bf16 v[32:35], a[32:35], a[188:191], v[32:35]
ds_read_b64_tr_b16 a[4:5], v193 offset:0
s_add_u32 m0, s98, 98304
v_mfma_f32_16x16x32_bf16 v[4:7], a[36:39], a[184:187], v[4:7]
ds_read_b64_tr_b16 a[6:7], v193 offset:4096
buffer_load_dwordx4 v208, s[8:11], s38 offen offset:0 lds
v_mfma_f32_16x16x32_bf16 v[36:39], a[36:39], a[188:191], v[36:39]
ds_read_b64_tr_b16 a[8:9], v194 offset:0
v_mfma_f32_16x16x32_bf16 v[8:11], a[40:43], a[184:187], v[8:11]
ds_read_b64_tr_b16 a[10:11], v194 offset:4096
ds_read_b64_tr_b16 a[12:13], v195 offset:0
v_mfma_f32_16x16x32_bf16 v[40:43], a[40:43], a[188:191], v[40:43]
ds_read_b64_tr_b16 a[14:15], v195 offset:4096
v_mfma_f32_16x16x32_bf16 v[12:15], a[44:47], a[184:187], v[12:15]
ds_read_b64_tr_b16 a[16:17], v196 offset:0
buffer_load_dwordx4 v209, s[8:11], s38 offen offset:1024 lds
v_mfma_f32_16x16x32_bf16 v[44:47], a[44:47], a[188:191], v[44:47]
ds_read_b64_tr_b16 a[18:19], v196 offset:4096
v_mfma_f32_16x16x32_bf16 v[16:19], a[48:51], a[184:187], v[16:19]
ds_read_b64_tr_b16 a[20:21], v197 offset:0
ds_read_b64_tr_b16 a[22:23], v197 offset:4096
v_mfma_f32_16x16x32_bf16 v[48:51], a[48:51], a[188:191], v[48:51]
ds_read_b64_tr_b16 a[24:25], v198 offset:0
v_mfma_f32_16x16x32_bf16 v[20:23], a[52:55], a[184:187], v[20:23]
ds_read_b64_tr_b16 a[26:27], v198 offset:4096
buffer_load_dwordx4 a[152:155], v212, s[68:71], s40 offen offset:3072 sc1
v_mfma_f32_16x16x32_bf16 v[52:55], a[52:55], a[188:191], v[52:55]
ds_read_b64_tr_b16 a[28:29], v199 offset:0
v_mfma_f32_16x16x32_bf16 v[24:27], a[56:59], a[184:187], v[24:27]
ds_read_b64_tr_b16 a[30:31], v199 offset:4096
v_mfma_f32_16x16x32_bf16 v[56:59], a[56:59], a[188:191], v[56:59]
v_mfma_f32_16x16x32_bf16 v[28:31], a[60:63], a[184:187], v[28:31]
buffer_load_dwordx4 a[156:159], v212, s[72:75], s40 offen offset:3072 sc1
v_mfma_f32_16x16x32_bf16 v[60:63], a[60:63], a[188:191], v[60:63]
s_add_u32 s40, s40, 0x80000
s_add_u32 s46, s46, 1
s_cmp_ge_u32 s46, s34
s_cbranch_scc0 L2_loop
L2_done:
s_cmp_eq_u32 s94, 0
s_cbranch_scc0 L2_P
s_nop 4
v_max3_f32 v128, abs(v0), abs(v1), abs(v2)
v_max3_f32 v129, abs(v16), abs(v17), abs(v18)
v_max3_f32 v130, abs(v32), abs(v33), abs(v34)
v_max3_f32 v131, abs(v48), abs(v49), abs(v50)
v_max3_f32 v128, v128, abs(v3), abs(v4)
v_max3_f32 v129, v129, abs(v19), abs(v20)
v_max3_f32 v130, v130, abs(v35), abs(v36)
v_max3_f32 v131, v131, abs(v51), abs(v52)
v_max3_f32 v128, v128, abs(v5), abs(v6)
v_max3_f32 v129, v129, abs(v21), abs(v22)
v_max3_f32 v130, v130, abs(v37), abs(v38)
v_max3_f32 v131, v131, abs(v53), abs(v54)
v_max3_f32 v128, v128, abs(v7), abs(v8)
v_max3_f32 v129, v129, abs(v23), abs(v24)
v_max3_f32 v130, v130, abs(v39), abs(v40)
v_max3_f32 v131, v131, abs(v55), abs(v56)
v_max3_f32 v128, v128, abs(v9), abs(v10)
v_max3_f32 v129, v129, abs(v25), abs(v26)
v_max3_f32 v130, v130, abs(v41), abs(v42)
v_max3_f32 v131, v131, abs(v57), abs(v58)
v_max3_f32 v128, v128, abs(v11), abs(v12)
v_max3_f32 v129, v129, abs(v27), abs(v28)
v_max3_f32 v130, v130, abs(v43), abs(v44)
v_max3_f32 v131, v131, abs(v59), abs(v60)
v_max3_f32 v128, v128, abs(v13), abs(v14)
v_max3_f32 v129, v129, abs(v29), abs(v30)
v_max3_f32 v130, v130, abs(v45), abs(v46)
v_max3_f32 v131, v131, abs(v61), abs(v62)
v_max3_f32 v128, v128, abs(v15), abs(v31)
v_max3_f32 v130, v130, abs(v47), abs(v63)
v_max_f32 v128, v128, v129
v_max_f32 v129, v130, v131
v_lshrrev_b32 v128, 23, v128
v_lshrrev_b32 v129, 23, v129
v_med3_u32 v128, v128, 15, s84
v_med3_u32 v129, v129, 15, s84
v_sub_u32 v130, s85, v128
v_sub_u32 v132, s85, v129
v_subrev_u32 v134, 14, v128
v_subrev_u32 v135, 14, v129
v_lshlrev_b32 v130, 23, v130
v_lshlrev_b32 v132, 23, v132
v_lshlrev_b32 v134, 23, v134
v_lshlrev_b32 v135, 23, v135
v_mov_b32 v131, v130
v_mov_b32 v133, v132
v_lshlrev_b32 v136, 3, v254
buffer_store_dwordx2 v[134:135], v136, s[12:15], s82 offen sc1
v_pk_mul_f32 v[0:1], v[0:1], v[130:131]
v_pk_mul_f32 v[2:3], v[2:3], v[130:131]
v_pk_mul_f32 v[4:5], v[4:5], v[130:131]
v_pk_mul_f32 v[6:7], v[6:7], v[130:131]
v_cvt_pk_f16_f32 v64, v0, v1
v_cvt_pk_f16_f32 v65, v2, v3
v_cvt_pk_f16_f32 v66, v4, v5
v_cvt_pk_f16_f32 v67, v6, v7
buffer_store_dwordx4 v[64:67], v212, s[12:15], s80 offen offset:0 sc1
v_pk_mul_f32 v[8:9], v[8:9], v[130:131]
v_pk_mul_f32 v[10:11], v[10:11], v[130:131]
v_pk_mul_f32 v[12:13], v[12:13], v[130:131]
v_pk_mul_f32 v[14:15], v[14:15], v[130:131]
v_cvt_pk_f16_f32 v68, v8, v9
v_cvt_pk_f16_f32 v69, v10, v11
v_cvt_pk_f16_f32 v70, v12, v13
v_cvt_pk_f16_f32 v71, v14, v15
buffer_store_dwordx4 v[68:71], v212, s[12:15], s80 offen offset:1024 sc1
v_pk_mul_f32 v[16:17], v[16:17], v[130:131]
v_pk_mul_f32 v[18:19], v[18:19], v[130:131]
v_pk_mul_f32 v[20:21], v[20:21], v[130:131]
v_pk_mul_f32 v[22:23], v[22:23], v[130:131]
v_cvt_pk_f16_f32 v72, v16, v17
v_cvt_pk_f16_f32 v73, v18, v19
v_cvt_pk_f16_f32 v74, v20, v21
v_cvt_pk_f16_f32 v75, v22, v23
buffer_store_dwordx4 v[72:75], v212, s[12:15], s80 offen offset:2048 sc1
v_pk_mul_f32 v[24:25], v[24:25], v[130:131]
v_pk_mul_f32 v[26:27], v[26:27], v[130:131]
v_pk_mul_f32 v[28:29], v[28:29], v[130:131]
v_pk_mul_f32 v[30:31], v[30:31], v[130:131]
v_cvt_pk_f16_f32 v76, v24, v25
v_cvt_pk_f16_f32 v77, v26, v27
v_cvt_pk_f16_f32 v78, v28, v29
v_cvt_pk_f16_f32 v79, v30, v31
buffer_store_dwordx4 v[76:79], v212, s[12:15], s80 offen offset:3072 sc1
v_pk_mul_f32 v[32:33], v[32:33], v[132:133]
v_pk_mul_f32 v[34:35], v[34:35], v[132:133]
v_pk_mul_f32 v[36:37], v[36:37], v[132:133]
v_pk_mul_f32 v[38:39], v[38:39], v[132:133]
v_cvt_pk_f16_f32 v80, v32, v33
v_cvt_pk_f16_f32 v81, v34, v35
v_cvt_pk_f16_f32 v82, v36, v37
v_cvt_pk_f16_f32 v83, v38, v39
buffer_store_dwordx4 v[80:83], v212, s[12:15], s81 offen offset:0 sc1
v_pk_mul_f32 v[40:41], v[40:41], v[132:133]
v_pk_mul_f32 v[42:43], v[42:43], v[132:133]
v_pk_mul_f32 v[44:45], v[44:45], v[132:133]
v_pk_mul_f32 v[46:47], v[46:47], v[132:133]
v_cvt_pk_f16_f32 v84, v40, v41
v_cvt_pk_f16_f32 v85, v42, v43
v_cvt_pk_f16_f32 v86, v44, v45
v_cvt_pk_f16_f32 v87, v46, v47
buffer_store_dwordx4 v[84:87], v212, s[12:15], s81 offen offset:1024 sc1
v_pk_mul_f32 v[48:49], v[48:49], v[132:133]
v_pk_mul_f32 v[50:51], v[50:51], v[132:133]
v_pk_mul_f32 v[52:53], v[52:53], v[132:133]
v_pk_mul_f32 v[54:55], v[54:55], v[132:133]
v_cvt_pk_f16_f32 v88, v48, v49
v_cvt_pk_f16_f32 v89, v50, v51
v_cvt_pk_f16_f32 v90, v52, v53
v_cvt_pk_f16_f32 v91, v54, v55
buffer_store_dwordx4 v[88:91], v212, s[12:15], s81 offen offset:2048 sc1
v_pk_mul_f32 v[56:57], v[56:57], v[132:133]
v_pk_mul_f32 v[58:59], v[58:59], v[132:133]
v_pk_mul_f32 v[60:61], v[60:61], v[132:133]
v_pk_mul_f32 v[62:63], v[62:63], v[132:133]
v_cvt_pk_f16_f32 v92, v56, v57
v_cvt_pk_f16_f32 v93, v58, v59
v_cvt_pk_f16_f32 v94, v60, v61
v_cvt_pk_f16_f32 v95, v62, v63
buffer_store_dwordx4 v[92:95], v212, s[12:15], s81 offen offset:3072 sc1
s_waitcnt vmcnt(0)
s_barrier
s_cmp_eq_u32 s20, 0
s_cbranch_scc0 L2_fin
buffer_store_dwordx2 v[230:231], v220, s[12:15], s62 offen sc1
s_branch L2_fin
L2_e2:
s_waitcnt vmcnt(16)
v_cmp_ne_u32 vcc, v219, v221
s_nop 1
s_cbranch_vccnz L2_e2_retry
buffer_load_dwordx4 v[64:67], v212, s[12:15], s80 offen offset:0 sc1
buffer_load_dwordx4 v[68:71], v212, s[12:15], s80 offen offset:1024 sc1
buffer_load_dwordx4 v[72:75], v212, s[12:15], s80 offen offset:2048 sc1
buffer_load_dwordx4 v[76:79], v212, s[12:15], s80 offen offset:3072 sc1
buffer_load_dwordx4 v[80:83], v212, s[12:15], s81 offen offset:0 sc1
buffer_load_dwordx4 v[84:87], v212, s[12:15], s81 offen offset:1024 sc1
buffer_load_dwordx4 v[88:91], v212, s[12:15], s81 offen offset:2048 sc1
buffer_load_dwordx4 v[92:95], v212, s[12:15], s81 offen offset:3072 sc1
buffer_load_dwordx2 v[96:97], v239, s[12:15], s82 offen sc1
s_mov_b32 s66, 1
s_branch L2_e2_ret
L2_e2_retry:
buffer_load_dword v221, v232, s[12:15], s62 offen sc1
s_branch L2_e2_ret
L2_P:
s_nop 3
v_pk_mul_f32 v[0:1], v[0:1], v[240:241]
v_pk_mul_f32 v[2:3], v[2:3], v[240:241]
v_pk_mul_f32 v[4:5], v[4:5], v[240:241]
v_pk_mul_f32 v[6:7], v[6:7], v[240:241]
v_pk_mul_f32 v[8:9], v[8:9], v[240:241]
v_pk_mul_f32 v[10:11], v[10:11], v[240:241]
v_pk_mul_f32 v[12:13], v[12:13], v[240:241]
v_pk_mul_f32 v[14:15], v[14:15], v[240:241]
v_pk_mul_f32 v[16:17], v[16:17], v[240:241]
v_pk_mul_f32 v[18:19], v[18:19], v[240:241]
v_pk_mul_f32 v[20:21], v[20:21], v[240:241]
v_pk_mul_f32 v[22:23], v[22:23], v[240:241]
v_pk_mul_f32 v[24:25], v[24:25], v[240:241]
v_pk_mul_f32 v[26:27], v[26:27], v[240:241]
v_pk_mul_f32 v[28:29], v[28:29], v[240:241]
v_pk_mul_f32 v[30:31], v[30:31], v[240:241]
v_pk_mul_f32 v[32:33], v[32:33], v[242:243]
v_pk_mul_f32 v[34:35], v[34:35], v[242:243]
v_pk_mul_f32 v[36:37], v[36:37], v[242:243]
v_pk_mul_f32 v[38:39], v[38:39], v[242:243]
v_pk_mul_f32 v[40:41], v[40:41], v[242:243]
v_pk_mul_f32 v[42:43], v[42:43], v[242:243]
v_pk_mul_f32 v[44:45], v[44:45], v[242:243]
v_pk_mul_f32 v[46:47], v[46:47], v[242:243]
v_pk_mul_f32 v[48:49], v[48:49], v[242:243]
v_pk_mul_f32 v[50:51], v[50:51], v[242:243]
v_pk_mul_f32 v[52:53], v[52:53], v[242:243]
v_pk_mul_f32 v[54:55], v[54:55], v[242:243]
v_pk_mul_f32 v[56:57], v[56:57], v[242:243]
v_pk_mul_f32 v[58:59], v[58:59], v[242:243]
v_pk_mul_f32 v[60:61], v[60:61], v[242:243]
v_pk_mul_f32 v[62:63], v[62:63], v[242:243]
s_cmp_eq_u32 s66, 1
s_cbranch_scc1 L2_have
s_waitcnt vmcnt(16)
L2_poll:
v_cmp_ne_u32 vcc, v219, v221
s_add_u32 s67, s67, 1
s_cbranch_vccz L2_poll_ok
s_cmp_gt_u32 s67, 0x80000
s_cbranch_scc1 L2_poll_ok
s_sleep 2
buffer_load_dword v221, v232, s[12:15], s62 offen sc1
s_waitcnt vmcnt(0)
s_branch L2_poll
L2_poll_ok:
buffer_load_dwordx4 v[64:67], v212, s[12:15], s80 offen offset:0 sc1
buffer_load_dwordx4 v[68:71], v212, s[12:15], s80 offen offset:1024 sc1
buffer_load_dwordx4 v[72:75], v212, s[12:15], s80 offen offset:2048 sc1
buffer_load_dwordx4 v[76:79], v212, s[12:15], s80 offen offset:3072 sc1
buffer_load_dwordx4 v[80:83], v212, s[12:15], s81 offen offset:0 sc1
buffer_load_dwordx4 v[84:87], v212, s[12:15], s81 offen offset:1024 sc1
buffer_load_dwordx4 v[88:91], v212, s[12:15], s81 offen offset:2048 sc1
buffer_load_dwordx4 v[92:95], v212, s[12:15], s81 offen offset:3072 sc1
buffer_load_dwordx2 v[96:97], v239, s[12:15], s82 offen sc1
L2_have:
s_waitcnt vmcnt(0)
v_mul_f32 v96, v96, v226
v_mul_f32 v97, v97, v227
v_fma_mix_f32 v0, v64, v96, v0 op_sel:[0,0,0] op_sel_hi:[1,0,0]
v_fma_mix_f32 v1, v64, v96, v1 op_sel:[1,0,0] op_sel_hi:[1,0,0]
v_fma_mix_f32 v2, v65, v96, v2 op_sel:[0,0,0] op_sel_hi:[1,0,0]
v_fma_mix_f32 v3, v65, v96, v3 op_sel:[1,0,0] op_sel_hi:[1,0,0]
v_cvt_pk_bf16_f32 v0, v0, v1
v_cvt_pk_bf16_f32 v1, v2, v3
ds_write_b64 v132, v[0:1] offset:0
v_fma_mix_f32 v4, v66, v96, v4 op_sel:[0,0,0] op_sel_hi:[1,0,0]
v_fma_mix_f32 v5, v66, v96, v5 op_sel:[1,0,0] op_sel_hi:[1,0,0]
v_fma_mix_f32 v6, v67, v96, v6 op_sel:[0,0,0] op_sel_hi:[1,0,0]
v_fma_mix_f32 v7, v67, v96, v7 op_sel:[1,0,0] op_sel_hi:[1,0,0]
v_cvt_pk_bf16_f32 v4, v4, v5
v_cvt_pk_bf16_f32 v5, v6, v7
ds_write_b64 v133, v[4:5] offset:0
v_fma_mix_f32 v8, v68, v96, v8 op_sel:[0,0,0] op_sel_hi:[1,0,0]
v_fma_mix_f32 v9, v68, v96, v9 op_sel:[1,0,0] op_sel_hi:[1,0,0]
v_fma_mix_f32 v10, v69, v96, v10 op_sel:[0,0,0] op_sel_hi:[1,0,0]
v_fma_mix_f32 v11, v69, v96, v11 op_sel:[1,0,0] op_sel_hi:[1,0,0]
v_cvt_pk_bf16_f32 v8, v8, v9
v_cvt_pk_bf16_f32 v9, v10, v11
ds_write_b64 v134, v[8:9] offset:0
v_fma_mix_f32 v12, v70, v96, v12 op_sel:[0,0,0] op_sel_hi:[1,0,0]
v_fma_mix_f32 v13, v70, v96, v13 op_sel:[1,0,0] op_sel_hi:[1,0,0]
v_fma_mix_f32 v14, v71, v96, v14 op_sel:[0,0,0] op_sel_hi:[1,0,0]
v_fma_mix_f32 v15, v71, v96, v15 op_sel:[1,0,0] op_sel_hi:[1,0,0]
v_cvt_pk_bf16_f32 v12, v12, v13
v_cvt_pk_bf16_f32 v13, v14, v15
ds_write_b64 v135, v[12:13] offset:0
v_fma_mix_f32 v16, v72, v96, v16 op_sel:[0,0,0] op_sel_hi:[1,0,0]
v_fma_mix_f32 v17, v72, v96, v17 op_sel:[1,0,0] op_sel_hi:[1,0,0]
v_fma_mix_f32 v18, v73, v96, v18 op_sel:[0,0,0] op_sel_hi:[1,0,0]
v_fma_mix_f32 v19, v73, v96, v19 op_sel:[1,0,0] op_sel_hi:[1,0,0]
v_cvt_pk_bf16_f32 v16, v16, v17
v_cvt_pk_bf16_f32 v17, v18, v19
ds_write_b64 v136, v[16:17] offset:0
v_fma_mix_f32 v20, v74, v96, v20 op_sel:[0,0,0] op_sel_hi:[1,0,0]
v_fma_mix_f32 v21, v74, v96, v21 op_sel:[1,0,0] op_sel_hi:[1,0,0]
v_fma_mix_f32 v22, v75, v96, v22 op_sel:[0,0,0] op_sel_hi:[1,0,0]
v_fma_mix_f32 v23, v75, v96, v23 op_sel:[1,0,0] op_sel_hi:[1,0,0]
v_cvt_pk_bf16_f32 v20, v20, v21
v_cvt_pk_bf16_f32 v21, v22, v23
ds_write_b64 v137, v[20:21] offset:0
v_fma_mix_f32 v24, v76, v96, v24 op_sel:[0,0,0] op_sel_hi:[1,0,0]
v_fma_mix_f32 v25, v76, v96, v25 op_sel:[1,0,0] op_sel_hi:[1,0,0]
v_fma_mix_f32 v26, v77, v96, v26 op_sel:[0,0,0] op_sel_hi:[1,0,0]
v_fma_mix_f32 v27, v77, v96, v27 op_sel:[1,0,0] op_sel_hi:[1,0,0]
v_cvt_pk_bf16_f32 v24, v24, v25
v_cvt_pk_bf16_f32 v25, v26, v27
ds_write_b64 v138, v[24:25] offset:0
v_fma_mix_f32 v28, v78, v96, v28 op_sel:[0,0,0] op_sel_hi:[1,0,0]
v_fma_mix_f32 v29, v78, v96, v29 op_sel:[1,0,0] op_sel_hi:[1,0,0]
v_fma_mix_f32 v30, v79, v96, v30 op_sel:[0,0,0] op_sel_hi:[1,0,0]
v_fma_mix_f32 v31, v79, v96, v31 op_sel:[1,0,0] op_sel_hi:[1,0,0]
v_cvt_pk_bf16_f32 v28, v28, v29
v_cvt_pk_bf16_f32 v29, v30, v31
ds_write_b64 v139, v[28:29] offset:0
v_fma_mix_f32 v32, v80, v97, v32 op_sel:[0,0,0] op_sel_hi:[1,0,0]
v_fma_mix_f32 v33, v80, v97, v33 op_sel:[1,0,0] op_sel_hi:[1,0,0]
v_fma_mix_f32 v34, v81, v97, v34 op_sel:[0,0,0] op_sel_hi:[1,0,0]
v_fma_mix_f32 v35, v81, v97, v35 op_sel:[1,0,0] op_sel_hi:[1,0,0]
v_cvt_pk_bf16_f32 v32, v32, v33
v_cvt_pk_bf16_f32 v33, v34, v35
ds_write_b64 v132, v[32:33] offset:256
v_fma_mix_f32 v36, v82, v97, v36 op_sel:[0,0,0] op_sel_hi:[1,0,0]
v_fma_mix_f32 v37, v82, v97, v37 op_sel:[1,0,0] op_sel_hi:[1,0,0]
v_fma_mix_f32 v38, v83, v97, v38 op_sel:[0,0,0] op_sel_hi:[1,0,0]
v_fma_mix_f32 v39, v83, v97, v39 op_sel:[1,0,0] op_sel_hi:[1,0,0]
v_cvt_pk_bf16_f32 v36, v36, v37
v_cvt_pk_bf16_f32 v37, v38, v39
ds_write_b64 v133, v[36:37] offset:256
v_fma_mix_f32 v40, v84, v97, v40 op_sel:[0,0,0] op_sel_hi:[1,0,0]
v_fma_mix_f32 v41, v84, v97, v41 op_sel:[1,0,0] op_sel_hi:[1,0,0]
v_fma_mix_f32 v42, v85, v97, v42 op_sel:[0,0,0] op_sel_hi:[1,0,0]
v_fma_mix_f32 v43, v85, v97, v43 op_sel:[1,0,0] op_sel_hi:[1,0,0]
v_cvt_pk_bf16_f32 v40, v40, v41
v_cvt_pk_bf16_f32 v41, v42, v43
ds_write_b64 v134, v[40:41] offset:256
v_fma_mix_f32 v44, v86, v97, v44 op_sel:[0,0,0] op_sel_hi:[1,0,0]
v_fma_mix_f32 v45, v86, v97, v45 op_sel:[1,0,0] op_sel_hi:[1,0,0]
v_fma_mix_f32 v46, v87, v97, v46 op_sel:[0,0,0] op_sel_hi:[1,0,0]
v_fma_mix_f32 v47, v87, v97, v47 op_sel:[1,0,0] op_sel_hi:[1,0,0]
v_cvt_pk_bf16_f32 v44, v44, v45
v_cvt_pk_bf16_f32 v45, v46, v47
ds_write_b64 v135, v[44:45] offset:256
v_fma_mix_f32 v48, v88, v97, v48 op_sel:[0,0,0] op_sel_hi:[1,0,0]
v_fma_mix_f32 v49, v88, v97, v49 op_sel:[1,0,0] op_sel_hi:[1,0,0]
v_fma_mix_f32 v50, v89, v97, v50 op_sel:[0,0,0] op_sel_hi:[1,0,0]
v_fma_mix_f32 v51, v89, v97, v51 op_sel:[1,0,0] op_sel_hi:[1,0,0]
v_cvt_pk_bf16_f32 v48, v48, v49
v_cvt_pk_bf16_f32 v49, v50, v51
ds_write_b64 v136, v[48:49] offset:256
v_fma_mix_f32 v52, v90, v97, v52 op_sel:[0,0,0] op_sel_hi:[1,0,0]
v_fma_mix_f32 v53, v90, v97, v53 op_sel:[1,0,0] op_sel_hi:[1,0,0]
v_fma_mix_f32 v54, v91, v97, v54 op_sel:[0,0,0] op_sel_hi:[1,0,0]
v_fma_mix_f32 v55, v91, v97, v55 op_sel:[1,0,0] op_sel_hi:[1,0,0]
v_cvt_pk_bf16_f32 v52, v52, v53
v_cvt_pk_bf16_f32 v53, v54, v55
ds_write_b64 v137, v[52:53] offset:256
v_fma_mix_f32 v56, v92, v97, v56 op_sel:[0,0,0] op_sel_hi:[1,0,0]
v_fma_mix_f32 v57, v92, v97, v57 op_sel:[1,0,0] op_sel_hi:[1,0,0]
v_fma_mix_f32 v58, v93, v97, v58 op_sel:[0,0,0] op_sel_hi:[1,0,0]
v_fma_mix_f32 v59, v93, v97, v59 op_sel:[1,0,0] op_sel_hi:[1,0,0]
v_cvt_pk_bf16_f32 v56, v56, v57
v_cvt_pk_bf16_f32 v57, v58, v59
ds_write_b64 v138, v[56:57] offset:256
v_fma_mix_f32 v60, v94, v97, v60 op_sel:[0,0,0] op_sel_hi:[1,0,0]
v_fma_mix_f32 v61, v94, v97, v61 op_sel:[1,0,0] op_sel_hi:[1,0,0]
v_fma_mix_f32 v62, v95, v97, v62 op_sel:[0,0,0] op_sel_hi:[1,0,0]
v_fma_mix_f32 v63, v95, v97, v63 op_sel:[1,0,0] op_sel_hi:[1,0,0]
v_cvt_pk_bf16_f32 v60, v60, v61
v_cvt_pk_bf16_f32 v61, v62, v63
ds_write_b64 v139, v[60:61] offset:256
s_waitcnt lgkmcnt(0)
ds_read_b128 v[0:3], v141 offset:0
ds_read_b128 v[4:7], v142 offset:1024
ds_read_b128 v[8:11], v143 offset:2048
ds_read_b128 v[12:15], v144 offset:3072
ds_read_b128 v[16:19], v145 offset:4096
ds_read_b128 v[20:23], v146 offset:5120
ds_read_b128 v[24:27], v147 offset:6144
ds_read_b128 v[28:31], v148 offset:7168
s_waitcnt lgkmcnt(7)
buffer_store_dwordx4 v[0:3], v222, s[16:19], s54 offen sc1
s_add_u32 s54, s54, 8192
s_waitcnt lgkmcnt(6)
buffer_store_dwordx4 v[4:7], v222, s[16:19], s54 offen sc1
s_add_u32 s54, s54, 8192
s_waitcnt lgkmcnt(5)
buffer_store_dwordx4 v[8:11], v222, s[16:19], s54 offen sc1
s_add_u32 s54, s54, 8192
s_waitcnt lgkmcnt(4)
buffer_store_dwordx4 v[12:15], v222, s[16:19], s54 offen sc1
s_add_u32 s54, s54, 8192
s_waitcnt lgkmcnt(3)
buffer_store_dwordx4 v[16:19], v222, s[16:19], s54 offen sc1
s_add_u32 s54, s54, 8192
s_waitcnt lgkmcnt(2)
buffer_store_dwordx4 v[20:23], v222, s[16:19], s54 offen sc1
s_add_u32 s54, s54, 8192
s_waitcnt lgkmcnt(1)
buffer_store_dwordx4 v[24:27], v222, s[16:19], s54 offen sc1
s_add_u32 s54, s54, 8192
s_waitcnt lgkmcnt(0)
buffer_store_dwordx4 v[28:31], v222, s[16:19], s54 offen sc1
L2_fin:
L_exit:
s_endpgm
code_end:
.section .rodata,"a"
.p2align 6
.amdhsa_kernel gated_mix__sliding_local_dilated__dense_activation_relu__prompt_kernel
  .amdhsa_next_free_vgpr 512
  .amdhsa_next_free_sgpr 102
  .amdhsa_accum_offset 256
  .amdhsa_group_segment_fixed_size 0
  .amdhsa_kernarg_size 80
  .amdhsa_user_sgpr_count 2
  .amdhsa_user_sgpr_kernarg_segment_ptr 1
  .amdhsa_system_sgpr_workgroup_id_x 1
.end_amdhsa_kernel
```
